```python
import torch

def _softmax(x, axis=-1):
    return torch.softmax(x, dim=axis)
def _gelu(x):
    return torch.nn.functional.gelu(x, approximate="tanh")
def _silu(x):
    return torch.nn.functional.silu(x)
def _sigmoid(x):
    return torch.sigmoid(x)
def _layernorm(x, axis=-1, eps=1e-5):
    m = x.mean(dim=axis, keepdim=True)
    v = x.var(dim=axis, keepdim=True, unbiased=False)
    return (x - m) / torch.sqrt(v + eps)
def _scatter_add(tgt, idx, src, axis=0):
    return tgt.clone().index_add_(axis, idx, src)
def _segment_sum(src, seg, n):
    out = torch.zeros((n,) + src.shape[1:], dtype=src.dtype)
    return out.index_add_(0, seg, src)
def _pad(x, pw):
    flat = tuple(v for pair in reversed(pw) for v in pair)
    return torch.nn.functional.pad(x, flat)

kernel_name = 'interleave_layers__linear_kernel_hedgehog__dense_activation_squared_relu__prompt'

def setup_inputs():

    _w = (lambda a: (lambda t: t.to(torch.bfloat16) if t.is_floating_point() else t)(torch.as_tensor(a)))
    def _A_setup():
        B, S, D, H = 1, 2048, 448, 16
        Dh = D // H
        return {
            "x": _w((lambda *s: torch.randn(*s, dtype=torch.bfloat16) * 0.05)(B, S, D)),
            "wqkv": _w((lambda *s: torch.randn(*s, dtype=torch.bfloat16) * 0.2)(D, 3 * D)),
            "w_phi": _w((lambda *s: torch.randn(*s, dtype=torch.bfloat16) * 0.2)(H, Dh, Dh) * (Dh ** -0.5)),
            "wo": _w((lambda *s: torch.randn(*s, dtype=torch.bfloat16) * 0.05)(D, D)),
        }
    _A_in = _A_setup()

    def _B_setup():
        B, S, D, F = 1, 2048, 448, 1792
        return {
            "x": _w((lambda *s: torch.randn(*s, dtype=torch.bfloat16) * 0.05)(B, S, D)),
            "w1": _w((lambda *s: torch.randn(*s, dtype=torch.bfloat16) * 0.05)(D, F)),
            "b1": _w((lambda *s: torch.randn(*s, dtype=torch.bfloat16) * 0.2)(F)),
            "w2": _w((lambda *s: torch.randn(*s, dtype=torch.bfloat16) * 0.05)(F, D)),
            "b2": _w((lambda *s: torch.randn(*s, dtype=torch.bfloat16) * 0.4)(D)),
        }
    _B_in = _B_setup()

    return {
        "A_x": _A_in["x"],
        "A_wqkv": _A_in["wqkv"],
        "A_w_phi": _A_in["w_phi"],
        "A_wo": _A_in["wo"],
        "B_x": _B_in["x"],
        "B_w1": _B_in["w1"],
        "B_b1": _B_in["b1"],
        "B_w2": _B_in["w2"],
        "B_b2": _B_in["b2"],
    }

def reference(A_x, A_wqkv, A_w_phi, A_wo, B_x, B_w1, B_b1, B_w2, B_b2):
    def _A_ref(x, wqkv, w_phi, wo):
        B, S, D = x.shape
        H = 16; Dh = D // H
        qkv = (lambda x, *d: x.permute(*d))((x @ wqkv).reshape(B, S, 3, H, Dh), 2, 0, 3, 1, 4)
        q, k, v = qkv[0], qkv[1], qkv[2]
        pq = torch.einsum("bhsd,hdf->bhsf", q, w_phi)
        pk = torch.einsum("bhsd,hdf->bhsf", k, w_phi)
        phi_q = torch.concatenate([_softmax(pq, axis=-1), _softmax(-pq, axis=-1)], axis=-1)
        phi_k = torch.concatenate([_softmax(pk, axis=-1), _softmax(-pk, axis=-1)], axis=-1)
        kv = torch.einsum("bhsf,bhsd->bhfd", phi_k, v)
        z  = torch.einsum("bhsf->bhf", phi_k)
        num = torch.einsum("bhqf,bhfd->bhqd", phi_q, kv)
        den = torch.einsum("bhqf,bhf->bhq", phi_q, z)[..., None] + 1e-6
        o = num / den
        return (lambda x, *d: x.permute(*d))(o, 0, 2, 1, 3).reshape(B, S, D) @ wo

    def _B_ref(x, w1, b1, w2, b2):
        h = torch.einsum("bsd,df->bsf", x, w1) + b1
        zero = torch.zeros_like(h)
        r = torch.where(h > zero, h, zero)
        h = r * r
        out = torch.einsum("bsf,fd->bsd", h, w2) + b2
        return out

    x = A_x
    x = x + _A_ref(_layernorm(x, axis=-1), A_wqkv, A_w_phi, A_wo)
    x = x + _B_ref(_layernorm(x, axis=-1), B_w1, B_b1, B_w2, B_b2)
    x = x + _A_ref(_layernorm(x, axis=-1), A_wqkv, A_w_phi, A_wo)
    x = x + _B_ref(_layernorm(x, axis=-1), B_w1, B_b1, B_w2, B_b2)
    return x
```

```asm
; @launch kernel=prep_kernel grid=(2088,1,1) block=(256,1,1) lds=4608
; @launch kernel=qkv0_kernel grid=(256,1,1) block=(512,1,1) lds=128512
; @launch kernel=wo0_kernel grid=(224,1,1) block=(256,1,1) lds=65536
; @launch kernel=ffa0_kernel grid=(224,1,1) block=(512,1,1) lds=122880
; @launch kernel=ffb0_kernel grid=(224,1,1) block=(256,1,1) lds=65536
; @launch kernel=qkv1_kernel grid=(256,1,1) block=(512,1,1) lds=128512
; @launch kernel=wo1_kernel grid=(224,1,1) block=(256,1,1) lds=65536
; @launch kernel=ffa1_kernel grid=(224,1,1) block=(512,1,1) lds=122880
; @launch kernel=ffb1_kernel grid=(224,1,1) block=(256,1,1) lds=65536
.amdgcn_target "amdgcn-amd-amdhsa--gfx950"
.text
.globl prep_kernel
.p2align 8
.type prep_kernel,@function
prep_kernel:
    s_load_dwordx4 s[4:7], s[0:1], 0
    s_load_dwordx4 s[8:11], s[0:1], 16
    s_load_dwordx2 s[12:13], s[0:1], 40
    s_load_dwordx2 s[14:15], s[0:1], 56
    s_load_dwordx2 s[16:17], s[0:1], 88
    s_cmp_ge_u32 s2, 2088
    s_cbranch_scc1 K0_END
    v_lshrrev_b32 v1, 6, v0
    v_and_b32 v0, 63, v0
    v_readfirstlane_b32 s3, v1
    v_lshlrev_b32 v2, 4, v0
    v_and_b32 v3, 15, v0
    v_lshrrev_b32 v4, 4, v0
    s_lshl_b32 s18, s2, 2
    s_add_u32 s18, s18, s3
    s_waitcnt lgkmcnt(0)
    s_mov_b32 s20, s16
    s_and_b32 s21, s17, 0xffff
    s_mov_b32 s22, 0x10000000
    s_mov_b32 s23, 0x00020000
    s_mov_b32 s40, 0x7fff0000
    s_cmp_lt_u32 s18, 1792
    s_cbranch_scc1 K0_x
    s_cmp_lt_u32 s18, 1824
    s_cbranch_scc1 K0_wphi
    s_cmp_lt_u32 s18, 2080
    s_cbranch_scc1 K0_zero
    s_cmp_lt_u32 s18, 3648
    s_cbranch_scc1 K0_tw1
    s_cmp_lt_u32 s18, 5216
    s_cbranch_scc1 K0_tw2
    s_cmp_lt_u32 s18, 5664
    s_cbranch_scc1 K0_two
    s_cmp_lt_u32 s18, 8352
    s_cbranch_scc1 K0_twq
    s_branch K0_END
    s_nop 11
K0_x:
    s_sub_u32 s19, s18, 0
    s_mov_b32 s24, s4
    s_and_b32 s25, s5, 0xffff
    s_mov_b32 s26, 0x1c0000
    s_mov_b32 s27, 0x00020000
    s_mul_hi_u32 s30, s19, 0x12492493
    s_mul_i32 s31, s30, 14
    s_sub_u32 s31, s19, s31
    s_mul_i32 s32, s30, 14336
    s_lshl_b32 s33, s31, 6
    s_add_u32 s32, s32, s33
    v_mul_u32_u24 v5, 896, v3
    v_lshl_add_u32 v5, v4, 3, v5
    v_add_u32 v5, s32, v5
    buffer_load_dwordx2 v[8:9], v5, s[24:27], 0 offen
    buffer_load_dwordx2 v[10:11], v5, s[24:27], 0 offen offset:32
    s_lshl_b32 s41, s19, 10
    s_add_u32 s41, s41, 0
    s_waitcnt vmcnt(0)
    buffer_store_dwordx4 v[8:11], v2, s[20:23], s41 offen
    s_branch K0_END
    s_nop 11
K0_wphi:
    s_sub_u32 s19, s18, 1792
    s_mov_b32 s24, s8
    s_and_b32 s25, s9, 0xffff
    s_mov_b32 s26, 0x6200
    s_mov_b32 s27, 0x00020000
    s_lshr_b32 s30, s19, 1
    s_and_b32 s31, s19, 1
    s_lshl_b32 s34, s31, 4
    v_add_u32 v5, s34, v3
    v_lshlrev_b32 v13, 2, v4
    v_mul_u32_u24 v13, 56, v13
    v_lshl_add_u32 v13, v5, 1, v13
    s_mul_i32 s34, s30, 1568
    v_add_u32 v13, s34, v13
    v_cmp_gt_u32 vcc, 28, v5
    v_mov_b32 v14, s40
    s_nop 0
    v_cndmask_b32 v13, v14, v13, vcc
    v_cmp_gt_u32 vcc, 3, v4
    s_nop 1
    s_nop 0
    v_cndmask_b32 v15, v14, v13, vcc
    s_mov_b32 s44, 0
    s_mov_b32 s45, 56
    s_mov_b32 s46, 112
    s_mov_b32 s47, 168
    s_mov_b32 s48, 896
    s_mov_b32 s49, 952
    s_mov_b32 s50, 1008
    s_mov_b32 s51, 1064
    buffer_load_ushort v16, v13, s[24:27], s44 offen
    buffer_load_ushort v17, v13, s[24:27], s45 offen
    buffer_load_ushort v18, v13, s[24:27], s46 offen
    buffer_load_ushort v19, v13, s[24:27], s47 offen
    buffer_load_ushort v20, v15, s[24:27], s48 offen
    buffer_load_ushort v21, v15, s[24:27], s49 offen
    buffer_load_ushort v22, v15, s[24:27], s50 offen
    buffer_load_ushort v23, v15, s[24:27], s51 offen
    s_lshl_b32 s41, s19, 10
    s_add_u32 s41, s41, 3211264
    s_waitcnt vmcnt(0)
    v_lshl_or_b32 v8, v17, 16, v16
    v_lshl_or_b32 v9, v19, 16, v18
    v_lshl_or_b32 v10, v21, 16, v20
    v_lshl_or_b32 v11, v23, 16, v22
    buffer_store_dwordx4 v[8:11], v2, s[20:23], s41 offen
    s_branch K0_END
    s_nop 11
K0_zero:
    s_sub_u32 s19, s18, 1824
    v_mov_b32 v8, 0
    v_mov_b32 v9, 0
    v_mov_b32 v10, 0
    v_mov_b32 v11, 0
    s_lshl_b32 s41, s19, 10
    s_add_u32 s41, s41, 6914048
    buffer_store_dwordx4 v[8:11], v2, s[20:23], s41 offen
    s_nop 11
K0_tw1:
    s_sub_u32 s19, s18, 2080
    s_mov_b32 s24, s12
    s_and_b32 s25, s13, 0xffff
    s_mov_b32 s26, 0x188000
    s_mov_b32 s27, 0x00020000
    s_lshr_b32 s19, s19, 2
    s_mul_hi_u32 s31, s19, 0x924924a
    s_mul_i32 s32, s31, 28
    s_sub_u32 s32, s19, s32
    s_mul_i32 s30, s31, 114688
    s_lshl_b32 s33, s32, 7
    s_add_u32 s30, s30, s33
    s_lshr_b32 s33, s32, 1
    s_mul_i32 s33, s33, 14
    s_add_u32 s33, s33, s31
    s_lshl_b32 s33, s33, 3
    s_and_b32 s34, s32, 1
    s_lshl_b32 s34, s34, 2
    s_add_u32 s33, s33, s34
    s_add_u32 s33, s33, s3
    s_lshl_b32 s41, s33, 10
    s_add_u32 s41, s41, 3702784
    v_lshl_add_u32 v13, s3, 4, v3
    v_lshl_or_b32 v5, s3, 6, v0
    v_lshrrev_b32 v6, 3, v5
    v_and_b32 v7, 7, v5
    v_mul_u32_u24 v12, 3584, v6
    v_lshl_add_u32 v12, v7, 4, v12
    buffer_load_dwordx4 v[16:19], v12, s[24:27], s30 offen
    v_mul_u32_u24 v12, 144, v6
    v_lshl_add_u32 v12, v7, 4, v12
    s_waitcnt vmcnt(0)
    ds_write_b128 v12, v[16:19]
    v_mul_u32_u24 v14, 576, v4
    v_lshl_add_u32 v14, v13, 1, v14
    s_waitcnt lgkmcnt(0)
    s_barrier
    ds_read_u16 v16, v14 offset:0
    ds_read_u16 v17, v14 offset:144
    ds_read_u16 v18, v14 offset:288
    ds_read_u16 v19, v14 offset:432
    ds_read_u16 v20, v14 offset:2304
    ds_read_u16 v21, v14 offset:2448
    ds_read_u16 v22, v14 offset:2592
    ds_read_u16 v23, v14 offset:2736
    s_waitcnt lgkmcnt(0)
    v_lshl_or_b32 v8, v17, 16, v16
    v_lshl_or_b32 v9, v19, 16, v18
    v_lshl_or_b32 v10, v21, 16, v20
    v_lshl_or_b32 v11, v23, 16, v22
    buffer_store_dwordx4 v[8:11], v2, s[20:23], s41 offen
    s_branch K0_END
    s_nop 11
K0_tw2:
    s_sub_u32 s19, s18, 3648
    s_mov_b32 s24, s14
    s_and_b32 s25, s15, 0xffff
    s_mov_b32 s26, 0x188000
    s_mov_b32 s27, 0x00020000
    s_lshr_b32 s19, s19, 2
    s_mul_hi_u32 s31, s19, 0x24924925
    s_mul_i32 s32, s31, 7
    s_sub_u32 s32, s19, s32
    s_mul_i32 s30, s31, 28672
    s_lshl_b32 s33, s32, 7
    s_add_u32 s30, s30, s33
    s_lshl_b32 s33, s32, 2
    s_add_u32 s33, s33, s3
    s_mul_i32 s33, s33, 56
    s_add_u32 s33, s33, s31
    s_lshl_b32 s41, s33, 10
    s_add_u32 s41, s41, 5308416
    v_lshl_add_u32 v13, s3, 4, v3
    v_lshl_or_b32 v5, s3, 6, v0
    v_lshrrev_b32 v6, 3, v5
    v_and_b32 v7, 7, v5
    v_mul_u32_u24 v12, 896, v6
    v_lshl_add_u32 v12, v7, 4, v12
    buffer_load_dwordx4 v[16:19], v12, s[24:27], s30 offen
    v_mul_u32_u24 v12, 144, v6
    v_lshl_add_u32 v12, v7, 4, v12
    s_waitcnt vmcnt(0)
    ds_write_b128 v12, v[16:19]
    v_mul_u32_u24 v14, 576, v4
    v_lshl_add_u32 v14, v13, 1, v14
    s_waitcnt lgkmcnt(0)
    s_barrier
    ds_read_u16 v16, v14 offset:0
    ds_read_u16 v17, v14 offset:144
    ds_read_u16 v18, v14 offset:288
    ds_read_u16 v19, v14 offset:432
    ds_read_u16 v20, v14 offset:2304
    ds_read_u16 v21, v14 offset:2448
    ds_read_u16 v22, v14 offset:2592
    ds_read_u16 v23, v14 offset:2736
    s_waitcnt lgkmcnt(0)
    v_lshl_or_b32 v8, v17, 16, v16
    v_lshl_or_b32 v9, v19, 16, v18
    v_lshl_or_b32 v10, v21, 16, v20
    v_lshl_or_b32 v11, v23, 16, v22
    buffer_store_dwordx4 v[8:11], v2, s[20:23], s41 offen
    s_branch K0_END
    s_nop 11
K0_two:
    s_sub_u32 s19, s18, 5216
    s_mov_b32 s24, s10
    s_and_b32 s25, s11, 0xffff
    s_mov_b32 s26, 0x62000
    s_mov_b32 s27, 0x00020000
    s_lshr_b32 s19, s19, 2
    s_mul_hi_u32 s31, s19, 0x24924925
    s_mul_i32 s32, s31, 7
    s_sub_u32 s32, s19, s32
    s_mul_i32 s30, s31, 25088
    s_lshl_b32 s33, s32, 7
    s_add_u32 s30, s30, s33
    s_lshl_b32 s33, s32, 2
    s_add_u32 s33, s33, s3
    s_lshl_b32 s33, s33, 4
    s_add_u32 s33, s33, s31
    s_lshl_b32 s41, s33, 10
    s_add_u32 s41, s41, 3244032
    v_lshl_add_u32 v13, s3, 4, v3
    v_lshl_or_b32 v5, s3, 6, v0
    v_lshrrev_b32 v6, 3, v5
    v_and_b32 v7, 7, v5
    v_mul_u32_u24 v12, 896, v6
    v_lshl_add_u32 v12, v7, 4, v12
    buffer_load_dwordx4 v[16:19], v12, s[24:27], s30 offen
    v_mul_u32_u24 v12, 144, v6
    v_lshl_add_u32 v12, v7, 4, v12
    s_waitcnt vmcnt(0)
    ds_write_b128 v12, v[16:19]
    v_mul_u32_u24 v14, 576, v4
    v_lshl_add_u32 v14, v13, 1, v14
    s_waitcnt lgkmcnt(0)
    s_barrier
    ds_read_u16 v16, v14 offset:0
    ds_read_u16 v17, v14 offset:144
    ds_read_u16 v18, v14 offset:288
    ds_read_u16 v19, v14 offset:432
    ds_read_u16 v20, v14 offset:2304
    ds_read_u16 v21, v14 offset:2448
    ds_read_u16 v22, v14 offset:2592
    ds_read_u16 v23, v14 offset:2736
    s_waitcnt lgkmcnt(0)
    v_cmp_gt_u32 vcc, 3, v4
    s_nop 1
    v_cndmask_b32 v20, 0, v20, vcc
    v_cndmask_b32 v21, 0, v21, vcc
    v_cndmask_b32 v22, 0, v22, vcc
    v_cndmask_b32 v23, 0, v23, vcc
    v_lshl_or_b32 v8, v17, 16, v16
    v_lshl_or_b32 v9, v19, 16, v18
    v_lshl_or_b32 v10, v21, 16, v20
    v_lshl_or_b32 v11, v23, 16, v22
    buffer_store_dwordx4 v[8:11], v2, s[20:23], s41 offen
    s_branch K0_END
    s_nop 11
K0_twq:
    s_sub_u32 s19, s18, 5664
    s_mov_b32 s24, s6
    s_and_b32 s25, s7, 0xffff
    s_mov_b32 s26, 0x126000
    s_mov_b32 s27, 0x00020000
    s_lshr_b32 s19, s19, 2
    s_mul_hi_u32 s31, s19, 0x6186187
    s_mul_i32 s32, s31, 42
    s_sub_u32 s32, s19, s32
    s_mul_hi_u32 s33, s32, 0x55555556
    s_mul_i32 s34, s33, 3
    s_sub_u32 s34, s32, s34
    s_mul_i32 s35, s34, 448
    s_mul_i32 s36, s31, 28
    s_add_u32 s35, s35, s36
    s_and_b32 s36, s35, 7
    s_sub_u32 s35, s35, s36
    s_mul_i32 s30, s33, 86016
    s_lshl_b32 s35, s35, 1
    s_add_u32 s30, s30, s35
    s_mul_i32 s37, s31, 14
    s_add_u32 s37, s37, s33
    s_mul_i32 s37, s37, 6
    s_lshl_b32 s38, s34, 1
    s_add_u32 s37, s37, s38
    s_add_u32 s37, s37, s3
    s_lshl_b32 s41, s37, 10
    s_add_u32 s41, s41, 1835008
    v_lshl_add_u32 v15, s3, 4, v3
    v_cmp_gt_u32 s[34:35], 28, v15
    v_add_u32 v13, s36, v15
    v_lshl_or_b32 v5, s3, 6, v0
    v_lshrrev_b32 v6, 3, v5
    v_and_b32 v7, 7, v5
    v_mul_u32_u24 v12, 2688, v6
    v_lshl_add_u32 v12, v7, 4, v12
    buffer_load_dwordx4 v[16:19], v12, s[24:27], s30 offen
    v_mul_u32_u24 v12, 144, v6
    v_lshl_add_u32 v12, v7, 4, v12
    s_waitcnt vmcnt(0)
    ds_write_b128 v12, v[16:19]
    v_mul_u32_u24 v14, 576, v4
    v_lshl_add_u32 v14, v13, 1, v14
    s_waitcnt lgkmcnt(0)
    s_barrier
    ds_read_u16 v16, v14 offset:0
    ds_read_u16 v17, v14 offset:144
    ds_read_u16 v18, v14 offset:288
    ds_read_u16 v19, v14 offset:432
    ds_read_u16 v20, v14 offset:2304
    ds_read_u16 v21, v14 offset:2448
    ds_read_u16 v22, v14 offset:2592
    ds_read_u16 v23, v14 offset:2736
    s_waitcnt lgkmcnt(0)
    v_lshl_or_b32 v8, v17, 16, v16
    v_lshl_or_b32 v9, v19, 16, v18
    v_lshl_or_b32 v10, v21, 16, v20
    v_lshl_or_b32 v11, v23, 16, v22
    v_cndmask_b32 v8, 0, v8, s[34:35]
    v_cndmask_b32 v9, 0, v9, s[34:35]
    v_cndmask_b32 v10, 0, v10, s[34:35]
    v_cndmask_b32 v11, 0, v11, s[34:35]
    s_cmp_ge_u32 s3, 2
    s_cbranch_scc1 K0_END
    buffer_store_dwordx4 v[8:11], v2, s[20:23], s41 offen
    s_branch K0_END
    s_nop 11
K0_END:
    s_endpgm
.globl qkv0_kernel
.p2align 8
.type qkv0_kernel,@function
qkv0_kernel:
    s_load_dwordx2 s[4:5], s[0:1], 88
    s_cmp_ge_u32 s2, 256
    s_cbranch_scc1 K1_END_0
    v_lshrrev_b32 v1, 6, v0
    v_and_b32 v0, 63, v0
    v_readfirstlane_b32 s3, v1
    v_lshlrev_b32 v1, 4, v0
    v_and_b32 v2, 15, v0
    v_lshrrev_b32 v3, 4, v0
    s_waitcnt lgkmcnt(0)
    s_mov_b32 s8, s4
    s_and_b32 s9, s5, 0xffff
    s_mov_b32 s10, 0x10000000
    s_mov_b32 s11, 0x00020000
    s_and_b32 s12, s2, 7
    s_lshr_b32 s13, s2, 3
    s_and_b32 s14, s12, 1
    s_lshl_b32 s14, s14, 3
    s_lshr_b32 s15, s13, 2
    s_add_u32 s14, s14, s15
    s_lshr_b32 s15, s12, 1
    s_lshl_b32 s15, s15, 2
    s_and_b32 s16, s13, 3
    s_add_u32 s15, s15, s16
    s_mul_i32 s16, s14, 86016
    s_add_u32 s16, s16, 1835008
    s_lshl_b32 s17, s15, 3
    s_add_u32 s17, s17, s3
    s_mov_b32 s30, s17
    s_mul_i32 s17, s17, 14336
    s_add_u32 s17, s17, 0
    s_lshl_b32 s19, s14, 11
    s_add_u32 s19, s19, 3211264
    buffer_load_dwordx4 v[140:143], v1, s[8:11], s19 offen
    buffer_load_dwordx4 v[144:147], v1, s[8:11], s19 offen offset:1024
    v_mov_b32 v104, 0x3f803f80
    v_mov_b32 v105, 0x3f803f80
    v_mov_b32 v106, 0x3f803f80
    v_mov_b32 v107, 0x3f803f80
    s_add_u32 s19, s3, 0
    s_add_u32 s19, s19, 0
    s_lshl_b32 s19, s19, 10
    s_mov_b32 m0, s19
    s_add_u32 s19, s19, s16
    buffer_load_dwordx4 v1, s[8:11], s19 offen lds
    s_add_u32 s19, s3, 8
    s_add_u32 s19, s19, 0
    s_lshl_b32 s19, s19, 10
    s_mov_b32 m0, s19
    s_add_u32 s19, s19, s16
    buffer_load_dwordx4 v1, s[8:11], s19 offen lds
    s_add_u32 s19, s3, 16
    s_add_u32 s19, s19, 0
    s_lshl_b32 s19, s19, 10
    s_mov_b32 m0, s19
    s_add_u32 s19, s19, s16
    buffer_load_dwordx4 v1, s[8:11], s19 offen lds
    s_add_u32 s19, s17, 0
    buffer_load_dwordx4 v[16:19], v1, s[8:11], s19 offen
    s_add_u32 s19, s17, 1024
    buffer_load_dwordx4 v[20:23], v1, s[8:11], s19 offen
    s_add_u32 s19, s17, 2048
    buffer_load_dwordx4 v[24:27], v1, s[8:11], s19 offen
    s_add_u32 s19, s17, 3072
    buffer_load_dwordx4 v[28:31], v1, s[8:11], s19 offen
    s_add_u32 s19, s3, 0
    s_add_u32 s19, s19, 24
    s_lshl_b32 s19, s19, 10
    s_mov_b32 m0, s19
    s_add_u32 s19, s19, s16
    buffer_load_dwordx4 v1, s[8:11], s19 offen lds
    s_add_u32 s19, s3, 8
    s_add_u32 s19, s19, 24
    s_lshl_b32 s19, s19, 10
    s_mov_b32 m0, s19
    s_add_u32 s19, s19, s16
    buffer_load_dwordx4 v1, s[8:11], s19 offen lds
    s_add_u32 s19, s3, 16
    s_add_u32 s19, s19, 24
    s_lshl_b32 s19, s19, 10
    s_mov_b32 m0, s19
    s_add_u32 s19, s19, s16
    buffer_load_dwordx4 v1, s[8:11], s19 offen lds
    s_add_u32 s19, s17, 4096
    buffer_load_dwordx4 v[32:35], v1, s[8:11], s19 offen
    s_add_u32 s19, s17, 5120
    buffer_load_dwordx4 v[36:39], v1, s[8:11], s19 offen
    s_add_u32 s19, s17, 6144
    buffer_load_dwordx4 v[40:43], v1, s[8:11], s19 offen
    s_add_u32 s19, s17, 7168
    buffer_load_dwordx4 v[44:47], v1, s[8:11], s19 offen
    v_add_u32 v4, 0x10000, v1
    s_min_u32 s19, s3, 5
    s_lshl_b32 s19, s19, 10
    v_add_u32 v5, s19, v1
    v_add_u32 v6, 0x10000, v5
    s_waitcnt vmcnt(7)
    s_barrier
    ds_read_b128 a[0:3], v1 offset:0
    ds_read_b128 a[4:7], v1 offset:1024
    ds_read_b128 a[8:11], v1 offset:2048
    ds_read_b128 a[12:15], v1 offset:3072
    ds_read_b128 a[16:19], v1 offset:4096
    ds_read_b128 a[20:23], v1 offset:5120
    ds_read_b128 a[48:51], v5 offset:0
    ds_read_b128 a[24:27], v1 offset:6144
    ds_read_b128 a[28:31], v1 offset:7168
    ds_read_b128 a[32:35], v1 offset:8192
    ds_read_b128 a[36:39], v1 offset:9216
    ds_read_b128 a[40:43], v1 offset:10240
    ds_read_b128 a[44:47], v1 offset:11264
    ds_read_b128 a[52:55], v5 offset:6144
    s_waitcnt lgkmcnt(7)
    v_mfma_f32_16x16x32_bf16 v[72:75], a[0:3], v[16:19], 0
    v_mfma_f32_16x16x32_bf16 v[76:79], a[4:7], v[16:19], 0
    v_mfma_f32_16x16x32_bf16 v[80:83], a[8:11], v[16:19], 0
    v_mfma_f32_16x16x32_bf16 v[84:87], a[12:15], v[16:19], 0
    v_mfma_f32_16x16x32_bf16 v[88:91], a[16:19], v[16:19], 0
    v_mfma_f32_16x16x32_bf16 v[92:95], a[20:23], v[16:19], 0
    v_mfma_f32_16x16x32_bf16 v[110:113], a[48:51], v[104:107], 0
    v_dot2_f32_bf16 v108, v16, v104, 0
    v_dot2_f32_bf16 v109, v16, v16, 0
    v_dot2_f32_bf16 v108, v17, v104, v108
    v_dot2_f32_bf16 v109, v17, v17, v109
    v_dot2_f32_bf16 v108, v18, v104, v108
    v_dot2_f32_bf16 v109, v18, v18, v109
    v_dot2_f32_bf16 v108, v19, v104, v108
    v_dot2_f32_bf16 v109, v19, v19, v109
    ds_read_b128 a[0:3], v1 offset:12288
    ds_read_b128 a[4:7], v1 offset:13312
    ds_read_b128 a[8:11], v1 offset:14336
    ds_read_b128 a[12:15], v1 offset:15360
    ds_read_b128 a[16:19], v1 offset:16384
    ds_read_b128 a[20:23], v1 offset:17408
    ds_read_b128 a[48:51], v5 offset:12288
    s_waitcnt lgkmcnt(7)
    v_mfma_f32_16x16x32_bf16 v[72:75], a[24:27], v[20:23], v[72:75]
    v_mfma_f32_16x16x32_bf16 v[76:79], a[28:31], v[20:23], v[76:79]
    v_mfma_f32_16x16x32_bf16 v[80:83], a[32:35], v[20:23], v[80:83]
    v_mfma_f32_16x16x32_bf16 v[84:87], a[36:39], v[20:23], v[84:87]
    v_mfma_f32_16x16x32_bf16 v[88:91], a[40:43], v[20:23], v[88:91]
    v_mfma_f32_16x16x32_bf16 v[92:95], a[44:47], v[20:23], v[92:95]
    v_mfma_f32_16x16x32_bf16 v[110:113], a[52:55], v[104:107], v[110:113]
    v_dot2_f32_bf16 v108, v20, v104, v108
    v_dot2_f32_bf16 v109, v20, v20, v109
    v_dot2_f32_bf16 v108, v21, v104, v108
    v_dot2_f32_bf16 v109, v21, v21, v109
    v_dot2_f32_bf16 v108, v22, v104, v108
    v_dot2_f32_bf16 v109, v22, v22, v109
    v_dot2_f32_bf16 v108, v23, v104, v108
    v_dot2_f32_bf16 v109, v23, v23, v109
    ds_read_b128 a[24:27], v1 offset:18432
    ds_read_b128 a[28:31], v1 offset:19456
    ds_read_b128 a[32:35], v1 offset:20480
    ds_read_b128 a[36:39], v1 offset:21504
    ds_read_b128 a[40:43], v1 offset:22528
    ds_read_b128 a[44:47], v1 offset:23552
    ds_read_b128 a[52:55], v5 offset:18432
    s_waitcnt lgkmcnt(7)
    v_mfma_f32_16x16x32_bf16 v[72:75], a[0:3], v[24:27], v[72:75]
    v_mfma_f32_16x16x32_bf16 v[76:79], a[4:7], v[24:27], v[76:79]
    v_mfma_f32_16x16x32_bf16 v[80:83], a[8:11], v[24:27], v[80:83]
    v_mfma_f32_16x16x32_bf16 v[84:87], a[12:15], v[24:27], v[84:87]
    v_mfma_f32_16x16x32_bf16 v[88:91], a[16:19], v[24:27], v[88:91]
    v_mfma_f32_16x16x32_bf16 v[92:95], a[20:23], v[24:27], v[92:95]
    v_mfma_f32_16x16x32_bf16 v[110:113], a[48:51], v[104:107], v[110:113]
    v_dot2_f32_bf16 v108, v24, v104, v108
    v_dot2_f32_bf16 v109, v24, v24, v109
    v_dot2_f32_bf16 v108, v25, v104, v108
    v_dot2_f32_bf16 v109, v25, v25, v109
    v_dot2_f32_bf16 v108, v26, v104, v108
    v_dot2_f32_bf16 v109, v26, v26, v109
    v_dot2_f32_bf16 v108, v27, v104, v108
    v_dot2_f32_bf16 v109, v27, v27, v109
    s_waitcnt vmcnt(0)
    s_barrier
    s_add_u32 s19, s3, 0
    s_add_u32 s19, s19, 48
    s_lshl_b32 s19, s19, 10
    s_mov_b32 m0, s19
    s_add_u32 s19, s19, s16
    buffer_load_dwordx4 v1, s[8:11], s19 offen lds
    s_add_u32 s19, s3, 8
    s_add_u32 s19, s19, 48
    s_lshl_b32 s19, s19, 10
    s_mov_b32 m0, s19
    s_add_u32 s19, s19, s16
    buffer_load_dwordx4 v1, s[8:11], s19 offen lds
    s_add_u32 s19, s3, 16
    s_add_u32 s19, s19, 48
    s_lshl_b32 s19, s19, 10
    s_mov_b32 m0, s19
    s_add_u32 s19, s19, s16
    buffer_load_dwordx4 v1, s[8:11], s19 offen lds
    s_add_u32 s19, s17, 8192
    buffer_load_dwordx4 v[48:51], v1, s[8:11], s19 offen
    s_add_u32 s19, s17, 9216
    buffer_load_dwordx4 v[52:55], v1, s[8:11], s19 offen
    s_add_u32 s19, s17, 10240
    buffer_load_dwordx4 v[56:59], v1, s[8:11], s19 offen
    s_add_u32 s19, s17, 11264
    buffer_load_dwordx4 v[60:63], v1, s[8:11], s19 offen
    ds_read_b128 a[0:3], v1 offset:24576
    ds_read_b128 a[4:7], v1 offset:25600
    ds_read_b128 a[8:11], v1 offset:26624
    ds_read_b128 a[12:15], v1 offset:27648
    ds_read_b128 a[16:19], v1 offset:28672
    ds_read_b128 a[20:23], v1 offset:29696
    ds_read_b128 a[48:51], v5 offset:24576
    s_waitcnt lgkmcnt(7)
    v_mfma_f32_16x16x32_bf16 v[72:75], a[24:27], v[28:31], v[72:75]
    v_mfma_f32_16x16x32_bf16 v[76:79], a[28:31], v[28:31], v[76:79]
    v_mfma_f32_16x16x32_bf16 v[80:83], a[32:35], v[28:31], v[80:83]
    v_mfma_f32_16x16x32_bf16 v[84:87], a[36:39], v[28:31], v[84:87]
    v_mfma_f32_16x16x32_bf16 v[88:91], a[40:43], v[28:31], v[88:91]
    v_mfma_f32_16x16x32_bf16 v[92:95], a[44:47], v[28:31], v[92:95]
    v_mfma_f32_16x16x32_bf16 v[110:113], a[52:55], v[104:107], v[110:113]
    v_dot2_f32_bf16 v108, v28, v104, v108
    v_dot2_f32_bf16 v109, v28, v28, v109
    v_dot2_f32_bf16 v108, v29, v104, v108
    v_dot2_f32_bf16 v109, v29, v29, v109
    v_dot2_f32_bf16 v108, v30, v104, v108
    v_dot2_f32_bf16 v109, v30, v30, v109
    v_dot2_f32_bf16 v108, v31, v104, v108
    v_dot2_f32_bf16 v109, v31, v31, v109
    ds_read_b128 a[24:27], v1 offset:30720
    ds_read_b128 a[28:31], v1 offset:31744
    ds_read_b128 a[32:35], v1 offset:32768
    ds_read_b128 a[36:39], v1 offset:33792
    ds_read_b128 a[40:43], v1 offset:34816
    ds_read_b128 a[44:47], v1 offset:35840
    ds_read_b128 a[52:55], v5 offset:30720
    s_waitcnt lgkmcnt(7)
    v_mfma_f32_16x16x32_bf16 v[72:75], a[0:3], v[32:35], v[72:75]
    v_mfma_f32_16x16x32_bf16 v[76:79], a[4:7], v[32:35], v[76:79]
    v_mfma_f32_16x16x32_bf16 v[80:83], a[8:11], v[32:35], v[80:83]
    v_mfma_f32_16x16x32_bf16 v[84:87], a[12:15], v[32:35], v[84:87]
    v_mfma_f32_16x16x32_bf16 v[88:91], a[16:19], v[32:35], v[88:91]
    v_mfma_f32_16x16x32_bf16 v[92:95], a[20:23], v[32:35], v[92:95]
    v_mfma_f32_16x16x32_bf16 v[110:113], a[48:51], v[104:107], v[110:113]
    v_dot2_f32_bf16 v108, v32, v104, v108
    v_dot2_f32_bf16 v109, v32, v32, v109
    v_dot2_f32_bf16 v108, v33, v104, v108
    v_dot2_f32_bf16 v109, v33, v33, v109
    v_dot2_f32_bf16 v108, v34, v104, v108
    v_dot2_f32_bf16 v109, v34, v34, v109
    v_dot2_f32_bf16 v108, v35, v104, v108
    v_dot2_f32_bf16 v109, v35, v35, v109
    ds_read_b128 a[0:3], v1 offset:36864
    ds_read_b128 a[4:7], v1 offset:37888
    ds_read_b128 a[8:11], v1 offset:38912
    ds_read_b128 a[12:15], v1 offset:39936
    ds_read_b128 a[16:19], v1 offset:40960
    ds_read_b128 a[20:23], v1 offset:41984
    ds_read_b128 a[48:51], v5 offset:36864
    s_waitcnt lgkmcnt(7)
    v_mfma_f32_16x16x32_bf16 v[72:75], a[24:27], v[36:39], v[72:75]
    v_mfma_f32_16x16x32_bf16 v[76:79], a[28:31], v[36:39], v[76:79]
    v_mfma_f32_16x16x32_bf16 v[80:83], a[32:35], v[36:39], v[80:83]
    v_mfma_f32_16x16x32_bf16 v[84:87], a[36:39], v[36:39], v[84:87]
    v_mfma_f32_16x16x32_bf16 v[88:91], a[40:43], v[36:39], v[88:91]
    v_mfma_f32_16x16x32_bf16 v[92:95], a[44:47], v[36:39], v[92:95]
    v_mfma_f32_16x16x32_bf16 v[110:113], a[52:55], v[104:107], v[110:113]
    v_dot2_f32_bf16 v108, v36, v104, v108
    v_dot2_f32_bf16 v109, v36, v36, v109
    v_dot2_f32_bf16 v108, v37, v104, v108
    v_dot2_f32_bf16 v109, v37, v37, v109
    v_dot2_f32_bf16 v108, v38, v104, v108
    v_dot2_f32_bf16 v109, v38, v38, v109
    v_dot2_f32_bf16 v108, v39, v104, v108
    v_dot2_f32_bf16 v109, v39, v39, v109
    ds_read_b128 a[24:27], v1 offset:43008
    ds_read_b128 a[28:31], v1 offset:44032
    ds_read_b128 a[32:35], v1 offset:45056
    ds_read_b128 a[36:39], v1 offset:46080
    ds_read_b128 a[40:43], v1 offset:47104
    ds_read_b128 a[44:47], v1 offset:48128
    ds_read_b128 a[52:55], v5 offset:43008
    s_waitcnt lgkmcnt(7)
    v_mfma_f32_16x16x32_bf16 v[72:75], a[0:3], v[40:43], v[72:75]
    v_mfma_f32_16x16x32_bf16 v[76:79], a[4:7], v[40:43], v[76:79]
    v_mfma_f32_16x16x32_bf16 v[80:83], a[8:11], v[40:43], v[80:83]
    v_mfma_f32_16x16x32_bf16 v[84:87], a[12:15], v[40:43], v[84:87]
    v_mfma_f32_16x16x32_bf16 v[88:91], a[16:19], v[40:43], v[88:91]
    v_mfma_f32_16x16x32_bf16 v[92:95], a[20:23], v[40:43], v[92:95]
    v_mfma_f32_16x16x32_bf16 v[110:113], a[48:51], v[104:107], v[110:113]
    v_dot2_f32_bf16 v108, v40, v104, v108
    v_dot2_f32_bf16 v109, v40, v40, v109
    v_dot2_f32_bf16 v108, v41, v104, v108
    v_dot2_f32_bf16 v109, v41, v41, v109
    v_dot2_f32_bf16 v108, v42, v104, v108
    v_dot2_f32_bf16 v109, v42, v42, v109
    v_dot2_f32_bf16 v108, v43, v104, v108
    v_dot2_f32_bf16 v109, v43, v43, v109
    s_waitcnt vmcnt(0)
    s_barrier
    s_add_u32 s19, s3, 0
    s_add_u32 s19, s19, 72
    s_lshl_b32 s19, s19, 10
    s_mov_b32 m0, s19
    s_add_u32 s19, s19, s16
    buffer_load_dwordx4 v1, s[8:11], s19 offen lds
    s_add_u32 s19, s3, 8
    s_min_u32 s19, s19, 11
    s_add_u32 s19, s19, 72
    s_lshl_b32 s19, s19, 10
    s_mov_b32 m0, s19
    s_add_u32 s19, s19, s16
    buffer_load_dwordx4 v1, s[8:11], s19 offen lds
    s_add_u32 s19, s17, 12288
    buffer_load_dwordx4 v[64:67], v1, s[8:11], s19 offen
    s_add_u32 s19, s17, 13312
    buffer_load_dwordx4 v[68:71], v1, s[8:11], s19 offen
    ds_read_b128 a[0:3], v1 offset:49152
    ds_read_b128 a[4:7], v1 offset:50176
    ds_read_b128 a[8:11], v1 offset:51200
    ds_read_b128 a[12:15], v1 offset:52224
    ds_read_b128 a[16:19], v1 offset:53248
    ds_read_b128 a[20:23], v1 offset:54272
    ds_read_b128 a[48:51], v5 offset:49152
    s_waitcnt lgkmcnt(7)
    v_mfma_f32_16x16x32_bf16 v[72:75], a[24:27], v[44:47], v[72:75]
    v_mfma_f32_16x16x32_bf16 v[76:79], a[28:31], v[44:47], v[76:79]
    v_mfma_f32_16x16x32_bf16 v[80:83], a[32:35], v[44:47], v[80:83]
    v_mfma_f32_16x16x32_bf16 v[84:87], a[36:39], v[44:47], v[84:87]
    v_mfma_f32_16x16x32_bf16 v[88:91], a[40:43], v[44:47], v[88:91]
    v_mfma_f32_16x16x32_bf16 v[92:95], a[44:47], v[44:47], v[92:95]
    v_mfma_f32_16x16x32_bf16 v[110:113], a[52:55], v[104:107], v[110:113]
    v_dot2_f32_bf16 v108, v44, v104, v108
    v_dot2_f32_bf16 v109, v44, v44, v109
    v_dot2_f32_bf16 v108, v45, v104, v108
    v_dot2_f32_bf16 v109, v45, v45, v109
    v_dot2_f32_bf16 v108, v46, v104, v108
    v_dot2_f32_bf16 v109, v46, v46, v109
    v_dot2_f32_bf16 v108, v47, v104, v108
    v_dot2_f32_bf16 v109, v47, v47, v109
    ds_read_b128 a[24:27], v1 offset:55296
    ds_read_b128 a[28:31], v1 offset:56320
    ds_read_b128 a[32:35], v1 offset:57344
    ds_read_b128 a[36:39], v1 offset:58368
    ds_read_b128 a[40:43], v1 offset:59392
    ds_read_b128 a[44:47], v1 offset:60416
    ds_read_b128 a[52:55], v5 offset:55296
    s_waitcnt lgkmcnt(7)
    v_mfma_f32_16x16x32_bf16 v[72:75], a[0:3], v[48:51], v[72:75]
    v_mfma_f32_16x16x32_bf16 v[76:79], a[4:7], v[48:51], v[76:79]
    v_mfma_f32_16x16x32_bf16 v[80:83], a[8:11], v[48:51], v[80:83]
    v_mfma_f32_16x16x32_bf16 v[84:87], a[12:15], v[48:51], v[84:87]
    v_mfma_f32_16x16x32_bf16 v[88:91], a[16:19], v[48:51], v[88:91]
    v_mfma_f32_16x16x32_bf16 v[92:95], a[20:23], v[48:51], v[92:95]
    v_mfma_f32_16x16x32_bf16 v[110:113], a[48:51], v[104:107], v[110:113]
    v_dot2_f32_bf16 v108, v48, v104, v108
    v_dot2_f32_bf16 v109, v48, v48, v109
    v_dot2_f32_bf16 v108, v49, v104, v108
    v_dot2_f32_bf16 v109, v49, v49, v109
    v_dot2_f32_bf16 v108, v50, v104, v108
    v_dot2_f32_bf16 v109, v50, v50, v109
    v_dot2_f32_bf16 v108, v51, v104, v108
    v_dot2_f32_bf16 v109, v51, v51, v109
    ds_read_b128 a[0:3], v1 offset:61440
    ds_read_b128 a[4:7], v1 offset:62464
    ds_read_b128 a[8:11], v1 offset:63488
    ds_read_b128 a[12:15], v1 offset:64512
    ds_read_b128 a[16:19], v4 offset:0
    ds_read_b128 a[20:23], v4 offset:1024
    ds_read_b128 a[48:51], v5 offset:61440
    s_waitcnt lgkmcnt(7)
    v_mfma_f32_16x16x32_bf16 v[72:75], a[24:27], v[52:55], v[72:75]
    v_mfma_f32_16x16x32_bf16 v[76:79], a[28:31], v[52:55], v[76:79]
    v_mfma_f32_16x16x32_bf16 v[80:83], a[32:35], v[52:55], v[80:83]
    v_mfma_f32_16x16x32_bf16 v[84:87], a[36:39], v[52:55], v[84:87]
    v_mfma_f32_16x16x32_bf16 v[88:91], a[40:43], v[52:55], v[88:91]
    v_mfma_f32_16x16x32_bf16 v[92:95], a[44:47], v[52:55], v[92:95]
    v_mfma_f32_16x16x32_bf16 v[110:113], a[52:55], v[104:107], v[110:113]
    v_dot2_f32_bf16 v108, v52, v104, v108
    v_dot2_f32_bf16 v109, v52, v52, v109
    v_dot2_f32_bf16 v108, v53, v104, v108
    v_dot2_f32_bf16 v109, v53, v53, v109
    v_dot2_f32_bf16 v108, v54, v104, v108
    v_dot2_f32_bf16 v109, v54, v54, v109
    v_dot2_f32_bf16 v108, v55, v104, v108
    v_dot2_f32_bf16 v109, v55, v55, v109
    ds_read_b128 a[24:27], v4 offset:2048
    ds_read_b128 a[28:31], v4 offset:3072
    ds_read_b128 a[32:35], v4 offset:4096
    ds_read_b128 a[36:39], v4 offset:5120
    ds_read_b128 a[40:43], v4 offset:6144
    ds_read_b128 a[44:47], v4 offset:7168
    ds_read_b128 a[52:55], v6 offset:2048
    s_waitcnt lgkmcnt(7)
    v_mfma_f32_16x16x32_bf16 v[72:75], a[0:3], v[56:59], v[72:75]
    v_mfma_f32_16x16x32_bf16 v[76:79], a[4:7], v[56:59], v[76:79]
    v_mfma_f32_16x16x32_bf16 v[80:83], a[8:11], v[56:59], v[80:83]
    v_mfma_f32_16x16x32_bf16 v[84:87], a[12:15], v[56:59], v[84:87]
    v_mfma_f32_16x16x32_bf16 v[88:91], a[16:19], v[56:59], v[88:91]
    v_mfma_f32_16x16x32_bf16 v[92:95], a[20:23], v[56:59], v[92:95]
    v_mfma_f32_16x16x32_bf16 v[110:113], a[48:51], v[104:107], v[110:113]
    v_dot2_f32_bf16 v108, v56, v104, v108
    v_dot2_f32_bf16 v109, v56, v56, v109
    v_dot2_f32_bf16 v108, v57, v104, v108
    v_dot2_f32_bf16 v109, v57, v57, v109
    v_dot2_f32_bf16 v108, v58, v104, v108
    v_dot2_f32_bf16 v109, v58, v58, v109
    v_dot2_f32_bf16 v108, v59, v104, v108
    v_dot2_f32_bf16 v109, v59, v59, v109
    s_waitcnt vmcnt(0)
    s_barrier
    ds_read_b128 a[0:3], v4 offset:8192
    ds_read_b128 a[4:7], v4 offset:9216
    ds_read_b128 a[8:11], v4 offset:10240
    ds_read_b128 a[12:15], v4 offset:11264
    ds_read_b128 a[16:19], v4 offset:12288
    ds_read_b128 a[20:23], v4 offset:13312
    ds_read_b128 a[48:51], v6 offset:8192
    s_waitcnt lgkmcnt(7)
    v_mfma_f32_16x16x32_bf16 v[72:75], a[24:27], v[60:63], v[72:75]
    v_mfma_f32_16x16x32_bf16 v[76:79], a[28:31], v[60:63], v[76:79]
    v_mfma_f32_16x16x32_bf16 v[80:83], a[32:35], v[60:63], v[80:83]
    v_mfma_f32_16x16x32_bf16 v[84:87], a[36:39], v[60:63], v[84:87]
    v_mfma_f32_16x16x32_bf16 v[88:91], a[40:43], v[60:63], v[88:91]
    v_mfma_f32_16x16x32_bf16 v[92:95], a[44:47], v[60:63], v[92:95]
    v_mfma_f32_16x16x32_bf16 v[110:113], a[52:55], v[104:107], v[110:113]
    v_dot2_f32_bf16 v108, v60, v104, v108
    v_dot2_f32_bf16 v109, v60, v60, v109
    v_dot2_f32_bf16 v108, v61, v104, v108
    v_dot2_f32_bf16 v109, v61, v61, v109
    v_dot2_f32_bf16 v108, v62, v104, v108
    v_dot2_f32_bf16 v109, v62, v62, v109
    v_dot2_f32_bf16 v108, v63, v104, v108
    v_dot2_f32_bf16 v109, v63, v63, v109
    ds_read_b128 a[24:27], v4 offset:14336
    ds_read_b128 a[28:31], v4 offset:15360
    ds_read_b128 a[32:35], v4 offset:16384
    ds_read_b128 a[36:39], v4 offset:17408
    ds_read_b128 a[40:43], v4 offset:18432
    ds_read_b128 a[44:47], v4 offset:19456
    ds_read_b128 a[52:55], v6 offset:14336
    s_waitcnt lgkmcnt(7)
    v_mfma_f32_16x16x32_bf16 v[72:75], a[0:3], v[64:67], v[72:75]
    v_mfma_f32_16x16x32_bf16 v[76:79], a[4:7], v[64:67], v[76:79]
    v_mfma_f32_16x16x32_bf16 v[80:83], a[8:11], v[64:67], v[80:83]
    v_mfma_f32_16x16x32_bf16 v[84:87], a[12:15], v[64:67], v[84:87]
    v_mfma_f32_16x16x32_bf16 v[88:91], a[16:19], v[64:67], v[88:91]
    v_mfma_f32_16x16x32_bf16 v[92:95], a[20:23], v[64:67], v[92:95]
    v_mfma_f32_16x16x32_bf16 v[110:113], a[48:51], v[104:107], v[110:113]
    v_dot2_f32_bf16 v108, v64, v104, v108
    v_dot2_f32_bf16 v109, v64, v64, v109
    v_dot2_f32_bf16 v108, v65, v104, v108
    v_dot2_f32_bf16 v109, v65, v65, v109
    v_dot2_f32_bf16 v108, v66, v104, v108
    v_dot2_f32_bf16 v109, v66, v66, v109
    v_dot2_f32_bf16 v108, v67, v104, v108
    v_dot2_f32_bf16 v109, v67, v67, v109
    s_waitcnt lgkmcnt(0)
    v_mfma_f32_16x16x32_bf16 v[72:75], a[24:27], v[68:71], v[72:75]
    v_mfma_f32_16x16x32_bf16 v[76:79], a[28:31], v[68:71], v[76:79]
    v_mfma_f32_16x16x32_bf16 v[80:83], a[32:35], v[68:71], v[80:83]
    v_mfma_f32_16x16x32_bf16 v[84:87], a[36:39], v[68:71], v[84:87]
    v_mfma_f32_16x16x32_bf16 v[88:91], a[40:43], v[68:71], v[88:91]
    v_mfma_f32_16x16x32_bf16 v[92:95], a[44:47], v[68:71], v[92:95]
    v_mfma_f32_16x16x32_bf16 v[110:113], a[52:55], v[104:107], v[110:113]
    v_dot2_f32_bf16 v108, v68, v104, v108
    v_dot2_f32_bf16 v109, v68, v68, v109
    v_dot2_f32_bf16 v108, v69, v104, v108
    v_dot2_f32_bf16 v109, v69, v69, v109
    v_dot2_f32_bf16 v108, v70, v104, v108
    v_dot2_f32_bf16 v109, v70, v70, v109
    v_dot2_f32_bf16 v108, v71, v104, v108
    v_dot2_f32_bf16 v109, v71, v71, v109
    s_min_u32 s19, s3, 5
    s_lshl_b32 s19, s19, 10
    v_add_u32 v5, s19, v1
    ds_write_b128 v6, v[110:113] offset:20480
    v_mov_b32 v7, v108
    s_nop 1
    v_permlane16_swap_b32 v108, v7
    v_add_f32 v108, v108, v7
    v_mov_b32 v7, v108
    s_nop 1
    v_permlane32_swap_b32 v108, v7
    v_add_f32 v108, v108, v7
    v_mov_b32 v7, v109
    s_nop 1
    v_permlane16_swap_b32 v109, v7
    v_add_f32 v109, v109, v7
    v_mov_b32 v7, v109
    s_nop 1
    v_permlane32_swap_b32 v109, v7
    v_add_f32 v109, v109, v7
    s_waitcnt lgkmcnt(0)
    s_barrier
    ds_read_b128 v[114:117], v4 offset:20480
    ds_read_b128 v[118:121], v4 offset:21504
    ds_read_b128 v[122:125], v4 offset:22528
    ds_read_b128 v[126:129], v4 offset:23552
    ds_read_b128 v[130:133], v4 offset:24576
    ds_read_b128 v[134:137], v4 offset:25600
    v_mul_f32 v10, 0x3b124925, v108
    v_mul_f32 v11, 0x3b124925, v109
    v_fma_f32 v11, -v10, v10, v11
    v_max_f32 v11, 0, v11
    v_cvt_pk_bf16_f32 v10, v10, v10
    v_lshlrev_b32 v8, 16, v10
    v_cvt_pk_bf16_f32 v10, v11, v11
    v_lshlrev_b32 v11, 16, v10
    v_add_f32 v11, 0x3727c5ac, v11
    v_cvt_pk_bf16_f32 v10, v11, v11
    v_lshlrev_b32 v11, 16, v10
    v_sqrt_f32 v11, v11
    s_nop 0
    v_cvt_pk_bf16_f32 v10, v11, v11
    v_lshlrev_b32 v11, 16, v10
    v_rcp_f32 v9, v11
    v_sub_f32 v8, 0, v8
    v_cmp_le_u32 s[32:33], 48, v0
    v_mov_b32 v12, 0xff800000
    v_mov_b32 v13, 0x7f800000
    v_mov_b32 v14, 1.0
    v_mov_b32 v15, 0x3fb8aa3b
    v_mul_u32_u24 v148, 1088, v3
    s_lshl_b32 s19, s3, 5
    v_lshl_add_u32 v148, v2, 1, v148
    v_add_u32 v148, s19, v148
    v_add_u32 v148, 94208, v148
    s_waitcnt lgkmcnt(0)
    v_fma_f32 v72, v8, v114, v72
    v_mul_f32 v72, v72, v9
    v_fma_f32 v73, v8, v115, v73
    v_mul_f32 v73, v73, v9
    v_fma_f32 v74, v8, v116, v74
    v_mul_f32 v74, v74, v9
    v_fma_f32 v75, v8, v117, v75
    v_mul_f32 v75, v75, v9
    v_fma_f32 v76, v8, v118, v76
    v_mul_f32 v76, v76, v9
    v_fma_f32 v77, v8, v119, v77
    v_mul_f32 v77, v77, v9
    v_fma_f32 v78, v8, v120, v78
    v_mul_f32 v78, v78, v9
    v_fma_f32 v79, v8, v121, v79
    v_mul_f32 v79, v79, v9
    v_fma_f32 v80, v8, v122, v80
    v_mul_f32 v80, v80, v9
    v_fma_f32 v81, v8, v123, v81
    v_mul_f32 v81, v81, v9
    v_fma_f32 v82, v8, v124, v82
    v_mul_f32 v82, v82, v9
    v_fma_f32 v83, v8, v125, v83
    v_mul_f32 v83, v83, v9
    v_fma_f32 v84, v8, v126, v84
    v_mul_f32 v84, v84, v9
    v_fma_f32 v85, v8, v127, v85
    v_mul_f32 v85, v85, v9
    v_fma_f32 v86, v8, v128, v86
    v_mul_f32 v86, v86, v9
    v_fma_f32 v87, v8, v129, v87
    v_mul_f32 v87, v87, v9
    v_fma_f32 v88, v8, v130, v88
    v_mul_f32 v88, v88, v9
    v_fma_f32 v89, v8, v131, v89
    v_mul_f32 v89, v89, v9
    v_fma_f32 v90, v8, v132, v90
    v_mul_f32 v90, v90, v9
    v_fma_f32 v91, v8, v133, v91
    v_mul_f32 v91, v91, v9
    v_fma_f32 v92, v8, v134, v92
    v_mul_f32 v92, v92, v9
    v_fma_f32 v93, v8, v135, v93
    v_mul_f32 v93, v93, v9
    v_fma_f32 v94, v8, v136, v94
    v_mul_f32 v94, v94, v9
    v_fma_f32 v95, v8, v137, v95
    v_mul_f32 v95, v95, v9
    v_cndmask_b32 v92, v92, v14, s[32:33]
    v_cvt_pk_bf16_f32 v16, v72, v73
    v_cvt_pk_bf16_f32 v17, v74, v75
    v_cvt_pk_bf16_f32 v18, v76, v77
    v_cvt_pk_bf16_f32 v19, v78, v79
    v_cvt_pk_bf16_f32 v20, v80, v81
    v_cvt_pk_bf16_f32 v21, v82, v83
    v_cvt_pk_bf16_f32 v22, v84, v85
    v_cvt_pk_bf16_f32 v23, v86, v87
    v_cvt_pk_bf16_f32 v24, v88, v89
    v_cvt_pk_bf16_f32 v25, v90, v91
    v_cvt_pk_bf16_f32 v26, v92, v93
    v_cvt_pk_bf16_f32 v27, v94, v95
    v_mfma_f32_16x16x32_bf16 v[36:39], v[140:143], v[16:19], 0
    v_mfma_f32_16x16x32_bf16 v[40:43], v[144:147], v[16:19], 0
    s_nop 6
    v_cvt_pk_bf16_f32 v150, v36, v37
    v_lshlrev_b32 v28, 16, v150
    v_and_b32 v29, 0xffff0000, v150
    v_cvt_pk_bf16_f32 v150, v38, v39
    v_lshlrev_b32 v30, 16, v150
    v_and_b32 v31, 0xffff0000, v150
    v_cvt_pk_bf16_f32 v150, v40, v41
    v_lshlrev_b32 v32, 16, v150
    v_and_b32 v33, 0xffff0000, v150
    v_cvt_pk_bf16_f32 v150, v42, v43
    v_lshlrev_b32 v34, 16, v150
    v_and_b32 v35, 0xffff0000, v150
    v_cndmask_b32 v150, v32, v12, s[32:33]
    v_cndmask_b32 v154, v32, v13, s[32:33]
    v_cndmask_b32 v151, v33, v12, s[32:33]
    v_cndmask_b32 v155, v33, v13, s[32:33]
    v_cndmask_b32 v152, v34, v12, s[32:33]
    v_cndmask_b32 v156, v34, v13, s[32:33]
    v_cndmask_b32 v153, v35, v12, s[32:33]
    v_cndmask_b32 v157, v35, v13, s[32:33]
    v_max3_f32 v158, v28, v29, v30
    v_min3_f32 v159, v28, v29, v30
    v_max3_f32 v158, v158, v31, v150
    v_min3_f32 v159, v159, v31, v154
    v_max3_f32 v158, v158, v151, v152
    v_min3_f32 v159, v159, v155, v156
    v_max_f32 v158, v158, v153
    v_min_f32 v159, v159, v157
    v_mov_b32 v160, v158
    s_nop 1
    v_permlane16_swap_b32 v158, v160
    v_max_f32 v158, v158, v160
    v_mov_b32 v160, v158
    s_nop 1
    v_permlane32_swap_b32 v158, v160
    v_max_f32 v158, v158, v160
    v_mov_b32 v160, v159
    s_nop 1
    v_permlane16_swap_b32 v159, v160
    v_min_f32 v159, v159, v160
    v_mov_b32 v160, v159
    s_nop 1
    v_permlane32_swap_b32 v159, v160
    v_min_f32 v159, v159, v160
    v_mul_f32 v158, v15, v158
    v_mul_f32 v159, v15, v159
    v_fma_f32 v162, v28, v15, -v158
    v_fma_f32 v170, -v28, v15, v159
    v_fma_f32 v163, v29, v15, -v158
    v_fma_f32 v171, -v29, v15, v159
    v_fma_f32 v164, v30, v15, -v158
    v_fma_f32 v172, -v30, v15, v159
    v_fma_f32 v165, v31, v15, -v158
    v_fma_f32 v173, -v31, v15, v159
    v_fma_f32 v166, v150, v15, -v158
    v_fma_f32 v174, -v154, v15, v159
    v_fma_f32 v167, v151, v15, -v158
    v_fma_f32 v175, -v155, v15, v159
    v_fma_f32 v168, v152, v15, -v158
    v_fma_f32 v176, -v156, v15, v159
    v_fma_f32 v169, v153, v15, -v158
    v_fma_f32 v177, -v157, v15, v159
    v_exp_f32 v162, v162
    v_exp_f32 v170, v170
    v_exp_f32 v163, v163
    v_exp_f32 v171, v171
    v_exp_f32 v164, v164
    v_exp_f32 v172, v172
    v_exp_f32 v165, v165
    v_exp_f32 v173, v173
    v_exp_f32 v166, v166
    v_exp_f32 v174, v174
    v_exp_f32 v167, v167
    v_exp_f32 v175, v175
    v_exp_f32 v168, v168
    v_exp_f32 v176, v176
    v_exp_f32 v169, v169
    v_exp_f32 v177, v177
    v_add_f32 v158, v162, v163
    v_add_f32 v159, v170, v171
    v_add_f32 v158, v158, v164
    v_add_f32 v159, v159, v172
    v_add_f32 v158, v158, v165
    v_add_f32 v159, v159, v173
    v_add_f32 v158, v158, v166
    v_add_f32 v159, v159, v174
    v_add_f32 v158, v158, v167
    v_add_f32 v159, v159, v175
    v_add_f32 v158, v158, v168
    v_add_f32 v159, v159, v176
    v_add_f32 v158, v158, v169
    v_add_f32 v159, v159, v177
    v_mov_b32 v160, v158
    s_nop 1
    v_permlane16_swap_b32 v158, v160
    v_add_f32 v158, v158, v160
    v_mov_b32 v160, v158
    s_nop 1
    v_permlane32_swap_b32 v158, v160
    v_add_f32 v158, v158, v160
    v_mov_b32 v160, v159
    s_nop 1
    v_permlane16_swap_b32 v159, v160
    v_add_f32 v159, v159, v160
    v_mov_b32 v160, v159
    s_nop 1
    v_permlane32_swap_b32 v159, v160
    v_add_f32 v159, v159, v160
    v_rcp_f32 v158, v158
    v_rcp_f32 v159, v159
    v_mul_f32 v162, v162, v158
    v_mul_f32 v170, v170, v159
    v_mul_f32 v163, v163, v158
    v_mul_f32 v171, v171, v159
    v_mul_f32 v164, v164, v158
    v_mul_f32 v172, v172, v159
    v_mul_f32 v165, v165, v158
    v_mul_f32 v173, v173, v159
    v_mul_f32 v166, v166, v158
    v_mul_f32 v174, v174, v159
    v_mul_f32 v167, v167, v158
    v_mul_f32 v175, v175, v159
    v_mul_f32 v168, v168, v158
    v_mul_f32 v176, v176, v159
    v_mul_f32 v169, v169, v158
    v_mul_f32 v177, v177, v159
    v_cvt_pk_bf16_f32 v44, v162, v163
    v_cvt_pk_bf16_f32 v48, v170, v171
    v_cvt_pk_bf16_f32 v45, v164, v165
    v_cvt_pk_bf16_f32 v49, v172, v173
    v_cvt_pk_bf16_f32 v46, v166, v167
    v_cvt_pk_bf16_f32 v50, v174, v175
    v_cvt_pk_bf16_f32 v47, v168, v169
    v_cvt_pk_bf16_f32 v51, v176, v177
    s_lshl_b32 s19, s30, 4
    s_add_u32 s19, s19, s14
    s_lshl_b32 s19, s19, 11
    s_add_u32 s19, s19, 7176192
    buffer_store_dwordx4 v[44:47], v1, s[8:11], s19 offen
    buffer_store_dwordx4 v[48:51], v1, s[8:11], s19 offen offset:1024
    v_mfma_f32_16x16x32_bf16 v[36:39], v[140:143], v[20:23], 0
    v_mfma_f32_16x16x32_bf16 v[40:43], v[144:147], v[20:23], 0
    s_nop 6
    v_cvt_pk_bf16_f32 v150, v36, v37
    v_lshlrev_b32 v28, 16, v150
    v_and_b32 v29, 0xffff0000, v150
    v_cvt_pk_bf16_f32 v150, v38, v39
    v_lshlrev_b32 v30, 16, v150
    v_and_b32 v31, 0xffff0000, v150
    v_cvt_pk_bf16_f32 v150, v40, v41
    v_lshlrev_b32 v32, 16, v150
    v_and_b32 v33, 0xffff0000, v150
    v_cvt_pk_bf16_f32 v150, v42, v43
    v_lshlrev_b32 v34, 16, v150
    v_and_b32 v35, 0xffff0000, v150
    v_cndmask_b32 v150, v32, v12, s[32:33]
    v_cndmask_b32 v154, v32, v13, s[32:33]
    v_cndmask_b32 v151, v33, v12, s[32:33]
    v_cndmask_b32 v155, v33, v13, s[32:33]
    v_cndmask_b32 v152, v34, v12, s[32:33]
    v_cndmask_b32 v156, v34, v13, s[32:33]
    v_cndmask_b32 v153, v35, v12, s[32:33]
    v_cndmask_b32 v157, v35, v13, s[32:33]
    v_max3_f32 v158, v28, v29, v30
    v_min3_f32 v159, v28, v29, v30
    v_max3_f32 v158, v158, v31, v150
    v_min3_f32 v159, v159, v31, v154
    v_max3_f32 v158, v158, v151, v152
    v_min3_f32 v159, v159, v155, v156
    v_max_f32 v158, v158, v153
    v_min_f32 v159, v159, v157
    v_mov_b32 v160, v158
    s_nop 1
    v_permlane16_swap_b32 v158, v160
    v_max_f32 v158, v158, v160
    v_mov_b32 v160, v158
    s_nop 1
    v_permlane32_swap_b32 v158, v160
    v_max_f32 v158, v158, v160
    v_mov_b32 v160, v159
    s_nop 1
    v_permlane16_swap_b32 v159, v160
    v_min_f32 v159, v159, v160
    v_mov_b32 v160, v159
    s_nop 1
    v_permlane32_swap_b32 v159, v160
    v_min_f32 v159, v159, v160
    v_mul_f32 v158, v15, v158
    v_mul_f32 v159, v15, v159
    v_fma_f32 v162, v28, v15, -v158
    v_fma_f32 v170, -v28, v15, v159
    v_fma_f32 v163, v29, v15, -v158
    v_fma_f32 v171, -v29, v15, v159
    v_fma_f32 v164, v30, v15, -v158
    v_fma_f32 v172, -v30, v15, v159
    v_fma_f32 v165, v31, v15, -v158
    v_fma_f32 v173, -v31, v15, v159
    v_fma_f32 v166, v150, v15, -v158
    v_fma_f32 v174, -v154, v15, v159
    v_fma_f32 v167, v151, v15, -v158
    v_fma_f32 v175, -v155, v15, v159
    v_fma_f32 v168, v152, v15, -v158
    v_fma_f32 v176, -v156, v15, v159
    v_fma_f32 v169, v153, v15, -v158
    v_fma_f32 v177, -v157, v15, v159
    v_exp_f32 v162, v162
    v_exp_f32 v170, v170
    v_exp_f32 v163, v163
    v_exp_f32 v171, v171
    v_exp_f32 v164, v164
    v_exp_f32 v172, v172
    v_exp_f32 v165, v165
    v_exp_f32 v173, v173
    v_exp_f32 v166, v166
    v_exp_f32 v174, v174
    v_exp_f32 v167, v167
    v_exp_f32 v175, v175
    v_exp_f32 v168, v168
    v_exp_f32 v176, v176
    v_exp_f32 v169, v169
    v_exp_f32 v177, v177
    v_add_f32 v158, v162, v163
    v_add_f32 v159, v170, v171
    v_add_f32 v158, v158, v164
    v_add_f32 v159, v159, v172
    v_add_f32 v158, v158, v165
    v_add_f32 v159, v159, v173
    v_add_f32 v158, v158, v166
    v_add_f32 v159, v159, v174
    v_add_f32 v158, v158, v167
    v_add_f32 v159, v159, v175
    v_add_f32 v158, v158, v168
    v_add_f32 v159, v159, v176
    v_add_f32 v158, v158, v169
    v_add_f32 v159, v159, v177
    v_mov_b32 v160, v158
    s_nop 1
    v_permlane16_swap_b32 v158, v160
    v_add_f32 v158, v158, v160
    v_mov_b32 v160, v158
    s_nop 1
    v_permlane32_swap_b32 v158, v160
    v_add_f32 v158, v158, v160
    v_mov_b32 v160, v159
    s_nop 1
    v_permlane16_swap_b32 v159, v160
    v_add_f32 v159, v159, v160
    v_mov_b32 v160, v159
    s_nop 1
    v_permlane32_swap_b32 v159, v160
    v_add_f32 v159, v159, v160
    v_rcp_f32 v158, v158
    v_rcp_f32 v159, v159
    v_mul_f32 v162, v162, v158
    v_mul_f32 v170, v170, v159
    v_mul_f32 v163, v163, v158
    v_mul_f32 v171, v171, v159
    v_mul_f32 v164, v164, v158
    v_mul_f32 v172, v172, v159
    v_mul_f32 v165, v165, v158
    v_mul_f32 v173, v173, v159
    v_mul_f32 v166, v166, v158
    v_mul_f32 v174, v174, v159
    v_mul_f32 v167, v167, v158
    v_mul_f32 v175, v175, v159
    v_mul_f32 v168, v168, v158
    v_mul_f32 v176, v176, v159
    v_mul_f32 v169, v169, v158
    v_mul_f32 v177, v177, v159
    v_cvt_pk_bf16_f32 v44, v162, v163
    v_cvt_pk_bf16_f32 v48, v170, v171
    v_cvt_pk_bf16_f32 v45, v164, v165
    v_cvt_pk_bf16_f32 v49, v172, v173
    v_cvt_pk_bf16_f32 v46, v166, v167
    v_cvt_pk_bf16_f32 v50, v174, v175
    v_cvt_pk_bf16_f32 v47, v168, v169
    v_cvt_pk_bf16_f32 v51, v176, v177
    ds_write_b16 v148, v44 offset:0
    ds_write_b16_d16_hi v148, v44 offset:272
    ds_write_b16 v148, v48 offset:8704
    ds_write_b16_d16_hi v148, v48 offset:8976
    ds_write_b16 v148, v24 offset:17408
    ds_write_b16_d16_hi v148, v24 offset:17680
    ds_write_b16 v148, v45 offset:544
    ds_write_b16_d16_hi v148, v45 offset:816
    ds_write_b16 v148, v49 offset:9248
    ds_write_b16_d16_hi v148, v49 offset:9520
    ds_write_b16 v148, v25 offset:17952
    ds_write_b16_d16_hi v148, v25 offset:18224
    ds_write_b16 v148, v46 offset:4352
    ds_write_b16_d16_hi v148, v46 offset:4624
    ds_write_b16 v148, v50 offset:13056
    ds_write_b16_d16_hi v148, v50 offset:13328
    ds_write_b16 v148, v26 offset:21760
    ds_write_b16_d16_hi v148, v26 offset:22032
    ds_write_b16 v148, v47 offset:4896
    ds_write_b16_d16_hi v148, v47 offset:5168
    ds_write_b16 v148, v51 offset:13600
    ds_write_b16_d16_hi v148, v51 offset:13872
    ds_write_b16 v148, v27 offset:22304
    ds_write_b16_d16_hi v148, v27 offset:22576
    s_waitcnt lgkmcnt(0)
    s_barrier
    s_cmp_ge_u32 s3, 4
    s_cbranch_scc1 K1_KVSKIP_0
    s_lshl_b32 s19, s3, 4
    v_add_u32 v41, s19, v2
    v_mul_u32_u24 v41, 272, v41
    v_lshl_add_u32 v41, v3, 4, v41
    v_add_u32 v41, 94208, v41
    v_mul_u32_u24 v42, 272, v2
    v_lshl_add_u32 v42, v3, 4, v42
    v_add_u32 v42, 111616, v42
    ds_read_b128 v[48:51], v41 offset:0
    ds_read_b128 v[64:67], v42 offset:0
    ds_read_b128 v[68:71], v42 offset:4352
    ds_read_b128 v[52:55], v41 offset:64
    ds_read_b128 v[72:75], v42 offset:64
    ds_read_b128 v[76:79], v42 offset:4416
    ds_read_b128 v[56:59], v41 offset:128
    ds_read_b128 v[80:83], v42 offset:128
    ds_read_b128 v[84:87], v42 offset:4480
    ds_read_b128 v[60:63], v41 offset:192
    ds_read_b128 v[88:91], v42 offset:192
    ds_read_b128 v[92:95], v42 offset:4544
    s_waitcnt lgkmcnt(9)
    v_mfma_f32_16x16x32_bf16 v[112:115], v[48:51], v[64:67], 0
    v_mfma_f32_16x16x32_bf16 v[116:119], v[48:51], v[68:71], 0
    s_waitcnt lgkmcnt(6)
    v_mfma_f32_16x16x32_bf16 v[112:115], v[52:55], v[72:75], v[112:115]
    v_mfma_f32_16x16x32_bf16 v[116:119], v[52:55], v[76:79], v[116:119]
    s_waitcnt lgkmcnt(3)
    v_mfma_f32_16x16x32_bf16 v[112:115], v[56:59], v[80:83], v[112:115]
    v_mfma_f32_16x16x32_bf16 v[116:119], v[56:59], v[84:87], v[116:119]
    s_waitcnt lgkmcnt(0)
    v_mfma_f32_16x16x32_bf16 v[112:115], v[60:63], v[88:91], v[112:115]
    v_mfma_f32_16x16x32_bf16 v[116:119], v[60:63], v[92:95], v[116:119]
    s_lshr_b32 s19, s3, 1
    s_lshl_b32 s19, s19, 11
    s_and_b32 s20, s3, 1
    s_lshl_b32 s20, s20, 4
    s_add_u32 s19, s19, s20
    v_lshlrev_b32 v43, 5, v0
    v_add_u32 v43, s19, v43
    v_add_u32 v43, 120320, v43
    ds_write_b128 v43, v[112:115] offset:0
    ds_write_b128 v43, v[116:119] offset:4096
    s_waitcnt lgkmcnt(0)
    s_nop 11
K1_KVSKIP_0:
    s_barrier
    v_lshlrev_b32 v43, 2, v0
    s_lshl_b32 s19, s3, 10
    v_add_u32 v44, s19, v43
    v_add_u32 v44, 120320, v44
    ds_read_b32 v48, v44 offset:0
    ds_read_b32 v49, v44 offset:256
    ds_read_b32 v50, v44 offset:512
    ds_read_b32 v51, v44 offset:768
    s_lshl_b32 s19, s14, 13
    s_lshl_b32 s20, s3, 10
    s_add_u32 s19, s19, s20
    s_add_u32 s19, s19, 6914048
    s_waitcnt lgkmcnt(3)
    buffer_atomic_add_f32 v48, v43, s[8:11], s19 offen offset:0
    s_waitcnt lgkmcnt(2)
    buffer_atomic_add_f32 v49, v43, s[8:11], s19 offen offset:256
    s_waitcnt lgkmcnt(1)
    buffer_atomic_add_f32 v50, v43, s[8:11], s19 offen offset:512
    s_waitcnt lgkmcnt(0)
    buffer_atomic_add_f32 v51, v43, s[8:11], s19 offen offset:768
    s_nop 11
K1_END_0:
    s_endpgm
.globl wo0_kernel
.p2align 8
.type wo0_kernel,@function
wo0_kernel:
    s_load_dwordx2 s[4:5], s[0:1], 88
    s_cmp_ge_u32 s2, 224
    s_cbranch_scc1 K2_END_0
    v_lshrrev_b32 v1, 6, v0
    v_and_b32 v0, 63, v0
    v_readfirstlane_b32 s3, v1
    v_lshlrev_b32 v1, 4, v0
    v_and_b32 v2, 15, v0
    v_lshrrev_b32 v3, 4, v0
    s_waitcnt lgkmcnt(0)
    s_mov_b32 s8, s4
    s_and_b32 s9, s5, 0xffff
    s_mov_b32 s10, 0x10000000
    s_mov_b32 s11, 0x00020000
    s_and_b32 s14, s2, 7
    s_lshr_b32 s15, s2, 3
    s_mul_hi_u32 s16, s15, 0x24924925
    s_mul_i32 s17, s16, 7
    s_sub_u32 s12, s15, s17
    s_lshl_b32 s13, s14, 2
    s_add_u32 s13, s13, s16
    v_lshlrev_b32 v4, 5, v0
    s_lshl_b32 s19, s3, 15
    s_add_u32 s19, s19, 6914048
    s_add_u32 s20, s19, 0
    buffer_load_dwordx4 v[16:19], v4, s[8:11], s20 offen
    buffer_load_dwordx4 v[20:23], v4, s[8:11], s20 offen offset:16
    s_add_u32 s20, s19, 2048
    buffer_load_dwordx4 v[24:27], v4, s[8:11], s20 offen
    buffer_load_dwordx4 v[28:31], v4, s[8:11], s20 offen offset:16
    s_add_u32 s20, s19, 4096
    buffer_load_dwordx4 v[32:35], v4, s[8:11], s20 offen
    buffer_load_dwordx4 v[36:39], v4, s[8:11], s20 offen offset:16
    s_add_u32 s20, s19, 6144
    buffer_load_dwordx4 v[40:43], v4, s[8:11], s20 offen
    buffer_load_dwordx4 v[44:47], v4, s[8:11], s20 offen offset:16
    s_add_u32 s20, s19, 8192
    buffer_load_dwordx4 v[48:51], v4, s[8:11], s20 offen
    buffer_load_dwordx4 v[52:55], v4, s[8:11], s20 offen offset:16
    s_add_u32 s20, s19, 10240
    buffer_load_dwordx4 v[56:59], v4, s[8:11], s20 offen
    buffer_load_dwordx4 v[60:63], v4, s[8:11], s20 offen offset:16
    s_add_u32 s20, s19, 12288
    buffer_load_dwordx4 v[64:67], v4, s[8:11], s20 offen
    buffer_load_dwordx4 v[68:71], v4, s[8:11], s20 offen offset:16
    s_add_u32 s20, s19, 14336
    buffer_load_dwordx4 v[72:75], v4, s[8:11], s20 offen
    buffer_load_dwordx4 v[76:79], v4, s[8:11], s20 offen offset:16
    s_add_u32 s20, s19, 16384
    buffer_load_dwordx4 v[80:83], v4, s[8:11], s20 offen
    buffer_load_dwordx4 v[84:87], v4, s[8:11], s20 offen offset:16
    s_add_u32 s20, s19, 18432
    buffer_load_dwordx4 v[88:91], v4, s[8:11], s20 offen
    buffer_load_dwordx4 v[92:95], v4, s[8:11], s20 offen offset:16
    s_add_u32 s20, s19, 20480
    buffer_load_dwordx4 v[96:99], v4, s[8:11], s20 offen
    buffer_load_dwordx4 v[100:103], v4, s[8:11], s20 offen offset:16
    s_add_u32 s20, s19, 22528
    buffer_load_dwordx4 v[104:107], v4, s[8:11], s20 offen
    buffer_load_dwordx4 v[108:111], v4, s[8:11], s20 offen offset:16
    s_add_u32 s20, s19, 24576
    buffer_load_dwordx4 v[112:115], v4, s[8:11], s20 offen
    buffer_load_dwordx4 v[116:119], v4, s[8:11], s20 offen offset:16
    s_add_u32 s20, s19, 26624
    buffer_load_dwordx4 v[120:123], v4, s[8:11], s20 offen
    buffer_load_dwordx4 v[124:127], v4, s[8:11], s20 offen offset:16
    s_add_u32 s20, s19, 28672
    buffer_load_dwordx4 v[128:131], v4, s[8:11], s20 offen
    buffer_load_dwordx4 v[132:135], v4, s[8:11], s20 offen offset:16
    s_add_u32 s20, s19, 30720
    buffer_load_dwordx4 v[136:139], v4, s[8:11], s20 offen
    buffer_load_dwordx4 v[140:143], v4, s[8:11], s20 offen offset:16
    s_lshl_b32 s20, s12, 2
    s_add_u32 s20, s20, 0
    s_lshl_b32 s20, s20, 4
    s_lshl_b32 s21, s3, 2
    s_add_u32 s20, s20, s21
    s_add_u32 s20, s20, 0
    s_lshl_b32 s20, s20, 10
    s_add_u32 s20, s20, 3244032
    buffer_load_dwordx4 a[0:3], v1, s[8:11], s20 offen
    s_lshl_b32 s20, s12, 2
    s_add_u32 s20, s20, 0
    s_lshl_b32 s20, s20, 4
    s_lshl_b32 s21, s3, 2
    s_add_u32 s20, s20, s21
    s_add_u32 s20, s20, 1
    s_lshl_b32 s20, s20, 10
    s_add_u32 s20, s20, 3244032
    buffer_load_dwordx4 a[4:7], v1, s[8:11], s20 offen
    s_lshl_b32 s20, s12, 2
    s_add_u32 s20, s20, 0
    s_lshl_b32 s20, s20, 4
    s_lshl_b32 s21, s3, 2
    s_add_u32 s20, s20, s21
    s_add_u32 s20, s20, 2
    s_lshl_b32 s20, s20, 10
    s_add_u32 s20, s20, 3244032
    buffer_load_dwordx4 a[8:11], v1, s[8:11], s20 offen
    s_lshl_b32 s20, s12, 2
    s_add_u32 s20, s20, 0
    s_lshl_b32 s20, s20, 4
    s_lshl_b32 s21, s3, 2
    s_add_u32 s20, s20, s21
    s_add_u32 s20, s20, 3
    s_lshl_b32 s20, s20, 10
    s_add_u32 s20, s20, 3244032
    buffer_load_dwordx4 a[12:15], v1, s[8:11], s20 offen
    s_lshl_b32 s20, s12, 2
    s_add_u32 s20, s20, 1
    s_lshl_b32 s20, s20, 4
    s_lshl_b32 s21, s3, 2
    s_add_u32 s20, s20, s21
    s_add_u32 s20, s20, 0
    s_lshl_b32 s20, s20, 10
    s_add_u32 s20, s20, 3244032
    buffer_load_dwordx4 a[16:19], v1, s[8:11], s20 offen
    s_lshl_b32 s20, s12, 2
    s_add_u32 s20, s20, 1
    s_lshl_b32 s20, s20, 4
    s_lshl_b32 s21, s3, 2
    s_add_u32 s20, s20, s21
    s_add_u32 s20, s20, 1
    s_lshl_b32 s20, s20, 10
    s_add_u32 s20, s20, 3244032
    buffer_load_dwordx4 a[20:23], v1, s[8:11], s20 offen
    s_lshl_b32 s20, s12, 2
    s_add_u32 s20, s20, 1
    s_lshl_b32 s20, s20, 4
    s_lshl_b32 s21, s3, 2
    s_add_u32 s20, s20, s21
    s_add_u32 s20, s20, 2
    s_lshl_b32 s20, s20, 10
    s_add_u32 s20, s20, 3244032
    buffer_load_dwordx4 a[24:27], v1, s[8:11], s20 offen
    s_lshl_b32 s20, s12, 2
    s_add_u32 s20, s20, 1
    s_lshl_b32 s20, s20, 4
    s_lshl_b32 s21, s3, 2
    s_add_u32 s20, s20, s21
    s_add_u32 s20, s20, 3
    s_lshl_b32 s20, s20, 10
    s_add_u32 s20, s20, 3244032
    buffer_load_dwordx4 a[28:31], v1, s[8:11], s20 offen
    s_lshl_b32 s20, s12, 2
    s_add_u32 s20, s20, 2
    s_lshl_b32 s20, s20, 4
    s_lshl_b32 s21, s3, 2
    s_add_u32 s20, s20, s21
    s_add_u32 s20, s20, 0
    s_lshl_b32 s20, s20, 10
    s_add_u32 s20, s20, 3244032
    buffer_load_dwordx4 a[32:35], v1, s[8:11], s20 offen
    s_lshl_b32 s20, s12, 2
    s_add_u32 s20, s20, 2
    s_lshl_b32 s20, s20, 4
    s_lshl_b32 s21, s3, 2
    s_add_u32 s20, s20, s21
    s_add_u32 s20, s20, 1
    s_lshl_b32 s20, s20, 10
    s_add_u32 s20, s20, 3244032
    buffer_load_dwordx4 a[36:39], v1, s[8:11], s20 offen
    s_lshl_b32 s20, s12, 2
    s_add_u32 s20, s20, 2
    s_lshl_b32 s20, s20, 4
    s_lshl_b32 s21, s3, 2
    s_add_u32 s20, s20, s21
    s_add_u32 s20, s20, 2
    s_lshl_b32 s20, s20, 10
    s_add_u32 s20, s20, 3244032
    buffer_load_dwordx4 a[40:43], v1, s[8:11], s20 offen
    s_lshl_b32 s20, s12, 2
    s_add_u32 s20, s20, 2
    s_lshl_b32 s20, s20, 4
    s_lshl_b32 s21, s3, 2
    s_add_u32 s20, s20, s21
    s_add_u32 s20, s20, 3
    s_lshl_b32 s20, s20, 10
    s_add_u32 s20, s20, 3244032
    buffer_load_dwordx4 a[44:47], v1, s[8:11], s20 offen
    s_lshl_b32 s20, s12, 2
    s_add_u32 s20, s20, 3
    s_lshl_b32 s20, s20, 4
    s_lshl_b32 s21, s3, 2
    s_add_u32 s20, s20, s21
    s_add_u32 s20, s20, 0
    s_lshl_b32 s20, s20, 10
    s_add_u32 s20, s20, 3244032
    buffer_load_dwordx4 a[48:51], v1, s[8:11], s20 offen
    s_lshl_b32 s20, s12, 2
    s_add_u32 s20, s20, 3
    s_lshl_b32 s20, s20, 4
    s_lshl_b32 s21, s3, 2
    s_add_u32 s20, s20, s21
    s_add_u32 s20, s20, 1
    s_lshl_b32 s20, s20, 10
    s_add_u32 s20, s20, 3244032
    buffer_load_dwordx4 a[52:55], v1, s[8:11], s20 offen
    s_lshl_b32 s20, s12, 2
    s_add_u32 s20, s20, 3
    s_lshl_b32 s20, s20, 4
    s_lshl_b32 s21, s3, 2
    s_add_u32 s20, s20, s21
    s_add_u32 s20, s20, 2
    s_lshl_b32 s20, s20, 10
    s_add_u32 s20, s20, 3244032
    buffer_load_dwordx4 a[56:59], v1, s[8:11], s20 offen
    s_lshl_b32 s20, s12, 2
    s_add_u32 s20, s20, 3
    s_lshl_b32 s20, s20, 4
    s_lshl_b32 s21, s3, 2
    s_add_u32 s20, s20, s21
    s_add_u32 s20, s20, 3
    s_lshl_b32 s20, s20, 10
    s_add_u32 s20, s20, 3244032
    buffer_load_dwordx4 a[60:63], v1, s[8:11], s20 offen
    s_lshl_b32 s20, s13, 2
    s_add_u32 s20, s20, 0
    s_lshl_b32 s20, s20, 4
    s_lshl_b32 s21, s3, 2
    s_add_u32 s20, s20, s21
    s_add_u32 s20, s20, 0
    s_lshl_b32 s20, s20, 11
    s_add_u32 s20, s20, 7176192
    buffer_load_dwordx4 a[64:67], v1, s[8:11], s20 offen
    buffer_load_dwordx4 a[68:71], v1, s[8:11], s20 offen offset:1024
    s_lshl_b32 s20, s13, 2
    s_add_u32 s20, s20, 0
    s_lshl_b32 s20, s20, 4
    s_lshl_b32 s21, s3, 2
    s_add_u32 s20, s20, s21
    s_add_u32 s20, s20, 1
    s_lshl_b32 s20, s20, 11
    s_add_u32 s20, s20, 7176192
    buffer_load_dwordx4 a[72:75], v1, s[8:11], s20 offen
    buffer_load_dwordx4 a[76:79], v1, s[8:11], s20 offen offset:1024
    s_lshl_b32 s20, s13, 2
    s_add_u32 s20, s20, 0
    s_lshl_b32 s20, s20, 4
    s_lshl_b32 s21, s3, 2
    s_add_u32 s20, s20, s21
    s_add_u32 s20, s20, 2
    s_lshl_b32 s20, s20, 11
    s_add_u32 s20, s20, 7176192
    buffer_load_dwordx4 a[80:83], v1, s[8:11], s20 offen
    buffer_load_dwordx4 a[84:87], v1, s[8:11], s20 offen offset:1024
    s_lshl_b32 s20, s13, 2
    s_add_u32 s20, s20, 0
    s_lshl_b32 s20, s20, 4
    s_lshl_b32 s21, s3, 2
    s_add_u32 s20, s20, s21
    s_add_u32 s20, s20, 3
    s_lshl_b32 s20, s20, 11
    s_add_u32 s20, s20, 7176192
    buffer_load_dwordx4 a[88:91], v1, s[8:11], s20 offen
    buffer_load_dwordx4 a[92:95], v1, s[8:11], s20 offen offset:1024
    s_lshl_b32 s20, s13, 2
    s_add_u32 s20, s20, 1
    s_lshl_b32 s20, s20, 4
    s_lshl_b32 s21, s3, 2
    s_add_u32 s20, s20, s21
    s_add_u32 s20, s20, 0
    s_lshl_b32 s20, s20, 11
    s_add_u32 s20, s20, 7176192
    buffer_load_dwordx4 a[96:99], v1, s[8:11], s20 offen
    buffer_load_dwordx4 a[100:103], v1, s[8:11], s20 offen offset:1024
    s_lshl_b32 s20, s13, 2
    s_add_u32 s20, s20, 1
    s_lshl_b32 s20, s20, 4
    s_lshl_b32 s21, s3, 2
    s_add_u32 s20, s20, s21
    s_add_u32 s20, s20, 1
    s_lshl_b32 s20, s20, 11
    s_add_u32 s20, s20, 7176192
    buffer_load_dwordx4 a[104:107], v1, s[8:11], s20 offen
    buffer_load_dwordx4 a[108:111], v1, s[8:11], s20 offen offset:1024
    s_lshl_b32 s20, s13, 2
    s_add_u32 s20, s20, 1
    s_lshl_b32 s20, s20, 4
    s_lshl_b32 s21, s3, 2
    s_add_u32 s20, s20, s21
    s_add_u32 s20, s20, 2
    s_lshl_b32 s20, s20, 11
    s_add_u32 s20, s20, 7176192
    buffer_load_dwordx4 a[112:115], v1, s[8:11], s20 offen
    buffer_load_dwordx4 a[116:119], v1, s[8:11], s20 offen offset:1024
    s_lshl_b32 s20, s13, 2
    s_add_u32 s20, s20, 1
    s_lshl_b32 s20, s20, 4
    s_lshl_b32 s21, s3, 2
    s_add_u32 s20, s20, s21
    s_add_u32 s20, s20, 3
    s_lshl_b32 s20, s20, 11
    s_add_u32 s20, s20, 7176192
    buffer_load_dwordx4 a[120:123], v1, s[8:11], s20 offen
    buffer_load_dwordx4 a[124:127], v1, s[8:11], s20 offen offset:1024
    v_add_u32 v5, 48, v2
    v_lshlrev_b32 v5, 2, v5
    v_mov_b32 v6, 0x358637bd
    s_waitcnt vmcnt(32)
    v_cvt_pk_bf16_f32 v144, v16, v17
    v_cvt_pk_bf16_f32 v145, v18, v19
    v_cvt_pk_bf16_f32 v146, v20, v21
    v_cvt_pk_bf16_f32 v147, v22, v23
    v_cvt_pk_bf16_f32 v148, v24, v25
    v_cvt_pk_bf16_f32 v149, v26, v27
    v_cvt_pk_bf16_f32 v150, v28, v29
    v_cvt_pk_bf16_f32 v151, v30, v31
    v_cvt_pk_bf16_f32 v152, v32, v33
    v_cvt_pk_bf16_f32 v153, v34, v35
    v_cvt_pk_bf16_f32 v154, v36, v37
    v_cvt_pk_bf16_f32 v155, v38, v39
    v_cvt_pk_bf16_f32 v156, v40, v41
    v_cvt_pk_bf16_f32 v157, v42, v43
    v_cvt_pk_bf16_f32 v158, v44, v45
    v_cvt_pk_bf16_f32 v159, v46, v47
    v_cvt_pk_bf16_f32 v160, v48, v49
    v_cvt_pk_bf16_f32 v161, v50, v51
    v_cvt_pk_bf16_f32 v162, v52, v53
    v_cvt_pk_bf16_f32 v163, v54, v55
    v_cvt_pk_bf16_f32 v164, v56, v57
    v_cvt_pk_bf16_f32 v165, v58, v59
    v_cvt_pk_bf16_f32 v166, v60, v61
    v_cvt_pk_bf16_f32 v167, v62, v63
    v_cvt_pk_bf16_f32 v168, v64, v65
    v_cvt_pk_bf16_f32 v169, v66, v67
    v_cvt_pk_bf16_f32 v170, v68, v69
    v_cvt_pk_bf16_f32 v171, v70, v71
    v_cvt_pk_bf16_f32 v172, v72, v73
    v_cvt_pk_bf16_f32 v173, v74, v75
    v_cvt_pk_bf16_f32 v174, v76, v77
    v_cvt_pk_bf16_f32 v175, v78, v79
    v_cvt_pk_bf16_f32 v176, v80, v81
    v_cvt_pk_bf16_f32 v177, v82, v83
    v_cvt_pk_bf16_f32 v178, v84, v85
    v_cvt_pk_bf16_f32 v179, v86, v87
    v_cvt_pk_bf16_f32 v180, v88, v89
    v_cvt_pk_bf16_f32 v181, v90, v91
    v_cvt_pk_bf16_f32 v182, v92, v93
    v_cvt_pk_bf16_f32 v183, v94, v95
    v_cvt_pk_bf16_f32 v184, v96, v97
    v_cvt_pk_bf16_f32 v185, v98, v99
    v_cvt_pk_bf16_f32 v186, v100, v101
    v_cvt_pk_bf16_f32 v187, v102, v103
    v_cvt_pk_bf16_f32 v188, v104, v105
    v_cvt_pk_bf16_f32 v189, v106, v107
    v_cvt_pk_bf16_f32 v190, v108, v109
    v_cvt_pk_bf16_f32 v191, v110, v111
    v_cvt_pk_bf16_f32 v192, v112, v113
    v_cvt_pk_bf16_f32 v193, v114, v115
    v_cvt_pk_bf16_f32 v194, v116, v117
    v_cvt_pk_bf16_f32 v195, v118, v119
    v_cvt_pk_bf16_f32 v196, v120, v121
    v_cvt_pk_bf16_f32 v197, v122, v123
    v_cvt_pk_bf16_f32 v198, v124, v125
    v_cvt_pk_bf16_f32 v199, v126, v127
    v_cvt_pk_bf16_f32 v200, v128, v129
    v_cvt_pk_bf16_f32 v201, v130, v131
    v_cvt_pk_bf16_f32 v202, v132, v133
    v_cvt_pk_bf16_f32 v203, v134, v135
    v_cvt_pk_bf16_f32 v204, v136, v137
    v_cvt_pk_bf16_f32 v205, v138, v139
    v_cvt_pk_bf16_f32 v206, v140, v141
    v_cvt_pk_bf16_f32 v207, v142, v143
    s_waitcnt vmcnt(16)
    s_waitcnt vmcnt(8)
    s_lshl_b32 s20, s13, 2
    s_add_u32 s20, s20, 2
    s_lshl_b32 s20, s20, 4
    s_lshl_b32 s21, s3, 2
    s_add_u32 s20, s20, s21
    s_add_u32 s20, s20, 0
    s_lshl_b32 s20, s20, 11
    s_add_u32 s20, s20, 7176192
    buffer_load_dwordx4 a[128:131], v1, s[8:11], s20 offen
    buffer_load_dwordx4 a[132:135], v1, s[8:11], s20 offen offset:1024
    s_lshl_b32 s20, s13, 2
    s_add_u32 s20, s20, 2
    s_lshl_b32 s20, s20, 4
    s_lshl_b32 s21, s3, 2
    s_add_u32 s20, s20, s21
    s_add_u32 s20, s20, 1
    s_lshl_b32 s20, s20, 11
    s_add_u32 s20, s20, 7176192
    buffer_load_dwordx4 a[136:139], v1, s[8:11], s20 offen
    buffer_load_dwordx4 a[140:143], v1, s[8:11], s20 offen offset:1024
    s_lshl_b32 s20, s13, 2
    s_add_u32 s20, s20, 2
    s_lshl_b32 s20, s20, 4
    s_lshl_b32 s21, s3, 2
    s_add_u32 s20, s20, s21
    s_add_u32 s20, s20, 2
    s_lshl_b32 s20, s20, 11
    s_add_u32 s20, s20, 7176192
    buffer_load_dwordx4 a[144:147], v1, s[8:11], s20 offen
    buffer_load_dwordx4 a[148:151], v1, s[8:11], s20 offen offset:1024
    s_lshl_b32 s20, s13, 2
    s_add_u32 s20, s20, 2
    s_lshl_b32 s20, s20, 4
    s_lshl_b32 s21, s3, 2
    s_add_u32 s20, s20, s21
    s_add_u32 s20, s20, 3
    s_lshl_b32 s20, s20, 11
    s_add_u32 s20, s20, 7176192
    buffer_load_dwordx4 a[152:155], v1, s[8:11], s20 offen
    buffer_load_dwordx4 a[156:159], v1, s[8:11], s20 offen offset:1024
    v_mfma_f32_16x16x32_bf16 v[80:83], v[144:147], a[64:67], 0
    v_mfma_f32_16x16x32_bf16 v[80:83], v[148:151], a[68:71], v[80:83]
    v_mfma_f32_16x16x32_bf16 v[84:87], v[152:155], a[64:67], 0
    v_mfma_f32_16x16x32_bf16 v[84:87], v[156:159], a[68:71], v[84:87]
    v_mfma_f32_16x16x32_bf16 v[88:91], v[160:163], a[72:75], 0
    v_mfma_f32_16x16x32_bf16 v[88:91], v[164:167], a[76:79], v[88:91]
    v_mfma_f32_16x16x32_bf16 v[92:95], v[168:171], a[72:75], 0
    v_mfma_f32_16x16x32_bf16 v[92:95], v[172:175], a[76:79], v[92:95]
    v_mfma_f32_16x16x32_bf16 v[96:99], v[176:179], a[80:83], 0
    v_mfma_f32_16x16x32_bf16 v[96:99], v[180:183], a[84:87], v[96:99]
    v_mfma_f32_16x16x32_bf16 v[100:103], v[184:187], a[80:83], 0
    v_mfma_f32_16x16x32_bf16 v[100:103], v[188:191], a[84:87], v[100:103]
    v_mfma_f32_16x16x32_bf16 v[104:107], v[192:195], a[88:91], 0
    v_mfma_f32_16x16x32_bf16 v[104:107], v[196:199], a[92:95], v[104:107]
    v_mfma_f32_16x16x32_bf16 v[108:111], v[200:203], a[88:91], 0
    v_mfma_f32_16x16x32_bf16 v[108:111], v[204:207], a[92:95], v[108:111]
    ds_bpermute_b32 v112, v5, v84
    ds_bpermute_b32 v113, v5, v92
    s_nop 1
    ds_bpermute_b32 v114, v5, v100
    s_nop 2
    ds_bpermute_b32 v115, v5, v108
    s_waitcnt lgkmcnt(0)
    v_cvt_pk_bf16_f32 v120, v112, v112
    v_lshlrev_b32 v112, 16, v120
    v_add_f32 v112, v112, v6
    v_cvt_pk_bf16_f32 v120, v112, v112
    v_lshlrev_b32 v112, 16, v120
    v_rcp_f32 v112, v112
    v_cvt_pk_bf16_f32 v120, v80, v81
    v_lshlrev_b32 v80, 16, v120
    v_and_b32 v81, 0xffff0000, v120
    v_mul_f32 v80, v80, v112
    v_mul_f32 v81, v81, v112
    v_cvt_pk_bf16_f32 v116, v80, v81
    v_cvt_pk_bf16_f32 v120, v82, v83
    v_lshlrev_b32 v82, 16, v120
    v_and_b32 v83, 0xffff0000, v120
    v_mul_f32 v82, v82, v112
    v_mul_f32 v83, v83, v112
    v_cvt_pk_bf16_f32 v117, v82, v83
    v_cvt_pk_bf16_f32 v120, v84, v85
    v_lshlrev_b32 v84, 16, v120
    v_and_b32 v85, 0xffff0000, v120
    v_mul_f32 v84, v84, v112
    v_mul_f32 v85, v85, v112
    v_cvt_pk_bf16_f32 v118, v84, v85
    v_cvt_pk_bf16_f32 v120, v86, v87
    v_lshlrev_b32 v86, 16, v120
    v_and_b32 v87, 0xffff0000, v120
    v_mul_f32 v86, v86, v112
    v_mul_f32 v87, v87, v112
    v_cvt_pk_bf16_f32 v119, v86, v87
    s_nop 1
    v_mfma_f32_16x16x32_bf16 v[16:19], a[0:3], v[116:119], 0
    v_mfma_f32_16x16x32_bf16 v[32:35], a[16:19], v[116:119], 0
    v_mfma_f32_16x16x32_bf16 v[48:51], a[32:35], v[116:119], 0
    v_mfma_f32_16x16x32_bf16 v[64:67], a[48:51], v[116:119], 0
    v_cvt_pk_bf16_f32 v120, v113, v113
    v_lshlrev_b32 v113, 16, v120
    v_add_f32 v113, v113, v6
    v_cvt_pk_bf16_f32 v120, v113, v113
    v_lshlrev_b32 v113, 16, v120
    v_rcp_f32 v113, v113
    v_cvt_pk_bf16_f32 v120, v88, v89
    v_lshlrev_b32 v88, 16, v120
    v_and_b32 v89, 0xffff0000, v120
    v_mul_f32 v88, v88, v113
    v_mul_f32 v89, v89, v113
    v_cvt_pk_bf16_f32 v116, v88, v89
    v_cvt_pk_bf16_f32 v120, v90, v91
    v_lshlrev_b32 v90, 16, v120
    v_and_b32 v91, 0xffff0000, v120
    v_mul_f32 v90, v90, v113
    v_mul_f32 v91, v91, v113
    v_cvt_pk_bf16_f32 v117, v90, v91
    v_cvt_pk_bf16_f32 v120, v92, v93
    v_lshlrev_b32 v92, 16, v120
    v_and_b32 v93, 0xffff0000, v120
    v_mul_f32 v92, v92, v113
    v_mul_f32 v93, v93, v113
    v_cvt_pk_bf16_f32 v118, v92, v93
    v_cvt_pk_bf16_f32 v120, v94, v95
    v_lshlrev_b32 v94, 16, v120
    v_and_b32 v95, 0xffff0000, v120
    v_mul_f32 v94, v94, v113
    v_mul_f32 v95, v95, v113
    v_cvt_pk_bf16_f32 v119, v94, v95
    s_nop 1
    v_mfma_f32_16x16x32_bf16 v[16:19], a[4:7], v[116:119], v[16:19]
    v_mfma_f32_16x16x32_bf16 v[32:35], a[20:23], v[116:119], v[32:35]
    v_mfma_f32_16x16x32_bf16 v[48:51], a[36:39], v[116:119], v[48:51]
    v_mfma_f32_16x16x32_bf16 v[64:67], a[52:55], v[116:119], v[64:67]
    v_cvt_pk_bf16_f32 v120, v114, v114
    v_lshlrev_b32 v114, 16, v120
    v_add_f32 v114, v114, v6
    v_cvt_pk_bf16_f32 v120, v114, v114
    v_lshlrev_b32 v114, 16, v120
    v_rcp_f32 v114, v114
    v_cvt_pk_bf16_f32 v120, v96, v97
    v_lshlrev_b32 v96, 16, v120
    v_and_b32 v97, 0xffff0000, v120
    v_mul_f32 v96, v96, v114
    v_mul_f32 v97, v97, v114
    v_cvt_pk_bf16_f32 v116, v96, v97
    v_cvt_pk_bf16_f32 v120, v98, v99
    v_lshlrev_b32 v98, 16, v120
    v_and_b32 v99, 0xffff0000, v120
    v_mul_f32 v98, v98, v114
    v_mul_f32 v99, v99, v114
    v_cvt_pk_bf16_f32 v117, v98, v99
    v_cvt_pk_bf16_f32 v120, v100, v101
    v_lshlrev_b32 v100, 16, v120
    v_and_b32 v101, 0xffff0000, v120
    v_mul_f32 v100, v100, v114
    v_mul_f32 v101, v101, v114
    v_cvt_pk_bf16_f32 v118, v100, v101
    v_cvt_pk_bf16_f32 v120, v102, v103
    v_lshlrev_b32 v102, 16, v120
    v_and_b32 v103, 0xffff0000, v120
    v_mul_f32 v102, v102, v114
    v_mul_f32 v103, v103, v114
    v_cvt_pk_bf16_f32 v119, v102, v103
    s_nop 1
    v_mfma_f32_16x16x32_bf16 v[16:19], a[8:11], v[116:119], v[16:19]
    v_mfma_f32_16x16x32_bf16 v[32:35], a[24:27], v[116:119], v[32:35]
    v_mfma_f32_16x16x32_bf16 v[48:51], a[40:43], v[116:119], v[48:51]
    v_mfma_f32_16x16x32_bf16 v[64:67], a[56:59], v[116:119], v[64:67]
    v_cvt_pk_bf16_f32 v120, v115, v115
    v_lshlrev_b32 v115, 16, v120
    v_add_f32 v115, v115, v6
    v_cvt_pk_bf16_f32 v120, v115, v115
    v_lshlrev_b32 v115, 16, v120
    v_rcp_f32 v115, v115
    v_cvt_pk_bf16_f32 v120, v104, v105
    v_lshlrev_b32 v104, 16, v120
    v_and_b32 v105, 0xffff0000, v120
    v_mul_f32 v104, v104, v115
    v_mul_f32 v105, v105, v115
    v_cvt_pk_bf16_f32 v116, v104, v105
    v_cvt_pk_bf16_f32 v120, v106, v107
    v_lshlrev_b32 v106, 16, v120
    v_and_b32 v107, 0xffff0000, v120
    v_mul_f32 v106, v106, v115
    v_mul_f32 v107, v107, v115
    v_cvt_pk_bf16_f32 v117, v106, v107
    v_cvt_pk_bf16_f32 v120, v108, v109
    v_lshlrev_b32 v108, 16, v120
    v_and_b32 v109, 0xffff0000, v120
    v_mul_f32 v108, v108, v115
    v_mul_f32 v109, v109, v115
    v_cvt_pk_bf16_f32 v118, v108, v109
    v_cvt_pk_bf16_f32 v120, v110, v111
    v_lshlrev_b32 v110, 16, v120
    v_and_b32 v111, 0xffff0000, v120
    v_mul_f32 v110, v110, v115
    v_mul_f32 v111, v111, v115
    v_cvt_pk_bf16_f32 v119, v110, v111
    s_nop 1
    v_mfma_f32_16x16x32_bf16 v[16:19], a[12:15], v[116:119], v[16:19]
    v_mfma_f32_16x16x32_bf16 v[32:35], a[28:31], v[116:119], v[32:35]
    v_mfma_f32_16x16x32_bf16 v[48:51], a[44:47], v[116:119], v[48:51]
    v_mfma_f32_16x16x32_bf16 v[64:67], a[60:63], v[116:119], v[64:67]
    s_waitcnt vmcnt(8)
    s_lshl_b32 s20, s13, 2
    s_add_u32 s20, s20, 3
    s_lshl_b32 s20, s20, 4
    s_lshl_b32 s21, s3, 2
    s_add_u32 s20, s20, s21
    s_add_u32 s20, s20, 0
    s_lshl_b32 s20, s20, 11
    s_add_u32 s20, s20, 7176192
    buffer_load_dwordx4 a[160:163], v1, s[8:11], s20 offen
    buffer_load_dwordx4 a[164:167], v1, s[8:11], s20 offen offset:1024
    s_lshl_b32 s20, s13, 2
    s_add_u32 s20, s20, 3
    s_lshl_b32 s20, s20, 4
    s_lshl_b32 s21, s3, 2
    s_add_u32 s20, s20, s21
    s_add_u32 s20, s20, 1
    s_lshl_b32 s20, s20, 11
    s_add_u32 s20, s20, 7176192
    buffer_load_dwordx4 a[168:171], v1, s[8:11], s20 offen
    buffer_load_dwordx4 a[172:175], v1, s[8:11], s20 offen offset:1024
    s_lshl_b32 s20, s13, 2
    s_add_u32 s20, s20, 3
    s_lshl_b32 s20, s20, 4
    s_lshl_b32 s21, s3, 2
    s_add_u32 s20, s20, s21
    s_add_u32 s20, s20, 2
    s_lshl_b32 s20, s20, 11
    s_add_u32 s20, s20, 7176192
    buffer_load_dwordx4 a[176:179], v1, s[8:11], s20 offen
    buffer_load_dwordx4 a[180:183], v1, s[8:11], s20 offen offset:1024
    s_lshl_b32 s20, s13, 2
    s_add_u32 s20, s20, 3
    s_lshl_b32 s20, s20, 4
    s_lshl_b32 s21, s3, 2
    s_add_u32 s20, s20, s21
    s_add_u32 s20, s20, 3
    s_lshl_b32 s20, s20, 11
    s_add_u32 s20, s20, 7176192
    buffer_load_dwordx4 a[184:187], v1, s[8:11], s20 offen
    buffer_load_dwordx4 a[188:191], v1, s[8:11], s20 offen offset:1024
    v_mfma_f32_16x16x32_bf16 v[80:83], v[144:147], a[96:99], 0
    v_mfma_f32_16x16x32_bf16 v[80:83], v[148:151], a[100:103], v[80:83]
    v_mfma_f32_16x16x32_bf16 v[84:87], v[152:155], a[96:99], 0
    v_mfma_f32_16x16x32_bf16 v[84:87], v[156:159], a[100:103], v[84:87]
    v_mfma_f32_16x16x32_bf16 v[88:91], v[160:163], a[104:107], 0
    v_mfma_f32_16x16x32_bf16 v[88:91], v[164:167], a[108:111], v[88:91]
    v_mfma_f32_16x16x32_bf16 v[92:95], v[168:171], a[104:107], 0
    v_mfma_f32_16x16x32_bf16 v[92:95], v[172:175], a[108:111], v[92:95]
    v_mfma_f32_16x16x32_bf16 v[96:99], v[176:179], a[112:115], 0
    v_mfma_f32_16x16x32_bf16 v[96:99], v[180:183], a[116:119], v[96:99]
    v_mfma_f32_16x16x32_bf16 v[100:103], v[184:187], a[112:115], 0
    v_mfma_f32_16x16x32_bf16 v[100:103], v[188:191], a[116:119], v[100:103]
    v_mfma_f32_16x16x32_bf16 v[104:107], v[192:195], a[120:123], 0
    v_mfma_f32_16x16x32_bf16 v[104:107], v[196:199], a[124:127], v[104:107]
    v_mfma_f32_16x16x32_bf16 v[108:111], v[200:203], a[120:123], 0
    v_mfma_f32_16x16x32_bf16 v[108:111], v[204:207], a[124:127], v[108:111]
    ds_bpermute_b32 v112, v5, v84
    ds_bpermute_b32 v113, v5, v92
    s_nop 1
    ds_bpermute_b32 v114, v5, v100
    s_nop 2
    ds_bpermute_b32 v115, v5, v108
    s_waitcnt lgkmcnt(0)
    v_cvt_pk_bf16_f32 v120, v112, v112
    v_lshlrev_b32 v112, 16, v120
    v_add_f32 v112, v112, v6
    v_cvt_pk_bf16_f32 v120, v112, v112
    v_lshlrev_b32 v112, 16, v120
    v_rcp_f32 v112, v112
    v_cvt_pk_bf16_f32 v120, v80, v81
    v_lshlrev_b32 v80, 16, v120
    v_and_b32 v81, 0xffff0000, v120
    v_mul_f32 v80, v80, v112
    v_mul_f32 v81, v81, v112
    v_cvt_pk_bf16_f32 v116, v80, v81
    v_cvt_pk_bf16_f32 v120, v82, v83
    v_lshlrev_b32 v82, 16, v120
    v_and_b32 v83, 0xffff0000, v120
    v_mul_f32 v82, v82, v112
    v_mul_f32 v83, v83, v112
    v_cvt_pk_bf16_f32 v117, v82, v83
    v_cvt_pk_bf16_f32 v120, v84, v85
    v_lshlrev_b32 v84, 16, v120
    v_and_b32 v85, 0xffff0000, v120
    v_mul_f32 v84, v84, v112
    v_mul_f32 v85, v85, v112
    v_cvt_pk_bf16_f32 v118, v84, v85
    v_cvt_pk_bf16_f32 v120, v86, v87
    v_lshlrev_b32 v86, 16, v120
    v_and_b32 v87, 0xffff0000, v120
    v_mul_f32 v86, v86, v112
    v_mul_f32 v87, v87, v112
    v_cvt_pk_bf16_f32 v119, v86, v87
    s_nop 1
    v_mfma_f32_16x16x32_bf16 v[20:23], a[0:3], v[116:119], 0
    v_mfma_f32_16x16x32_bf16 v[36:39], a[16:19], v[116:119], 0
    v_mfma_f32_16x16x32_bf16 v[52:55], a[32:35], v[116:119], 0
    v_mfma_f32_16x16x32_bf16 v[68:71], a[48:51], v[116:119], 0
    v_cvt_pk_bf16_f32 v120, v113, v113
    v_lshlrev_b32 v113, 16, v120
    v_add_f32 v113, v113, v6
    v_cvt_pk_bf16_f32 v120, v113, v113
    v_lshlrev_b32 v113, 16, v120
    v_rcp_f32 v113, v113
    v_cvt_pk_bf16_f32 v120, v88, v89
    v_lshlrev_b32 v88, 16, v120
    v_and_b32 v89, 0xffff0000, v120
    v_mul_f32 v88, v88, v113
    v_mul_f32 v89, v89, v113
    v_cvt_pk_bf16_f32 v116, v88, v89
    v_cvt_pk_bf16_f32 v120, v90, v91
    v_lshlrev_b32 v90, 16, v120
    v_and_b32 v91, 0xffff0000, v120
    v_mul_f32 v90, v90, v113
    v_mul_f32 v91, v91, v113
    v_cvt_pk_bf16_f32 v117, v90, v91
    v_cvt_pk_bf16_f32 v120, v92, v93
    v_lshlrev_b32 v92, 16, v120
    v_and_b32 v93, 0xffff0000, v120
    v_mul_f32 v92, v92, v113
    v_mul_f32 v93, v93, v113
    v_cvt_pk_bf16_f32 v118, v92, v93
    v_cvt_pk_bf16_f32 v120, v94, v95
    v_lshlrev_b32 v94, 16, v120
    v_and_b32 v95, 0xffff0000, v120
    v_mul_f32 v94, v94, v113
    v_mul_f32 v95, v95, v113
    v_cvt_pk_bf16_f32 v119, v94, v95
    s_nop 1
    v_mfma_f32_16x16x32_bf16 v[20:23], a[4:7], v[116:119], v[20:23]
    v_mfma_f32_16x16x32_bf16 v[36:39], a[20:23], v[116:119], v[36:39]
    v_mfma_f32_16x16x32_bf16 v[52:55], a[36:39], v[116:119], v[52:55]
    v_mfma_f32_16x16x32_bf16 v[68:71], a[52:55], v[116:119], v[68:71]
    v_cvt_pk_bf16_f32 v120, v114, v114
    v_lshlrev_b32 v114, 16, v120
    v_add_f32 v114, v114, v6
    v_cvt_pk_bf16_f32 v120, v114, v114
    v_lshlrev_b32 v114, 16, v120
    v_rcp_f32 v114, v114
    v_cvt_pk_bf16_f32 v120, v96, v97
    v_lshlrev_b32 v96, 16, v120
    v_and_b32 v97, 0xffff0000, v120
    v_mul_f32 v96, v96, v114
    v_mul_f32 v97, v97, v114
    v_cvt_pk_bf16_f32 v116, v96, v97
    v_cvt_pk_bf16_f32 v120, v98, v99
    v_lshlrev_b32 v98, 16, v120
    v_and_b32 v99, 0xffff0000, v120
    v_mul_f32 v98, v98, v114
    v_mul_f32 v99, v99, v114
    v_cvt_pk_bf16_f32 v117, v98, v99
    v_cvt_pk_bf16_f32 v120, v100, v101
    v_lshlrev_b32 v100, 16, v120
    v_and_b32 v101, 0xffff0000, v120
    v_mul_f32 v100, v100, v114
    v_mul_f32 v101, v101, v114
    v_cvt_pk_bf16_f32 v118, v100, v101
    v_cvt_pk_bf16_f32 v120, v102, v103
    v_lshlrev_b32 v102, 16, v120
    v_and_b32 v103, 0xffff0000, v120
    v_mul_f32 v102, v102, v114
    v_mul_f32 v103, v103, v114
    v_cvt_pk_bf16_f32 v119, v102, v103
    s_nop 1
    v_mfma_f32_16x16x32_bf16 v[20:23], a[8:11], v[116:119], v[20:23]
    v_mfma_f32_16x16x32_bf16 v[36:39], a[24:27], v[116:119], v[36:39]
    v_mfma_f32_16x16x32_bf16 v[52:55], a[40:43], v[116:119], v[52:55]
    v_mfma_f32_16x16x32_bf16 v[68:71], a[56:59], v[116:119], v[68:71]
    v_cvt_pk_bf16_f32 v120, v115, v115
    v_lshlrev_b32 v115, 16, v120
    v_add_f32 v115, v115, v6
    v_cvt_pk_bf16_f32 v120, v115, v115
    v_lshlrev_b32 v115, 16, v120
    v_rcp_f32 v115, v115
    v_cvt_pk_bf16_f32 v120, v104, v105
    v_lshlrev_b32 v104, 16, v120
    v_and_b32 v105, 0xffff0000, v120
    v_mul_f32 v104, v104, v115
    v_mul_f32 v105, v105, v115
    v_cvt_pk_bf16_f32 v116, v104, v105
    v_cvt_pk_bf16_f32 v120, v106, v107
    v_lshlrev_b32 v106, 16, v120
    v_and_b32 v107, 0xffff0000, v120
    v_mul_f32 v106, v106, v115
    v_mul_f32 v107, v107, v115
    v_cvt_pk_bf16_f32 v117, v106, v107
    v_cvt_pk_bf16_f32 v120, v108, v109
    v_lshlrev_b32 v108, 16, v120
    v_and_b32 v109, 0xffff0000, v120
    v_mul_f32 v108, v108, v115
    v_mul_f32 v109, v109, v115
    v_cvt_pk_bf16_f32 v118, v108, v109
    v_cvt_pk_bf16_f32 v120, v110, v111
    v_lshlrev_b32 v110, 16, v120
    v_and_b32 v111, 0xffff0000, v120
    v_mul_f32 v110, v110, v115
    v_mul_f32 v111, v111, v115
    v_cvt_pk_bf16_f32 v119, v110, v111
    s_nop 1
    v_mfma_f32_16x16x32_bf16 v[20:23], a[12:15], v[116:119], v[20:23]
    v_mfma_f32_16x16x32_bf16 v[36:39], a[28:31], v[116:119], v[36:39]
    v_mfma_f32_16x16x32_bf16 v[52:55], a[44:47], v[116:119], v[52:55]
    v_mfma_f32_16x16x32_bf16 v[68:71], a[60:63], v[116:119], v[68:71]
    s_waitcnt vmcnt(8)
    v_mfma_f32_16x16x32_bf16 v[80:83], v[144:147], a[128:131], 0
    v_mfma_f32_16x16x32_bf16 v[80:83], v[148:151], a[132:135], v[80:83]
    v_mfma_f32_16x16x32_bf16 v[84:87], v[152:155], a[128:131], 0
    v_mfma_f32_16x16x32_bf16 v[84:87], v[156:159], a[132:135], v[84:87]
    v_mfma_f32_16x16x32_bf16 v[88:91], v[160:163], a[136:139], 0
    v_mfma_f32_16x16x32_bf16 v[88:91], v[164:167], a[140:143], v[88:91]
    v_mfma_f32_16x16x32_bf16 v[92:95], v[168:171], a[136:139], 0
    v_mfma_f32_16x16x32_bf16 v[92:95], v[172:175], a[140:143], v[92:95]
    v_mfma_f32_16x16x32_bf16 v[96:99], v[176:179], a[144:147], 0
    v_mfma_f32_16x16x32_bf16 v[96:99], v[180:183], a[148:151], v[96:99]
    v_mfma_f32_16x16x32_bf16 v[100:103], v[184:187], a[144:147], 0
    v_mfma_f32_16x16x32_bf16 v[100:103], v[188:191], a[148:151], v[100:103]
    v_mfma_f32_16x16x32_bf16 v[104:107], v[192:195], a[152:155], 0
    v_mfma_f32_16x16x32_bf16 v[104:107], v[196:199], a[156:159], v[104:107]
    v_mfma_f32_16x16x32_bf16 v[108:111], v[200:203], a[152:155], 0
    v_mfma_f32_16x16x32_bf16 v[108:111], v[204:207], a[156:159], v[108:111]
    ds_bpermute_b32 v112, v5, v84
    ds_bpermute_b32 v113, v5, v92
    s_nop 1
    ds_bpermute_b32 v114, v5, v100
    s_nop 2
    ds_bpermute_b32 v115, v5, v108
    s_waitcnt lgkmcnt(0)
    v_cvt_pk_bf16_f32 v120, v112, v112
    v_lshlrev_b32 v112, 16, v120
    v_add_f32 v112, v112, v6
    v_cvt_pk_bf16_f32 v120, v112, v112
    v_lshlrev_b32 v112, 16, v120
    v_rcp_f32 v112, v112
    v_cvt_pk_bf16_f32 v120, v80, v81
    v_lshlrev_b32 v80, 16, v120
    v_and_b32 v81, 0xffff0000, v120
    v_mul_f32 v80, v80, v112
    v_mul_f32 v81, v81, v112
    v_cvt_pk_bf16_f32 v116, v80, v81
    v_cvt_pk_bf16_f32 v120, v82, v83
    v_lshlrev_b32 v82, 16, v120
    v_and_b32 v83, 0xffff0000, v120
    v_mul_f32 v82, v82, v112
    v_mul_f32 v83, v83, v112
    v_cvt_pk_bf16_f32 v117, v82, v83
    v_cvt_pk_bf16_f32 v120, v84, v85
    v_lshlrev_b32 v84, 16, v120
    v_and_b32 v85, 0xffff0000, v120
    v_mul_f32 v84, v84, v112
    v_mul_f32 v85, v85, v112
    v_cvt_pk_bf16_f32 v118, v84, v85
    v_cvt_pk_bf16_f32 v120, v86, v87
    v_lshlrev_b32 v86, 16, v120
    v_and_b32 v87, 0xffff0000, v120
    v_mul_f32 v86, v86, v112
    v_mul_f32 v87, v87, v112
    v_cvt_pk_bf16_f32 v119, v86, v87
    s_nop 1
    v_mfma_f32_16x16x32_bf16 v[24:27], a[0:3], v[116:119], 0
    v_mfma_f32_16x16x32_bf16 v[40:43], a[16:19], v[116:119], 0
    v_mfma_f32_16x16x32_bf16 v[56:59], a[32:35], v[116:119], 0
    v_mfma_f32_16x16x32_bf16 v[72:75], a[48:51], v[116:119], 0
    v_cvt_pk_bf16_f32 v120, v113, v113
    v_lshlrev_b32 v113, 16, v120
    v_add_f32 v113, v113, v6
    v_cvt_pk_bf16_f32 v120, v113, v113
    v_lshlrev_b32 v113, 16, v120
    v_rcp_f32 v113, v113
    v_cvt_pk_bf16_f32 v120, v88, v89
    v_lshlrev_b32 v88, 16, v120
    v_and_b32 v89, 0xffff0000, v120
    v_mul_f32 v88, v88, v113
    v_mul_f32 v89, v89, v113
    v_cvt_pk_bf16_f32 v116, v88, v89
    v_cvt_pk_bf16_f32 v120, v90, v91
    v_lshlrev_b32 v90, 16, v120
    v_and_b32 v91, 0xffff0000, v120
    v_mul_f32 v90, v90, v113
    v_mul_f32 v91, v91, v113
    v_cvt_pk_bf16_f32 v117, v90, v91
    v_cvt_pk_bf16_f32 v120, v92, v93
    v_lshlrev_b32 v92, 16, v120
    v_and_b32 v93, 0xffff0000, v120
    v_mul_f32 v92, v92, v113
    v_mul_f32 v93, v93, v113
    v_cvt_pk_bf16_f32 v118, v92, v93
    v_cvt_pk_bf16_f32 v120, v94, v95
    v_lshlrev_b32 v94, 16, v120
    v_and_b32 v95, 0xffff0000, v120
    v_mul_f32 v94, v94, v113
    v_mul_f32 v95, v95, v113
    v_cvt_pk_bf16_f32 v119, v94, v95
    s_nop 1
    v_mfma_f32_16x16x32_bf16 v[24:27], a[4:7], v[116:119], v[24:27]
    v_mfma_f32_16x16x32_bf16 v[40:43], a[20:23], v[116:119], v[40:43]
    v_mfma_f32_16x16x32_bf16 v[56:59], a[36:39], v[116:119], v[56:59]
    v_mfma_f32_16x16x32_bf16 v[72:75], a[52:55], v[116:119], v[72:75]
    v_cvt_pk_bf16_f32 v120, v114, v114
    v_lshlrev_b32 v114, 16, v120
    v_add_f32 v114, v114, v6
    v_cvt_pk_bf16_f32 v120, v114, v114
    v_lshlrev_b32 v114, 16, v120
    v_rcp_f32 v114, v114
    v_cvt_pk_bf16_f32 v120, v96, v97
    v_lshlrev_b32 v96, 16, v120
    v_and_b32 v97, 0xffff0000, v120
    v_mul_f32 v96, v96, v114
    v_mul_f32 v97, v97, v114
    v_cvt_pk_bf16_f32 v116, v96, v97
    v_cvt_pk_bf16_f32 v120, v98, v99
    v_lshlrev_b32 v98, 16, v120
    v_and_b32 v99, 0xffff0000, v120
    v_mul_f32 v98, v98, v114
    v_mul_f32 v99, v99, v114
    v_cvt_pk_bf16_f32 v117, v98, v99
    v_cvt_pk_bf16_f32 v120, v100, v101
    v_lshlrev_b32 v100, 16, v120
    v_and_b32 v101, 0xffff0000, v120
    v_mul_f32 v100, v100, v114
    v_mul_f32 v101, v101, v114
    v_cvt_pk_bf16_f32 v118, v100, v101
    v_cvt_pk_bf16_f32 v120, v102, v103
    v_lshlrev_b32 v102, 16, v120
    v_and_b32 v103, 0xffff0000, v120
    v_mul_f32 v102, v102, v114
    v_mul_f32 v103, v103, v114
    v_cvt_pk_bf16_f32 v119, v102, v103
    s_nop 1
    v_mfma_f32_16x16x32_bf16 v[24:27], a[8:11], v[116:119], v[24:27]
    v_mfma_f32_16x16x32_bf16 v[40:43], a[24:27], v[116:119], v[40:43]
    v_mfma_f32_16x16x32_bf16 v[56:59], a[40:43], v[116:119], v[56:59]
    v_mfma_f32_16x16x32_bf16 v[72:75], a[56:59], v[116:119], v[72:75]
    v_cvt_pk_bf16_f32 v120, v115, v115
    v_lshlrev_b32 v115, 16, v120
    v_add_f32 v115, v115, v6
    v_cvt_pk_bf16_f32 v120, v115, v115
    v_lshlrev_b32 v115, 16, v120
    v_rcp_f32 v115, v115
    v_cvt_pk_bf16_f32 v120, v104, v105
    v_lshlrev_b32 v104, 16, v120
    v_and_b32 v105, 0xffff0000, v120
    v_mul_f32 v104, v104, v115
    v_mul_f32 v105, v105, v115
    v_cvt_pk_bf16_f32 v116, v104, v105
    v_cvt_pk_bf16_f32 v120, v106, v107
    v_lshlrev_b32 v106, 16, v120
    v_and_b32 v107, 0xffff0000, v120
    v_mul_f32 v106, v106, v115
    v_mul_f32 v107, v107, v115
    v_cvt_pk_bf16_f32 v117, v106, v107
    v_cvt_pk_bf16_f32 v120, v108, v109
    v_lshlrev_b32 v108, 16, v120
    v_and_b32 v109, 0xffff0000, v120
    v_mul_f32 v108, v108, v115
    v_mul_f32 v109, v109, v115
    v_cvt_pk_bf16_f32 v118, v108, v109
    v_cvt_pk_bf16_f32 v120, v110, v111
    v_lshlrev_b32 v110, 16, v120
    v_and_b32 v111, 0xffff0000, v120
    v_mul_f32 v110, v110, v115
    v_mul_f32 v111, v111, v115
    v_cvt_pk_bf16_f32 v119, v110, v111
    s_nop 1
    v_mfma_f32_16x16x32_bf16 v[24:27], a[12:15], v[116:119], v[24:27]
    v_mfma_f32_16x16x32_bf16 v[40:43], a[28:31], v[116:119], v[40:43]
    v_mfma_f32_16x16x32_bf16 v[56:59], a[44:47], v[116:119], v[56:59]
    v_mfma_f32_16x16x32_bf16 v[72:75], a[60:63], v[116:119], v[72:75]
    s_waitcnt vmcnt(0)
    v_mfma_f32_16x16x32_bf16 v[80:83], v[144:147], a[160:163], 0
    v_mfma_f32_16x16x32_bf16 v[80:83], v[148:151], a[164:167], v[80:83]
    v_mfma_f32_16x16x32_bf16 v[84:87], v[152:155], a[160:163], 0
    v_mfma_f32_16x16x32_bf16 v[84:87], v[156:159], a[164:167], v[84:87]
    v_mfma_f32_16x16x32_bf16 v[88:91], v[160:163], a[168:171], 0
    v_mfma_f32_16x16x32_bf16 v[88:91], v[164:167], a[172:175], v[88:91]
    v_mfma_f32_16x16x32_bf16 v[92:95], v[168:171], a[168:171], 0
    v_mfma_f32_16x16x32_bf16 v[92:95], v[172:175], a[172:175], v[92:95]
    v_mfma_f32_16x16x32_bf16 v[96:99], v[176:179], a[176:179], 0
    v_mfma_f32_16x16x32_bf16 v[96:99], v[180:183], a[180:183], v[96:99]
    v_mfma_f32_16x16x32_bf16 v[100:103], v[184:187], a[176:179], 0
    v_mfma_f32_16x16x32_bf16 v[100:103], v[188:191], a[180:183], v[100:103]
    v_mfma_f32_16x16x32_bf16 v[104:107], v[192:195], a[184:187], 0
    v_mfma_f32_16x16x32_bf16 v[104:107], v[196:199], a[188:191], v[104:107]
    v_mfma_f32_16x16x32_bf16 v[108:111], v[200:203], a[184:187], 0
    v_mfma_f32_16x16x32_bf16 v[108:111], v[204:207], a[188:191], v[108:111]
    ds_bpermute_b32 v112, v5, v84
    ds_bpermute_b32 v113, v5, v92
    s_nop 1
    ds_bpermute_b32 v114, v5, v100
    s_nop 2
    ds_bpermute_b32 v115, v5, v108
    s_waitcnt lgkmcnt(0)
    v_cvt_pk_bf16_f32 v120, v112, v112
    v_lshlrev_b32 v112, 16, v120
    v_add_f32 v112, v112, v6
    v_cvt_pk_bf16_f32 v120, v112, v112
    v_lshlrev_b32 v112, 16, v120
    v_rcp_f32 v112, v112
    v_cvt_pk_bf16_f32 v120, v80, v81
    v_lshlrev_b32 v80, 16, v120
    v_and_b32 v81, 0xffff0000, v120
    v_mul_f32 v80, v80, v112
    v_mul_f32 v81, v81, v112
    v_cvt_pk_bf16_f32 v116, v80, v81
    v_cvt_pk_bf16_f32 v120, v82, v83
    v_lshlrev_b32 v82, 16, v120
    v_and_b32 v83, 0xffff0000, v120
    v_mul_f32 v82, v82, v112
    v_mul_f32 v83, v83, v112
    v_cvt_pk_bf16_f32 v117, v82, v83
    v_cvt_pk_bf16_f32 v120, v84, v85
    v_lshlrev_b32 v84, 16, v120
    v_and_b32 v85, 0xffff0000, v120
    v_mul_f32 v84, v84, v112
    v_mul_f32 v85, v85, v112
    v_cvt_pk_bf16_f32 v118, v84, v85
    v_cvt_pk_bf16_f32 v120, v86, v87
    v_lshlrev_b32 v86, 16, v120
    v_and_b32 v87, 0xffff0000, v120
    v_mul_f32 v86, v86, v112
    v_mul_f32 v87, v87, v112
    v_cvt_pk_bf16_f32 v119, v86, v87
    s_nop 1
    v_mfma_f32_16x16x32_bf16 v[28:31], a[0:3], v[116:119], 0
    v_mfma_f32_16x16x32_bf16 v[44:47], a[16:19], v[116:119], 0
    v_mfma_f32_16x16x32_bf16 v[60:63], a[32:35], v[116:119], 0
    v_mfma_f32_16x16x32_bf16 v[76:79], a[48:51], v[116:119], 0
    v_cvt_pk_bf16_f32 v120, v113, v113
    v_lshlrev_b32 v113, 16, v120
    v_add_f32 v113, v113, v6
    v_cvt_pk_bf16_f32 v120, v113, v113
    v_lshlrev_b32 v113, 16, v120
    v_rcp_f32 v113, v113
    v_cvt_pk_bf16_f32 v120, v88, v89
    v_lshlrev_b32 v88, 16, v120
    v_and_b32 v89, 0xffff0000, v120
    v_mul_f32 v88, v88, v113
    v_mul_f32 v89, v89, v113
    v_cvt_pk_bf16_f32 v116, v88, v89
    v_cvt_pk_bf16_f32 v120, v90, v91
    v_lshlrev_b32 v90, 16, v120
    v_and_b32 v91, 0xffff0000, v120
    v_mul_f32 v90, v90, v113
    v_mul_f32 v91, v91, v113
    v_cvt_pk_bf16_f32 v117, v90, v91
    v_cvt_pk_bf16_f32 v120, v92, v93
    v_lshlrev_b32 v92, 16, v120
    v_and_b32 v93, 0xffff0000, v120
    v_mul_f32 v92, v92, v113
    v_mul_f32 v93, v93, v113
    v_cvt_pk_bf16_f32 v118, v92, v93
    v_cvt_pk_bf16_f32 v120, v94, v95
    v_lshlrev_b32 v94, 16, v120
    v_and_b32 v95, 0xffff0000, v120
    v_mul_f32 v94, v94, v113
    v_mul_f32 v95, v95, v113
    v_cvt_pk_bf16_f32 v119, v94, v95
    s_nop 1
    v_mfma_f32_16x16x32_bf16 v[28:31], a[4:7], v[116:119], v[28:31]
    v_mfma_f32_16x16x32_bf16 v[44:47], a[20:23], v[116:119], v[44:47]
    v_mfma_f32_16x16x32_bf16 v[60:63], a[36:39], v[116:119], v[60:63]
    v_mfma_f32_16x16x32_bf16 v[76:79], a[52:55], v[116:119], v[76:79]
    v_cvt_pk_bf16_f32 v120, v114, v114
    v_lshlrev_b32 v114, 16, v120
    v_add_f32 v114, v114, v6
    v_cvt_pk_bf16_f32 v120, v114, v114
    v_lshlrev_b32 v114, 16, v120
    v_rcp_f32 v114, v114
    v_cvt_pk_bf16_f32 v120, v96, v97
    v_lshlrev_b32 v96, 16, v120
    v_and_b32 v97, 0xffff0000, v120
    v_mul_f32 v96, v96, v114
    v_mul_f32 v97, v97, v114
    v_cvt_pk_bf16_f32 v116, v96, v97
    v_cvt_pk_bf16_f32 v120, v98, v99
    v_lshlrev_b32 v98, 16, v120
    v_and_b32 v99, 0xffff0000, v120
    v_mul_f32 v98, v98, v114
    v_mul_f32 v99, v99, v114
    v_cvt_pk_bf16_f32 v117, v98, v99
    v_cvt_pk_bf16_f32 v120, v100, v101
    v_lshlrev_b32 v100, 16, v120
    v_and_b32 v101, 0xffff0000, v120
    v_mul_f32 v100, v100, v114
    v_mul_f32 v101, v101, v114
    v_cvt_pk_bf16_f32 v118, v100, v101
    v_cvt_pk_bf16_f32 v120, v102, v103
    v_lshlrev_b32 v102, 16, v120
    v_and_b32 v103, 0xffff0000, v120
    v_mul_f32 v102, v102, v114
    v_mul_f32 v103, v103, v114
    v_cvt_pk_bf16_f32 v119, v102, v103
    s_nop 1
    v_mfma_f32_16x16x32_bf16 v[28:31], a[8:11], v[116:119], v[28:31]
    v_mfma_f32_16x16x32_bf16 v[44:47], a[24:27], v[116:119], v[44:47]
    v_mfma_f32_16x16x32_bf16 v[60:63], a[40:43], v[116:119], v[60:63]
    v_mfma_f32_16x16x32_bf16 v[76:79], a[56:59], v[116:119], v[76:79]
    v_cvt_pk_bf16_f32 v120, v115, v115
    v_lshlrev_b32 v115, 16, v120
    v_add_f32 v115, v115, v6
    v_cvt_pk_bf16_f32 v120, v115, v115
    v_lshlrev_b32 v115, 16, v120
    v_rcp_f32 v115, v115
    v_cvt_pk_bf16_f32 v120, v104, v105
    v_lshlrev_b32 v104, 16, v120
    v_and_b32 v105, 0xffff0000, v120
    v_mul_f32 v104, v104, v115
    v_mul_f32 v105, v105, v115
    v_cvt_pk_bf16_f32 v116, v104, v105
    v_cvt_pk_bf16_f32 v120, v106, v107
    v_lshlrev_b32 v106, 16, v120
    v_and_b32 v107, 0xffff0000, v120
    v_mul_f32 v106, v106, v115
    v_mul_f32 v107, v107, v115
    v_cvt_pk_bf16_f32 v117, v106, v107
    v_cvt_pk_bf16_f32 v120, v108, v109
    v_lshlrev_b32 v108, 16, v120
    v_and_b32 v109, 0xffff0000, v120
    v_mul_f32 v108, v108, v115
    v_mul_f32 v109, v109, v115
    v_cvt_pk_bf16_f32 v118, v108, v109
    v_cvt_pk_bf16_f32 v120, v110, v111
    v_lshlrev_b32 v110, 16, v120
    v_and_b32 v111, 0xffff0000, v120
    v_mul_f32 v110, v110, v115
    v_mul_f32 v111, v111, v115
    v_cvt_pk_bf16_f32 v119, v110, v111
    s_nop 1
    v_mfma_f32_16x16x32_bf16 v[28:31], a[12:15], v[116:119], v[28:31]
    v_mfma_f32_16x16x32_bf16 v[44:47], a[28:31], v[116:119], v[44:47]
    v_mfma_f32_16x16x32_bf16 v[60:63], a[44:47], v[116:119], v[60:63]
    v_mfma_f32_16x16x32_bf16 v[76:79], a[60:63], v[116:119], v[76:79]
    s_lshl_b32 s19, s3, 14
    v_add_u32 v4, s19, v1
    ds_write_b128 v4, v[16:19] offset:0
    ds_write_b128 v4, v[20:23] offset:1024
    ds_write_b128 v4, v[24:27] offset:2048
    ds_write_b128 v4, v[28:31] offset:3072
    ds_write_b128 v4, v[32:35] offset:4096
    ds_write_b128 v4, v[36:39] offset:5120
    ds_write_b128 v4, v[40:43] offset:6144
    ds_write_b128 v4, v[44:47] offset:7168
    ds_write_b128 v4, v[48:51] offset:8192
    ds_write_b128 v4, v[52:55] offset:9216
    ds_write_b128 v4, v[56:59] offset:10240
    ds_write_b128 v4, v[60:63] offset:11264
    ds_write_b128 v4, v[64:67] offset:12288
    ds_write_b128 v4, v[68:71] offset:13312
    ds_write_b128 v4, v[72:75] offset:14336
    ds_write_b128 v4, v[76:79] offset:15360
    s_lshl_b32 s19, s13, 2
    s_add_u32 s19, s19, s3
    s_mul_i32 s19, s19, 14336
    s_lshl_b32 s20, s12, 11
    s_add_u32 s19, s19, s20
    s_add_u32 s21, s19, 0
    buffer_load_dwordx4 v[80:83], v1, s[8:11], s21 offen
    buffer_load_dwordx4 v[84:87], v1, s[8:11], s21 offen offset:1024
    s_waitcnt lgkmcnt(0)
    s_barrier
    s_lshl_b32 s20, s3, 10
    v_add_u32 v4, s20, v1
    ds_read_b128 v[16:19], v4 offset:0
    ds_read_b128 v[20:23], v4 offset:4096
    ds_read_b128 v[24:27], v4 offset:8192
    ds_read_b128 v[28:31], v4 offset:12288
    ds_read_b128 v[32:35], v4 offset:16384
    ds_read_b128 v[36:39], v4 offset:20480
    ds_read_b128 v[40:43], v4 offset:24576
    ds_read_b128 v[44:47], v4 offset:28672
    ds_read_b128 v[48:51], v4 offset:32768
    ds_read_b128 v[52:55], v4 offset:36864
    ds_read_b128 v[56:59], v4 offset:40960
    ds_read_b128 v[60:63], v4 offset:45056
    ds_read_b128 v[64:67], v4 offset:49152
    ds_read_b128 v[68:71], v4 offset:53248
    ds_read_b128 v[72:75], v4 offset:57344
    ds_read_b128 v[76:79], v4 offset:61440
    s_waitcnt lgkmcnt(8)
    v_add_f32 v16, v16, v32
    v_add_f32 v17, v17, v33
    v_add_f32 v18, v18, v34
    v_add_f32 v19, v19, v35
    v_add_f32 v20, v20, v36
    v_add_f32 v21, v21, v37
    v_add_f32 v22, v22, v38
    v_add_f32 v23, v23, v39
    v_add_f32 v24, v24, v40
    v_add_f32 v25, v25, v41
    v_add_f32 v26, v26, v42
    v_add_f32 v27, v27, v43
    v_add_f32 v28, v28, v44
    v_add_f32 v29, v29, v45
    v_add_f32 v30, v30, v46
    v_add_f32 v31, v31, v47
    s_waitcnt lgkmcnt(0)
    v_add_f32 v48, v48, v64
    v_add_f32 v16, v16, v48
    v_add_f32 v49, v49, v65
    v_add_f32 v17, v17, v49
    v_add_f32 v50, v50, v66
    v_add_f32 v18, v18, v50
    v_add_f32 v51, v51, v67
    v_add_f32 v19, v19, v51
    v_add_f32 v52, v52, v68
    v_add_f32 v20, v20, v52
    v_add_f32 v53, v53, v69
    v_add_f32 v21, v21, v53
    v_add_f32 v54, v54, v70
    v_add_f32 v22, v22, v54
    v_add_f32 v55, v55, v71
    v_add_f32 v23, v23, v55
    v_add_f32 v56, v56, v72
    v_add_f32 v24, v24, v56
    v_add_f32 v57, v57, v73
    v_add_f32 v25, v25, v57
    v_add_f32 v58, v58, v74
    v_add_f32 v26, v26, v58
    v_add_f32 v59, v59, v75
    v_add_f32 v27, v27, v59
    v_add_f32 v60, v60, v76
    v_add_f32 v28, v28, v60
    v_add_f32 v61, v61, v77
    v_add_f32 v29, v29, v61
    v_add_f32 v62, v62, v78
    v_add_f32 v30, v30, v62
    v_add_f32 v63, v63, v79
    v_add_f32 v31, v31, v63
    s_waitcnt vmcnt(0)
    v_cvt_pk_bf16_f32 v6, v16, v17
    v_lshlrev_b32 v16, 16, v6
    v_and_b32 v17, 0xffff0000, v6
    v_lshlrev_b32 v7, 16, v80
    v_and_b32 v8, 0xffff0000, v80
    v_add_f32 v16, v16, v7
    v_add_f32 v17, v17, v8
    v_cvt_pk_bf16_f32 v96, v16, v17
    v_cvt_pk_bf16_f32 v6, v18, v19
    v_lshlrev_b32 v18, 16, v6
    v_and_b32 v19, 0xffff0000, v6
    v_lshlrev_b32 v7, 16, v81
    v_and_b32 v8, 0xffff0000, v81
    v_add_f32 v18, v18, v7
    v_add_f32 v19, v19, v8
    v_cvt_pk_bf16_f32 v97, v18, v19
    v_cvt_pk_bf16_f32 v6, v20, v21
    v_lshlrev_b32 v20, 16, v6
    v_and_b32 v21, 0xffff0000, v6
    v_lshlrev_b32 v7, 16, v82
    v_and_b32 v8, 0xffff0000, v82
    v_add_f32 v20, v20, v7
    v_add_f32 v21, v21, v8
    v_cvt_pk_bf16_f32 v98, v20, v21
    v_cvt_pk_bf16_f32 v6, v22, v23
    v_lshlrev_b32 v22, 16, v6
    v_and_b32 v23, 0xffff0000, v6
    v_lshlrev_b32 v7, 16, v83
    v_and_b32 v8, 0xffff0000, v83
    v_add_f32 v22, v22, v7
    v_add_f32 v23, v23, v8
    v_cvt_pk_bf16_f32 v99, v22, v23
    v_cvt_pk_bf16_f32 v6, v24, v25
    v_lshlrev_b32 v24, 16, v6
    v_and_b32 v25, 0xffff0000, v6
    v_lshlrev_b32 v7, 16, v84
    v_and_b32 v8, 0xffff0000, v84
    v_add_f32 v24, v24, v7
    v_add_f32 v25, v25, v8
    v_cvt_pk_bf16_f32 v100, v24, v25
    v_cvt_pk_bf16_f32 v6, v26, v27
    v_lshlrev_b32 v26, 16, v6
    v_and_b32 v27, 0xffff0000, v6
    v_lshlrev_b32 v7, 16, v85
    v_and_b32 v8, 0xffff0000, v85
    v_add_f32 v26, v26, v7
    v_add_f32 v27, v27, v8
    v_cvt_pk_bf16_f32 v101, v26, v27
    v_cvt_pk_bf16_f32 v6, v28, v29
    v_lshlrev_b32 v28, 16, v6
    v_and_b32 v29, 0xffff0000, v6
    v_lshlrev_b32 v7, 16, v86
    v_and_b32 v8, 0xffff0000, v86
    v_add_f32 v28, v28, v7
    v_add_f32 v29, v29, v8
    v_cvt_pk_bf16_f32 v102, v28, v29
    v_cvt_pk_bf16_f32 v6, v30, v31
    v_lshlrev_b32 v30, 16, v6
    v_and_b32 v31, 0xffff0000, v6
    v_lshlrev_b32 v7, 16, v87
    v_and_b32 v8, 0xffff0000, v87
    v_add_f32 v30, v30, v7
    v_add_f32 v31, v31, v8
    v_cvt_pk_bf16_f32 v103, v30, v31
    s_add_u32 s21, s19, 11370496
    buffer_store_dwordx4 v[96:99], v1, s[8:11], s21 offen
    buffer_store_dwordx4 v[100:103], v1, s[8:11], s21 offen offset:1024
    s_nop 11
K2_END_0:
    s_endpgm
.globl ffa0_kernel
.p2align 8
.type ffa0_kernel,@function
ffa0_kernel:
    s_load_dwordx2 s[6:7], s[0:1], 48
    s_load_dwordx2 s[4:5], s[0:1], 88
    s_cmp_ge_u32 s2, 224
    s_cbranch_scc1 K3_END_11370496
    v_lshrrev_b32 v1, 6, v0
    v_and_b32 v0, 63, v0
    v_readfirstlane_b32 s3, v1
    v_lshlrev_b32 v1, 4, v0
    v_and_b32 v2, 15, v0
    v_lshrrev_b32 v3, 4, v0
    s_waitcnt lgkmcnt(0)
    s_mov_b32 s8, s4
    s_and_b32 s9, s5, 0xffff
    s_mov_b32 s10, 0x10000000
    s_mov_b32 s11, 0x00020000
    s_mov_b32 s24, s6
    s_and_b32 s25, s7, 0xffff
    s_mov_b32 s26, 0xe00
    s_mov_b32 s27, 0x00020000
    s_and_b32 s14, s2, 7
    s_lshr_b32 s15, s2, 3
    s_and_b32 s12, s14, 1
    s_mul_i32 s12, s12, 7
    s_lshr_b32 s16, s15, 2
    s_add_u32 s12, s12, s16
    s_lshr_b32 s13, s14, 1
    s_lshl_b32 s13, s13, 2
    s_and_b32 s16, s15, 3
    s_add_u32 s13, s13, s16
    s_mul_i32 s16, s12, 114688
    s_add_u32 s16, s16, 3702784
    s_lshl_b32 s17, s13, 3
    s_add_u32 s17, s17, s3
    s_mov_b32 s30, s17
    s_mul_i32 s17, s17, 14336
    s_add_u32 s17, s17, 11370496
    s_lshl_b32 s20, s12, 8
    v_lshl_add_u32 v5, v3, 3, s20
    buffer_load_dwordx2 v[150:151], v5, s[24:27], 0 offen offset:0
    buffer_load_dwordx2 v[152:153], v5, s[24:27], 0 offen offset:32
    buffer_load_dwordx2 v[154:155], v5, s[24:27], 0 offen offset:64
    buffer_load_dwordx2 v[156:157], v5, s[24:27], 0 offen offset:96
    buffer_load_dwordx2 v[158:159], v5, s[24:27], 0 offen offset:128
    buffer_load_dwordx2 v[160:161], v5, s[24:27], 0 offen offset:160
    buffer_load_dwordx2 v[162:163], v5, s[24:27], 0 offen offset:192
    buffer_load_dwordx2 v[164:165], v5, s[24:27], 0 offen offset:224
    v_mov_b32 v104, 0x3f803f80
    v_mov_b32 v105, 0x3f803f80
    v_mov_b32 v106, 0x3f803f80
    v_mov_b32 v107, 0x3f803f80
    s_add_u32 s19, s3, 0
    s_add_u32 s19, s19, 0
    s_lshl_b32 s19, s19, 10
    s_mov_b32 m0, s19
    s_add_u32 s19, s19, s16
    buffer_load_dwordx4 v1, s[8:11], s19 offen lds
    s_add_u32 s19, s3, 8
    s_add_u32 s19, s19, 0
    s_lshl_b32 s19, s19, 10
    s_mov_b32 m0, s19
    s_add_u32 s19, s19, s16
    buffer_load_dwordx4 v1, s[8:11], s19 offen lds
    s_add_u32 s19, s3, 16
    s_add_u32 s19, s19, 0
    s_lshl_b32 s19, s19, 10
    s_mov_b32 m0, s19
    s_add_u32 s19, s19, s16
    buffer_load_dwordx4 v1, s[8:11], s19 offen lds
    s_add_u32 s19, s3, 24
    s_add_u32 s19, s19, 0
    s_lshl_b32 s19, s19, 10
    s_mov_b32 m0, s19
    s_add_u32 s19, s19, s16
    buffer_load_dwordx4 v1, s[8:11], s19 offen lds
    s_add_u32 s19, s17, 0
    buffer_load_dwordx4 v[16:19], v1, s[8:11], s19 offen
    s_add_u32 s19, s17, 1024
    buffer_load_dwordx4 v[20:23], v1, s[8:11], s19 offen
    s_add_u32 s19, s17, 2048
    buffer_load_dwordx4 v[24:27], v1, s[8:11], s19 offen
    s_add_u32 s19, s17, 3072
    buffer_load_dwordx4 v[28:31], v1, s[8:11], s19 offen
    s_add_u32 s19, s3, 0
    s_add_u32 s19, s19, 32
    s_lshl_b32 s19, s19, 10
    s_mov_b32 m0, s19
    s_add_u32 s19, s19, s16
    buffer_load_dwordx4 v1, s[8:11], s19 offen lds
    s_add_u32 s19, s3, 8
    s_add_u32 s19, s19, 32
    s_lshl_b32 s19, s19, 10
    s_mov_b32 m0, s19
    s_add_u32 s19, s19, s16
    buffer_load_dwordx4 v1, s[8:11], s19 offen lds
    s_add_u32 s19, s3, 16
    s_add_u32 s19, s19, 32
    s_lshl_b32 s19, s19, 10
    s_mov_b32 m0, s19
    s_add_u32 s19, s19, s16
    buffer_load_dwordx4 v1, s[8:11], s19 offen lds
    s_add_u32 s19, s3, 24
    s_add_u32 s19, s19, 32
    s_lshl_b32 s19, s19, 10
    s_mov_b32 m0, s19
    s_add_u32 s19, s19, s16
    buffer_load_dwordx4 v1, s[8:11], s19 offen lds
    s_add_u32 s19, s17, 4096
    buffer_load_dwordx4 v[32:35], v1, s[8:11], s19 offen
    s_add_u32 s19, s17, 5120
    buffer_load_dwordx4 v[36:39], v1, s[8:11], s19 offen
    s_add_u32 s19, s17, 6144
    buffer_load_dwordx4 v[40:43], v1, s[8:11], s19 offen
    s_add_u32 s19, s17, 7168
    buffer_load_dwordx4 v[44:47], v1, s[8:11], s19 offen
    v_add_u32 v4, 0x10000, v1
    s_min_u32 s19, s3, 7
    s_lshl_b32 s19, s19, 10
    v_add_u32 v5, s19, v1
    v_add_u32 v6, 0x10000, v5
    s_waitcnt vmcnt(8)
    s_barrier
    ds_read_b128 a[0:3], v1 offset:0
    ds_read_b128 a[4:7], v1 offset:1024
    ds_read_b128 a[8:11], v1 offset:2048
    ds_read_b128 a[12:15], v1 offset:3072
    ds_read_b128 a[16:19], v1 offset:4096
    ds_read_b128 a[20:23], v1 offset:5120
    ds_read_b128 a[24:27], v1 offset:6144
    ds_read_b128 a[28:31], v1 offset:7168
    ds_read_b128 a[64:67], v5 offset:0
    ds_read_b128 a[32:35], v1 offset:8192
    ds_read_b128 a[36:39], v1 offset:9216
    ds_read_b128 a[40:43], v1 offset:10240
    ds_read_b128 a[44:47], v1 offset:11264
    ds_read_b128 a[48:51], v1 offset:12288
    ds_read_b128 a[52:55], v1 offset:13312
    ds_read_b128 a[56:59], v1 offset:14336
    ds_read_b128 a[60:63], v1 offset:15360
    ds_read_b128 a[68:71], v5 offset:8192
    s_waitcnt lgkmcnt(9)
    v_mfma_f32_16x16x32_bf16 v[72:75], a[0:3], v[16:19], 0
    v_mfma_f32_16x16x32_bf16 v[76:79], a[4:7], v[16:19], 0
    v_mfma_f32_16x16x32_bf16 v[80:83], a[8:11], v[16:19], 0
    v_mfma_f32_16x16x32_bf16 v[84:87], a[12:15], v[16:19], 0
    v_mfma_f32_16x16x32_bf16 v[88:91], a[16:19], v[16:19], 0
    v_mfma_f32_16x16x32_bf16 v[92:95], a[20:23], v[16:19], 0
    v_mfma_f32_16x16x32_bf16 v[96:99], a[24:27], v[16:19], 0
    v_mfma_f32_16x16x32_bf16 v[100:103], a[28:31], v[16:19], 0
    v_mfma_f32_16x16x32_bf16 v[110:113], a[64:67], v[104:107], 0
    v_dot2_f32_bf16 v108, v16, v104, 0
    v_dot2_f32_bf16 v109, v16, v16, 0
    v_dot2_f32_bf16 v108, v17, v104, v108
    v_dot2_f32_bf16 v109, v17, v17, v109
    v_dot2_f32_bf16 v108, v18, v104, v108
    v_dot2_f32_bf16 v109, v18, v18, v109
    v_dot2_f32_bf16 v108, v19, v104, v108
    v_dot2_f32_bf16 v109, v19, v19, v109
    ds_read_b128 a[0:3], v1 offset:16384
    ds_read_b128 a[4:7], v1 offset:17408
    ds_read_b128 a[8:11], v1 offset:18432
    ds_read_b128 a[12:15], v1 offset:19456
    ds_read_b128 a[16:19], v1 offset:20480
    ds_read_b128 a[20:23], v1 offset:21504
    ds_read_b128 a[24:27], v1 offset:22528
    ds_read_b128 a[28:31], v1 offset:23552
    ds_read_b128 a[64:67], v5 offset:16384
    s_waitcnt lgkmcnt(9)
    v_mfma_f32_16x16x32_bf16 v[72:75], a[32:35], v[20:23], v[72:75]
    v_mfma_f32_16x16x32_bf16 v[76:79], a[36:39], v[20:23], v[76:79]
    v_mfma_f32_16x16x32_bf16 v[80:83], a[40:43], v[20:23], v[80:83]
    v_mfma_f32_16x16x32_bf16 v[84:87], a[44:47], v[20:23], v[84:87]
    v_mfma_f32_16x16x32_bf16 v[88:91], a[48:51], v[20:23], v[88:91]
    v_mfma_f32_16x16x32_bf16 v[92:95], a[52:55], v[20:23], v[92:95]
    v_mfma_f32_16x16x32_bf16 v[96:99], a[56:59], v[20:23], v[96:99]
    v_mfma_f32_16x16x32_bf16 v[100:103], a[60:63], v[20:23], v[100:103]
    v_mfma_f32_16x16x32_bf16 v[110:113], a[68:71], v[104:107], v[110:113]
    v_dot2_f32_bf16 v108, v20, v104, v108
    v_dot2_f32_bf16 v109, v20, v20, v109
    v_dot2_f32_bf16 v108, v21, v104, v108
    v_dot2_f32_bf16 v109, v21, v21, v109
    v_dot2_f32_bf16 v108, v22, v104, v108
    v_dot2_f32_bf16 v109, v22, v22, v109
    v_dot2_f32_bf16 v108, v23, v104, v108
    v_dot2_f32_bf16 v109, v23, v23, v109
    ds_read_b128 a[32:35], v1 offset:24576
    ds_read_b128 a[36:39], v1 offset:25600
    ds_read_b128 a[40:43], v1 offset:26624
    ds_read_b128 a[44:47], v1 offset:27648
    ds_read_b128 a[48:51], v1 offset:28672
    ds_read_b128 a[52:55], v1 offset:29696
    ds_read_b128 a[56:59], v1 offset:30720
    ds_read_b128 a[60:63], v1 offset:31744
    ds_read_b128 a[68:71], v5 offset:24576
    s_waitcnt lgkmcnt(9)
    v_mfma_f32_16x16x32_bf16 v[72:75], a[0:3], v[24:27], v[72:75]
    v_mfma_f32_16x16x32_bf16 v[76:79], a[4:7], v[24:27], v[76:79]
    v_mfma_f32_16x16x32_bf16 v[80:83], a[8:11], v[24:27], v[80:83]
    v_mfma_f32_16x16x32_bf16 v[84:87], a[12:15], v[24:27], v[84:87]
    v_mfma_f32_16x16x32_bf16 v[88:91], a[16:19], v[24:27], v[88:91]
    v_mfma_f32_16x16x32_bf16 v[92:95], a[20:23], v[24:27], v[92:95]
    v_mfma_f32_16x16x32_bf16 v[96:99], a[24:27], v[24:27], v[96:99]
    v_mfma_f32_16x16x32_bf16 v[100:103], a[28:31], v[24:27], v[100:103]
    v_mfma_f32_16x16x32_bf16 v[110:113], a[64:67], v[104:107], v[110:113]
    v_dot2_f32_bf16 v108, v24, v104, v108
    v_dot2_f32_bf16 v109, v24, v24, v109
    v_dot2_f32_bf16 v108, v25, v104, v108
    v_dot2_f32_bf16 v109, v25, v25, v109
    v_dot2_f32_bf16 v108, v26, v104, v108
    v_dot2_f32_bf16 v109, v26, v26, v109
    v_dot2_f32_bf16 v108, v27, v104, v108
    v_dot2_f32_bf16 v109, v27, v27, v109
    s_waitcnt vmcnt(0)
    s_barrier
    s_add_u32 s19, s3, 0
    s_add_u32 s19, s19, 64
    s_lshl_b32 s19, s19, 10
    s_mov_b32 m0, s19
    s_add_u32 s19, s19, s16
    buffer_load_dwordx4 v1, s[8:11], s19 offen lds
    s_add_u32 s19, s3, 8
    s_add_u32 s19, s19, 64
    s_lshl_b32 s19, s19, 10
    s_mov_b32 m0, s19
    s_add_u32 s19, s19, s16
    buffer_load_dwordx4 v1, s[8:11], s19 offen lds
    s_add_u32 s19, s3, 16
    s_add_u32 s19, s19, 64
    s_lshl_b32 s19, s19, 10
    s_mov_b32 m0, s19
    s_add_u32 s19, s19, s16
    buffer_load_dwordx4 v1, s[8:11], s19 offen lds
    s_add_u32 s19, s3, 24
    s_add_u32 s19, s19, 64
    s_lshl_b32 s19, s19, 10
    s_mov_b32 m0, s19
    s_add_u32 s19, s19, s16
    buffer_load_dwordx4 v1, s[8:11], s19 offen lds
    s_add_u32 s19, s17, 8192
    buffer_load_dwordx4 v[48:51], v1, s[8:11], s19 offen
    s_add_u32 s19, s17, 9216
    buffer_load_dwordx4 v[52:55], v1, s[8:11], s19 offen
    s_add_u32 s19, s17, 10240
    buffer_load_dwordx4 v[56:59], v1, s[8:11], s19 offen
    s_add_u32 s19, s17, 11264
    buffer_load_dwordx4 v[60:63], v1, s[8:11], s19 offen
    ds_read_b128 a[0:3], v1 offset:32768
    ds_read_b128 a[4:7], v1 offset:33792
    ds_read_b128 a[8:11], v1 offset:34816
    ds_read_b128 a[12:15], v1 offset:35840
    ds_read_b128 a[16:19], v1 offset:36864
    ds_read_b128 a[20:23], v1 offset:37888
    ds_read_b128 a[24:27], v1 offset:38912
    ds_read_b128 a[28:31], v1 offset:39936
    ds_read_b128 a[64:67], v5 offset:32768
    s_waitcnt lgkmcnt(9)
    v_mfma_f32_16x16x32_bf16 v[72:75], a[32:35], v[28:31], v[72:75]
    v_mfma_f32_16x16x32_bf16 v[76:79], a[36:39], v[28:31], v[76:79]
    v_mfma_f32_16x16x32_bf16 v[80:83], a[40:43], v[28:31], v[80:83]
    v_mfma_f32_16x16x32_bf16 v[84:87], a[44:47], v[28:31], v[84:87]
    v_mfma_f32_16x16x32_bf16 v[88:91], a[48:51], v[28:31], v[88:91]
    v_mfma_f32_16x16x32_bf16 v[92:95], a[52:55], v[28:31], v[92:95]
    v_mfma_f32_16x16x32_bf16 v[96:99], a[56:59], v[28:31], v[96:99]
    v_mfma_f32_16x16x32_bf16 v[100:103], a[60:63], v[28:31], v[100:103]
    v_mfma_f32_16x16x32_bf16 v[110:113], a[68:71], v[104:107], v[110:113]
    v_dot2_f32_bf16 v108, v28, v104, v108
    v_dot2_f32_bf16 v109, v28, v28, v109
    v_dot2_f32_bf16 v108, v29, v104, v108
    v_dot2_f32_bf16 v109, v29, v29, v109
    v_dot2_f32_bf16 v108, v30, v104, v108
    v_dot2_f32_bf16 v109, v30, v30, v109
    v_dot2_f32_bf16 v108, v31, v104, v108
    v_dot2_f32_bf16 v109, v31, v31, v109
    ds_read_b128 a[32:35], v1 offset:40960
    ds_read_b128 a[36:39], v1 offset:41984
    ds_read_b128 a[40:43], v1 offset:43008
    ds_read_b128 a[44:47], v1 offset:44032
    ds_read_b128 a[48:51], v1 offset:45056
    ds_read_b128 a[52:55], v1 offset:46080
    ds_read_b128 a[56:59], v1 offset:47104
    ds_read_b128 a[60:63], v1 offset:48128
    ds_read_b128 a[68:71], v5 offset:40960
    s_waitcnt lgkmcnt(9)
    v_mfma_f32_16x16x32_bf16 v[72:75], a[0:3], v[32:35], v[72:75]
    v_mfma_f32_16x16x32_bf16 v[76:79], a[4:7], v[32:35], v[76:79]
    v_mfma_f32_16x16x32_bf16 v[80:83], a[8:11], v[32:35], v[80:83]
    v_mfma_f32_16x16x32_bf16 v[84:87], a[12:15], v[32:35], v[84:87]
    v_mfma_f32_16x16x32_bf16 v[88:91], a[16:19], v[32:35], v[88:91]
    v_mfma_f32_16x16x32_bf16 v[92:95], a[20:23], v[32:35], v[92:95]
    v_mfma_f32_16x16x32_bf16 v[96:99], a[24:27], v[32:35], v[96:99]
    v_mfma_f32_16x16x32_bf16 v[100:103], a[28:31], v[32:35], v[100:103]
    v_mfma_f32_16x16x32_bf16 v[110:113], a[64:67], v[104:107], v[110:113]
    v_dot2_f32_bf16 v108, v32, v104, v108
    v_dot2_f32_bf16 v109, v32, v32, v109
    v_dot2_f32_bf16 v108, v33, v104, v108
    v_dot2_f32_bf16 v109, v33, v33, v109
    v_dot2_f32_bf16 v108, v34, v104, v108
    v_dot2_f32_bf16 v109, v34, v34, v109
    v_dot2_f32_bf16 v108, v35, v104, v108
    v_dot2_f32_bf16 v109, v35, v35, v109
    ds_read_b128 a[0:3], v1 offset:49152
    ds_read_b128 a[4:7], v1 offset:50176
    ds_read_b128 a[8:11], v1 offset:51200
    ds_read_b128 a[12:15], v1 offset:52224
    ds_read_b128 a[16:19], v1 offset:53248
    ds_read_b128 a[20:23], v1 offset:54272
    ds_read_b128 a[24:27], v1 offset:55296
    ds_read_b128 a[28:31], v1 offset:56320
    ds_read_b128 a[64:67], v5 offset:49152
    s_waitcnt lgkmcnt(9)
    v_mfma_f32_16x16x32_bf16 v[72:75], a[32:35], v[36:39], v[72:75]
    v_mfma_f32_16x16x32_bf16 v[76:79], a[36:39], v[36:39], v[76:79]
    v_mfma_f32_16x16x32_bf16 v[80:83], a[40:43], v[36:39], v[80:83]
    v_mfma_f32_16x16x32_bf16 v[84:87], a[44:47], v[36:39], v[84:87]
    v_mfma_f32_16x16x32_bf16 v[88:91], a[48:51], v[36:39], v[88:91]
    v_mfma_f32_16x16x32_bf16 v[92:95], a[52:55], v[36:39], v[92:95]
    v_mfma_f32_16x16x32_bf16 v[96:99], a[56:59], v[36:39], v[96:99]
    v_mfma_f32_16x16x32_bf16 v[100:103], a[60:63], v[36:39], v[100:103]
    v_mfma_f32_16x16x32_bf16 v[110:113], a[68:71], v[104:107], v[110:113]
    v_dot2_f32_bf16 v108, v36, v104, v108
    v_dot2_f32_bf16 v109, v36, v36, v109
    v_dot2_f32_bf16 v108, v37, v104, v108
    v_dot2_f32_bf16 v109, v37, v37, v109
    v_dot2_f32_bf16 v108, v38, v104, v108
    v_dot2_f32_bf16 v109, v38, v38, v109
    v_dot2_f32_bf16 v108, v39, v104, v108
    v_dot2_f32_bf16 v109, v39, v39, v109
    ds_read_b128 a[32:35], v1 offset:57344
    ds_read_b128 a[36:39], v1 offset:58368
    ds_read_b128 a[40:43], v1 offset:59392
    ds_read_b128 a[44:47], v1 offset:60416
    ds_read_b128 a[48:51], v1 offset:61440
    ds_read_b128 a[52:55], v1 offset:62464
    ds_read_b128 a[56:59], v1 offset:63488
    ds_read_b128 a[60:63], v1 offset:64512
    ds_read_b128 a[68:71], v5 offset:57344
    s_waitcnt lgkmcnt(9)
    v_mfma_f32_16x16x32_bf16 v[72:75], a[0:3], v[40:43], v[72:75]
    v_mfma_f32_16x16x32_bf16 v[76:79], a[4:7], v[40:43], v[76:79]
    v_mfma_f32_16x16x32_bf16 v[80:83], a[8:11], v[40:43], v[80:83]
    v_mfma_f32_16x16x32_bf16 v[84:87], a[12:15], v[40:43], v[84:87]
    v_mfma_f32_16x16x32_bf16 v[88:91], a[16:19], v[40:43], v[88:91]
    v_mfma_f32_16x16x32_bf16 v[92:95], a[20:23], v[40:43], v[92:95]
    v_mfma_f32_16x16x32_bf16 v[96:99], a[24:27], v[40:43], v[96:99]
    v_mfma_f32_16x16x32_bf16 v[100:103], a[28:31], v[40:43], v[100:103]
    v_mfma_f32_16x16x32_bf16 v[110:113], a[64:67], v[104:107], v[110:113]
    v_dot2_f32_bf16 v108, v40, v104, v108
    v_dot2_f32_bf16 v109, v40, v40, v109
    v_dot2_f32_bf16 v108, v41, v104, v108
    v_dot2_f32_bf16 v109, v41, v41, v109
    v_dot2_f32_bf16 v108, v42, v104, v108
    v_dot2_f32_bf16 v109, v42, v42, v109
    v_dot2_f32_bf16 v108, v43, v104, v108
    v_dot2_f32_bf16 v109, v43, v43, v109
    s_waitcnt vmcnt(0)
    s_barrier
    s_add_u32 s19, s3, 0
    s_add_u32 s19, s19, 96
    s_lshl_b32 s19, s19, 10
    s_mov_b32 m0, s19
    s_add_u32 s19, s19, s16
    buffer_load_dwordx4 v1, s[8:11], s19 offen lds
    s_add_u32 s19, s3, 8
    s_add_u32 s19, s19, 96
    s_lshl_b32 s19, s19, 10
    s_mov_b32 m0, s19
    s_add_u32 s19, s19, s16
    buffer_load_dwordx4 v1, s[8:11], s19 offen lds
    s_add_u32 s19, s17, 12288
    buffer_load_dwordx4 v[64:67], v1, s[8:11], s19 offen
    s_add_u32 s19, s17, 13312
    buffer_load_dwordx4 v[68:71], v1, s[8:11], s19 offen
    ds_read_b128 a[0:3], v4 offset:0
    ds_read_b128 a[4:7], v4 offset:1024
    ds_read_b128 a[8:11], v4 offset:2048
    ds_read_b128 a[12:15], v4 offset:3072
    ds_read_b128 a[16:19], v4 offset:4096
    ds_read_b128 a[20:23], v4 offset:5120
    ds_read_b128 a[24:27], v4 offset:6144
    ds_read_b128 a[28:31], v4 offset:7168
    ds_read_b128 a[64:67], v6 offset:0
    s_waitcnt lgkmcnt(9)
    v_mfma_f32_16x16x32_bf16 v[72:75], a[32:35], v[44:47], v[72:75]
    v_mfma_f32_16x16x32_bf16 v[76:79], a[36:39], v[44:47], v[76:79]
    v_mfma_f32_16x16x32_bf16 v[80:83], a[40:43], v[44:47], v[80:83]
    v_mfma_f32_16x16x32_bf16 v[84:87], a[44:47], v[44:47], v[84:87]
    v_mfma_f32_16x16x32_bf16 v[88:91], a[48:51], v[44:47], v[88:91]
    v_mfma_f32_16x16x32_bf16 v[92:95], a[52:55], v[44:47], v[92:95]
    v_mfma_f32_16x16x32_bf16 v[96:99], a[56:59], v[44:47], v[96:99]
    v_mfma_f32_16x16x32_bf16 v[100:103], a[60:63], v[44:47], v[100:103]
    v_mfma_f32_16x16x32_bf16 v[110:113], a[68:71], v[104:107], v[110:113]
    v_dot2_f32_bf16 v108, v44, v104, v108
    v_dot2_f32_bf16 v109, v44, v44, v109
    v_dot2_f32_bf16 v108, v45, v104, v108
    v_dot2_f32_bf16 v109, v45, v45, v109
    v_dot2_f32_bf16 v108, v46, v104, v108
    v_dot2_f32_bf16 v109, v46, v46, v109
    v_dot2_f32_bf16 v108, v47, v104, v108
    v_dot2_f32_bf16 v109, v47, v47, v109
    ds_read_b128 a[32:35], v4 offset:8192
    ds_read_b128 a[36:39], v4 offset:9216
    ds_read_b128 a[40:43], v4 offset:10240
    ds_read_b128 a[44:47], v4 offset:11264
    ds_read_b128 a[48:51], v4 offset:12288
    ds_read_b128 a[52:55], v4 offset:13312
    ds_read_b128 a[56:59], v4 offset:14336
    ds_read_b128 a[60:63], v4 offset:15360
    ds_read_b128 a[68:71], v6 offset:8192
    s_waitcnt lgkmcnt(9)
    v_mfma_f32_16x16x32_bf16 v[72:75], a[0:3], v[48:51], v[72:75]
    v_mfma_f32_16x16x32_bf16 v[76:79], a[4:7], v[48:51], v[76:79]
    v_mfma_f32_16x16x32_bf16 v[80:83], a[8:11], v[48:51], v[80:83]
    v_mfma_f32_16x16x32_bf16 v[84:87], a[12:15], v[48:51], v[84:87]
    v_mfma_f32_16x16x32_bf16 v[88:91], a[16:19], v[48:51], v[88:91]
    v_mfma_f32_16x16x32_bf16 v[92:95], a[20:23], v[48:51], v[92:95]
    v_mfma_f32_16x16x32_bf16 v[96:99], a[24:27], v[48:51], v[96:99]
    v_mfma_f32_16x16x32_bf16 v[100:103], a[28:31], v[48:51], v[100:103]
    v_mfma_f32_16x16x32_bf16 v[110:113], a[64:67], v[104:107], v[110:113]
    v_dot2_f32_bf16 v108, v48, v104, v108
    v_dot2_f32_bf16 v109, v48, v48, v109
    v_dot2_f32_bf16 v108, v49, v104, v108
    v_dot2_f32_bf16 v109, v49, v49, v109
    v_dot2_f32_bf16 v108, v50, v104, v108
    v_dot2_f32_bf16 v109, v50, v50, v109
    v_dot2_f32_bf16 v108, v51, v104, v108
    v_dot2_f32_bf16 v109, v51, v51, v109
    ds_read_b128 a[0:3], v4 offset:16384
    ds_read_b128 a[4:7], v4 offset:17408
    ds_read_b128 a[8:11], v4 offset:18432
    ds_read_b128 a[12:15], v4 offset:19456
    ds_read_b128 a[16:19], v4 offset:20480
    ds_read_b128 a[20:23], v4 offset:21504
    ds_read_b128 a[24:27], v4 offset:22528
    ds_read_b128 a[28:31], v4 offset:23552
    ds_read_b128 a[64:67], v6 offset:16384
    s_waitcnt lgkmcnt(9)
    v_mfma_f32_16x16x32_bf16 v[72:75], a[32:35], v[52:55], v[72:75]
    v_mfma_f32_16x16x32_bf16 v[76:79], a[36:39], v[52:55], v[76:79]
    v_mfma_f32_16x16x32_bf16 v[80:83], a[40:43], v[52:55], v[80:83]
    v_mfma_f32_16x16x32_bf16 v[84:87], a[44:47], v[52:55], v[84:87]
    v_mfma_f32_16x16x32_bf16 v[88:91], a[48:51], v[52:55], v[88:91]
    v_mfma_f32_16x16x32_bf16 v[92:95], a[52:55], v[52:55], v[92:95]
    v_mfma_f32_16x16x32_bf16 v[96:99], a[56:59], v[52:55], v[96:99]
    v_mfma_f32_16x16x32_bf16 v[100:103], a[60:63], v[52:55], v[100:103]
    v_mfma_f32_16x16x32_bf16 v[110:113], a[68:71], v[104:107], v[110:113]
    v_dot2_f32_bf16 v108, v52, v104, v108
    v_dot2_f32_bf16 v109, v52, v52, v109
    v_dot2_f32_bf16 v108, v53, v104, v108
    v_dot2_f32_bf16 v109, v53, v53, v109
    v_dot2_f32_bf16 v108, v54, v104, v108
    v_dot2_f32_bf16 v109, v54, v54, v109
    v_dot2_f32_bf16 v108, v55, v104, v108
    v_dot2_f32_bf16 v109, v55, v55, v109
    ds_read_b128 a[32:35], v4 offset:24576
    ds_read_b128 a[36:39], v4 offset:25600
    ds_read_b128 a[40:43], v4 offset:26624
    ds_read_b128 a[44:47], v4 offset:27648
    ds_read_b128 a[48:51], v4 offset:28672
    ds_read_b128 a[52:55], v4 offset:29696
    ds_read_b128 a[56:59], v4 offset:30720
    ds_read_b128 a[60:63], v4 offset:31744
    ds_read_b128 a[68:71], v6 offset:24576
    s_waitcnt lgkmcnt(9)
    v_mfma_f32_16x16x32_bf16 v[72:75], a[0:3], v[56:59], v[72:75]
    v_mfma_f32_16x16x32_bf16 v[76:79], a[4:7], v[56:59], v[76:79]
    v_mfma_f32_16x16x32_bf16 v[80:83], a[8:11], v[56:59], v[80:83]
    v_mfma_f32_16x16x32_bf16 v[84:87], a[12:15], v[56:59], v[84:87]
    v_mfma_f32_16x16x32_bf16 v[88:91], a[16:19], v[56:59], v[88:91]
    v_mfma_f32_16x16x32_bf16 v[92:95], a[20:23], v[56:59], v[92:95]
    v_mfma_f32_16x16x32_bf16 v[96:99], a[24:27], v[56:59], v[96:99]
    v_mfma_f32_16x16x32_bf16 v[100:103], a[28:31], v[56:59], v[100:103]
    v_mfma_f32_16x16x32_bf16 v[110:113], a[64:67], v[104:107], v[110:113]
    v_dot2_f32_bf16 v108, v56, v104, v108
    v_dot2_f32_bf16 v109, v56, v56, v109
    v_dot2_f32_bf16 v108, v57, v104, v108
    v_dot2_f32_bf16 v109, v57, v57, v109
    v_dot2_f32_bf16 v108, v58, v104, v108
    v_dot2_f32_bf16 v109, v58, v58, v109
    v_dot2_f32_bf16 v108, v59, v104, v108
    v_dot2_f32_bf16 v109, v59, v59, v109
    s_waitcnt vmcnt(0)
    s_barrier
    ds_read_b128 a[0:3], v4 offset:32768
    ds_read_b128 a[4:7], v4 offset:33792
    ds_read_b128 a[8:11], v4 offset:34816
    ds_read_b128 a[12:15], v4 offset:35840
    ds_read_b128 a[16:19], v4 offset:36864
    ds_read_b128 a[20:23], v4 offset:37888
    ds_read_b128 a[24:27], v4 offset:38912
    ds_read_b128 a[28:31], v4 offset:39936
    ds_read_b128 a[64:67], v6 offset:32768
    s_waitcnt lgkmcnt(9)
    v_mfma_f32_16x16x32_bf16 v[72:75], a[32:35], v[60:63], v[72:75]
    v_mfma_f32_16x16x32_bf16 v[76:79], a[36:39], v[60:63], v[76:79]
    v_mfma_f32_16x16x32_bf16 v[80:83], a[40:43], v[60:63], v[80:83]
    v_mfma_f32_16x16x32_bf16 v[84:87], a[44:47], v[60:63], v[84:87]
    v_mfma_f32_16x16x32_bf16 v[88:91], a[48:51], v[60:63], v[88:91]
    v_mfma_f32_16x16x32_bf16 v[92:95], a[52:55], v[60:63], v[92:95]
    v_mfma_f32_16x16x32_bf16 v[96:99], a[56:59], v[60:63], v[96:99]
    v_mfma_f32_16x16x32_bf16 v[100:103], a[60:63], v[60:63], v[100:103]
    v_mfma_f32_16x16x32_bf16 v[110:113], a[68:71], v[104:107], v[110:113]
    v_dot2_f32_bf16 v108, v60, v104, v108
    v_dot2_f32_bf16 v109, v60, v60, v109
    v_dot2_f32_bf16 v108, v61, v104, v108
    v_dot2_f32_bf16 v109, v61, v61, v109
    v_dot2_f32_bf16 v108, v62, v104, v108
    v_dot2_f32_bf16 v109, v62, v62, v109
    v_dot2_f32_bf16 v108, v63, v104, v108
    v_dot2_f32_bf16 v109, v63, v63, v109
    ds_read_b128 a[32:35], v4 offset:40960
    ds_read_b128 a[36:39], v4 offset:41984
    ds_read_b128 a[40:43], v4 offset:43008
    ds_read_b128 a[44:47], v4 offset:44032
    ds_read_b128 a[48:51], v4 offset:45056
    ds_read_b128 a[52:55], v4 offset:46080
    ds_read_b128 a[56:59], v4 offset:47104
    ds_read_b128 a[60:63], v4 offset:48128
    ds_read_b128 a[68:71], v6 offset:40960
    s_waitcnt lgkmcnt(9)
    v_mfma_f32_16x16x32_bf16 v[72:75], a[0:3], v[64:67], v[72:75]
    v_mfma_f32_16x16x32_bf16 v[76:79], a[4:7], v[64:67], v[76:79]
    v_mfma_f32_16x16x32_bf16 v[80:83], a[8:11], v[64:67], v[80:83]
    v_mfma_f32_16x16x32_bf16 v[84:87], a[12:15], v[64:67], v[84:87]
    v_mfma_f32_16x16x32_bf16 v[88:91], a[16:19], v[64:67], v[88:91]
    v_mfma_f32_16x16x32_bf16 v[92:95], a[20:23], v[64:67], v[92:95]
    v_mfma_f32_16x16x32_bf16 v[96:99], a[24:27], v[64:67], v[96:99]
    v_mfma_f32_16x16x32_bf16 v[100:103], a[28:31], v[64:67], v[100:103]
    v_mfma_f32_16x16x32_bf16 v[110:113], a[64:67], v[104:107], v[110:113]
    v_dot2_f32_bf16 v108, v64, v104, v108
    v_dot2_f32_bf16 v109, v64, v64, v109
    v_dot2_f32_bf16 v108, v65, v104, v108
    v_dot2_f32_bf16 v109, v65, v65, v109
    v_dot2_f32_bf16 v108, v66, v104, v108
    v_dot2_f32_bf16 v109, v66, v66, v109
    v_dot2_f32_bf16 v108, v67, v104, v108
    v_dot2_f32_bf16 v109, v67, v67, v109
    s_waitcnt lgkmcnt(0)
    v_mfma_f32_16x16x32_bf16 v[72:75], a[32:35], v[68:71], v[72:75]
    v_mfma_f32_16x16x32_bf16 v[76:79], a[36:39], v[68:71], v[76:79]
    v_mfma_f32_16x16x32_bf16 v[80:83], a[40:43], v[68:71], v[80:83]
    v_mfma_f32_16x16x32_bf16 v[84:87], a[44:47], v[68:71], v[84:87]
    v_mfma_f32_16x16x32_bf16 v[88:91], a[48:51], v[68:71], v[88:91]
    v_mfma_f32_16x16x32_bf16 v[92:95], a[52:55], v[68:71], v[92:95]
    v_mfma_f32_16x16x32_bf16 v[96:99], a[56:59], v[68:71], v[96:99]
    v_mfma_f32_16x16x32_bf16 v[100:103], a[60:63], v[68:71], v[100:103]
    v_mfma_f32_16x16x32_bf16 v[110:113], a[68:71], v[104:107], v[110:113]
    v_dot2_f32_bf16 v108, v68, v104, v108
    v_dot2_f32_bf16 v109, v68, v68, v109
    v_dot2_f32_bf16 v108, v69, v104, v108
    v_dot2_f32_bf16 v109, v69, v69, v109
    v_dot2_f32_bf16 v108, v70, v104, v108
    v_dot2_f32_bf16 v109, v70, v70, v109
    v_dot2_f32_bf16 v108, v71, v104, v108
    v_dot2_f32_bf16 v109, v71, v71, v109
    s_min_u32 s19, s3, 7
    s_lshl_b32 s19, s19, 10
    v_add_u32 v5, s19, v1
    ds_write_b128 v6, v[110:113] offset:49152
    v_mov_b32 v7, v108
    s_nop 1
    v_permlane16_swap_b32 v108, v7
    v_add_f32 v108, v108, v7
    v_mov_b32 v7, v108
    s_nop 1
    v_permlane32_swap_b32 v108, v7
    v_add_f32 v108, v108, v7
    v_mov_b32 v7, v109
    s_nop 1
    v_permlane16_swap_b32 v109, v7
    v_add_f32 v109, v109, v7
    v_mov_b32 v7, v109
    s_nop 1
    v_permlane32_swap_b32 v109, v7
    v_add_f32 v109, v109, v7
    s_waitcnt lgkmcnt(0)
    s_barrier
    ds_read_b128 v[114:117], v4 offset:49152
    ds_read_b128 v[118:121], v4 offset:50176
    ds_read_b128 v[122:125], v4 offset:51200
    ds_read_b128 v[126:129], v4 offset:52224
    ds_read_b128 v[130:133], v4 offset:53248
    ds_read_b128 v[134:137], v4 offset:54272
    ds_read_b128 v[138:141], v4 offset:55296
    ds_read_b128 v[142:145], v4 offset:56320
    v_mul_f32 v10, 0x3b124925, v108
    v_mul_f32 v11, 0x3b124925, v109
    v_fma_f32 v11, -v10, v10, v11
    v_max_f32 v11, 0, v11
    v_cvt_pk_bf16_f32 v10, v10, v10
    v_lshlrev_b32 v8, 16, v10
    v_cvt_pk_bf16_f32 v10, v11, v11
    v_lshlrev_b32 v11, 16, v10
    v_add_f32 v11, 0x3727c5ac, v11
    v_cvt_pk_bf16_f32 v10, v11, v11
    v_lshlrev_b32 v11, 16, v10
    v_sqrt_f32 v11, v11
    s_nop 0
    v_cvt_pk_bf16_f32 v10, v11, v11
    v_lshlrev_b32 v11, 16, v10
    v_rcp_f32 v9, v11
    v_sub_f32 v8, 0, v8
    v_mov_b32 v12, v8
    v_mov_b32 v13, v8
    v_mov_b32 v14, v9
    v_mov_b32 v15, v9
    v_lshlrev_b32 v16, 16, v150
    v_and_b32 v17, 0xffff0000, v150
    v_lshlrev_b32 v18, 16, v151
    v_and_b32 v19, 0xffff0000, v151
    v_lshlrev_b32 v20, 16, v152
    v_and_b32 v21, 0xffff0000, v152
    v_lshlrev_b32 v22, 16, v153
    v_and_b32 v23, 0xffff0000, v153
    v_lshlrev_b32 v24, 16, v154
    v_and_b32 v25, 0xffff0000, v154
    v_lshlrev_b32 v26, 16, v155
    v_and_b32 v27, 0xffff0000, v155
    v_lshlrev_b32 v28, 16, v156
    v_and_b32 v29, 0xffff0000, v156
    v_lshlrev_b32 v30, 16, v157
    v_and_b32 v31, 0xffff0000, v157
    v_lshlrev_b32 v32, 16, v158
    v_and_b32 v33, 0xffff0000, v158
    v_lshlrev_b32 v34, 16, v159
    v_and_b32 v35, 0xffff0000, v159
    v_lshlrev_b32 v36, 16, v160
    v_and_b32 v37, 0xffff0000, v160
    v_lshlrev_b32 v38, 16, v161
    v_and_b32 v39, 0xffff0000, v161
    v_lshlrev_b32 v40, 16, v162
    v_and_b32 v41, 0xffff0000, v162
    v_lshlrev_b32 v42, 16, v163
    v_and_b32 v43, 0xffff0000, v163
    v_lshlrev_b32 v44, 16, v164
    v_and_b32 v45, 0xffff0000, v164
    v_lshlrev_b32 v46, 16, v165
    v_and_b32 v47, 0xffff0000, v165
    s_waitcnt lgkmcnt(0)
    s_mul_i32 s19, s30, 56
    s_lshl_b32 s20, s12, 2
    s_add_u32 s19, s19, s20
    s_lshl_b32 s19, s19, 10
    s_add_u32 s19, s19, 16875520
    v_pk_fma_f32 v[72:73], v[114:115], v[12:13], v[72:73]
    v_pk_mul_f32 v[72:73], v[72:73], v[14:15]
    v_cvt_pk_bf16_f32 v7, v72, v73
    v_lshlrev_b32 v72, 16, v7
    v_and_b32 v73, 0xffff0000, v7
    v_pk_add_f32 v[72:73], v[72:73], v[16:17]
    v_cvt_pk_bf16_f32 v7, v72, v73
    v_lshlrev_b32 v72, 16, v7
    v_and_b32 v73, 0xffff0000, v7
    v_max_f32 v72, 0, v72
    v_max_f32 v73, 0, v73
    v_pk_mul_f32 v[72:73], v[72:73], v[72:73]
    v_cvt_pk_bf16_f32 v48, v72, v73
    v_pk_fma_f32 v[74:75], v[116:117], v[12:13], v[74:75]
    v_pk_mul_f32 v[74:75], v[74:75], v[14:15]
    v_cvt_pk_bf16_f32 v7, v74, v75
    v_lshlrev_b32 v74, 16, v7
    v_and_b32 v75, 0xffff0000, v7
    v_pk_add_f32 v[74:75], v[74:75], v[18:19]
    v_cvt_pk_bf16_f32 v7, v74, v75
    v_lshlrev_b32 v74, 16, v7
    v_and_b32 v75, 0xffff0000, v7
    v_max_f32 v74, 0, v74
    v_max_f32 v75, 0, v75
    v_pk_mul_f32 v[74:75], v[74:75], v[74:75]
    v_cvt_pk_bf16_f32 v49, v74, v75
    v_pk_fma_f32 v[76:77], v[118:119], v[12:13], v[76:77]
    v_pk_mul_f32 v[76:77], v[76:77], v[14:15]
    v_cvt_pk_bf16_f32 v7, v76, v77
    v_lshlrev_b32 v76, 16, v7
    v_and_b32 v77, 0xffff0000, v7
    v_pk_add_f32 v[76:77], v[76:77], v[20:21]
    v_cvt_pk_bf16_f32 v7, v76, v77
    v_lshlrev_b32 v76, 16, v7
    v_and_b32 v77, 0xffff0000, v7
    v_max_f32 v76, 0, v76
    v_max_f32 v77, 0, v77
    v_pk_mul_f32 v[76:77], v[76:77], v[76:77]
    v_cvt_pk_bf16_f32 v50, v76, v77
    v_pk_fma_f32 v[78:79], v[120:121], v[12:13], v[78:79]
    v_pk_mul_f32 v[78:79], v[78:79], v[14:15]
    v_cvt_pk_bf16_f32 v7, v78, v79
    v_lshlrev_b32 v78, 16, v7
    v_and_b32 v79, 0xffff0000, v7
    v_pk_add_f32 v[78:79], v[78:79], v[22:23]
    v_cvt_pk_bf16_f32 v7, v78, v79
    v_lshlrev_b32 v78, 16, v7
    v_and_b32 v79, 0xffff0000, v7
    v_max_f32 v78, 0, v78
    v_max_f32 v79, 0, v79
    v_pk_mul_f32 v[78:79], v[78:79], v[78:79]
    v_cvt_pk_bf16_f32 v51, v78, v79
    buffer_store_dwordx4 v[48:51], v1, s[8:11], s19 offen offset:0
    v_pk_fma_f32 v[80:81], v[122:123], v[12:13], v[80:81]
    v_pk_mul_f32 v[80:81], v[80:81], v[14:15]
    v_cvt_pk_bf16_f32 v7, v80, v81
    v_lshlrev_b32 v80, 16, v7
    v_and_b32 v81, 0xffff0000, v7
    v_pk_add_f32 v[80:81], v[80:81], v[24:25]
    v_cvt_pk_bf16_f32 v7, v80, v81
    v_lshlrev_b32 v80, 16, v7
    v_and_b32 v81, 0xffff0000, v7
    v_max_f32 v80, 0, v80
    v_max_f32 v81, 0, v81
    v_pk_mul_f32 v[80:81], v[80:81], v[80:81]
    v_cvt_pk_bf16_f32 v52, v80, v81
    v_pk_fma_f32 v[82:83], v[124:125], v[12:13], v[82:83]
    v_pk_mul_f32 v[82:83], v[82:83], v[14:15]
    v_cvt_pk_bf16_f32 v7, v82, v83
    v_lshlrev_b32 v82, 16, v7
    v_and_b32 v83, 0xffff0000, v7
    v_pk_add_f32 v[82:83], v[82:83], v[26:27]
    v_cvt_pk_bf16_f32 v7, v82, v83
    v_lshlrev_b32 v82, 16, v7
    v_and_b32 v83, 0xffff0000, v7
    v_max_f32 v82, 0, v82
    v_max_f32 v83, 0, v83
    v_pk_mul_f32 v[82:83], v[82:83], v[82:83]
    v_cvt_pk_bf16_f32 v53, v82, v83
    v_pk_fma_f32 v[84:85], v[126:127], v[12:13], v[84:85]
    v_pk_mul_f32 v[84:85], v[84:85], v[14:15]
    v_cvt_pk_bf16_f32 v7, v84, v85
    v_lshlrev_b32 v84, 16, v7
    v_and_b32 v85, 0xffff0000, v7
    v_pk_add_f32 v[84:85], v[84:85], v[28:29]
    v_cvt_pk_bf16_f32 v7, v84, v85
    v_lshlrev_b32 v84, 16, v7
    v_and_b32 v85, 0xffff0000, v7
    v_max_f32 v84, 0, v84
    v_max_f32 v85, 0, v85
    v_pk_mul_f32 v[84:85], v[84:85], v[84:85]
    v_cvt_pk_bf16_f32 v54, v84, v85
    v_pk_fma_f32 v[86:87], v[128:129], v[12:13], v[86:87]
    v_pk_mul_f32 v[86:87], v[86:87], v[14:15]
    v_cvt_pk_bf16_f32 v7, v86, v87
    v_lshlrev_b32 v86, 16, v7
    v_and_b32 v87, 0xffff0000, v7
    v_pk_add_f32 v[86:87], v[86:87], v[30:31]
    v_cvt_pk_bf16_f32 v7, v86, v87
    v_lshlrev_b32 v86, 16, v7
    v_and_b32 v87, 0xffff0000, v7
    v_max_f32 v86, 0, v86
    v_max_f32 v87, 0, v87
    v_pk_mul_f32 v[86:87], v[86:87], v[86:87]
    v_cvt_pk_bf16_f32 v55, v86, v87
    buffer_store_dwordx4 v[52:55], v1, s[8:11], s19 offen offset:1024
    v_pk_fma_f32 v[88:89], v[130:131], v[12:13], v[88:89]
    v_pk_mul_f32 v[88:89], v[88:89], v[14:15]
    v_cvt_pk_bf16_f32 v7, v88, v89
    v_lshlrev_b32 v88, 16, v7
    v_and_b32 v89, 0xffff0000, v7
    v_pk_add_f32 v[88:89], v[88:89], v[32:33]
    v_cvt_pk_bf16_f32 v7, v88, v89
    v_lshlrev_b32 v88, 16, v7
    v_and_b32 v89, 0xffff0000, v7
    v_max_f32 v88, 0, v88
    v_max_f32 v89, 0, v89
    v_pk_mul_f32 v[88:89], v[88:89], v[88:89]
    v_cvt_pk_bf16_f32 v48, v88, v89
    v_pk_fma_f32 v[90:91], v[132:133], v[12:13], v[90:91]
    v_pk_mul_f32 v[90:91], v[90:91], v[14:15]
    v_cvt_pk_bf16_f32 v7, v90, v91
    v_lshlrev_b32 v90, 16, v7
    v_and_b32 v91, 0xffff0000, v7
    v_pk_add_f32 v[90:91], v[90:91], v[34:35]
    v_cvt_pk_bf16_f32 v7, v90, v91
    v_lshlrev_b32 v90, 16, v7
    v_and_b32 v91, 0xffff0000, v7
    v_max_f32 v90, 0, v90
    v_max_f32 v91, 0, v91
    v_pk_mul_f32 v[90:91], v[90:91], v[90:91]
    v_cvt_pk_bf16_f32 v49, v90, v91
    v_pk_fma_f32 v[92:93], v[134:135], v[12:13], v[92:93]
    v_pk_mul_f32 v[92:93], v[92:93], v[14:15]
    v_cvt_pk_bf16_f32 v7, v92, v93
    v_lshlrev_b32 v92, 16, v7
    v_and_b32 v93, 0xffff0000, v7
    v_pk_add_f32 v[92:93], v[92:93], v[36:37]
    v_cvt_pk_bf16_f32 v7, v92, v93
    v_lshlrev_b32 v92, 16, v7
    v_and_b32 v93, 0xffff0000, v7
    v_max_f32 v92, 0, v92
    v_max_f32 v93, 0, v93
    v_pk_mul_f32 v[92:93], v[92:93], v[92:93]
    v_cvt_pk_bf16_f32 v50, v92, v93
    v_pk_fma_f32 v[94:95], v[136:137], v[12:13], v[94:95]
    v_pk_mul_f32 v[94:95], v[94:95], v[14:15]
    v_cvt_pk_bf16_f32 v7, v94, v95
    v_lshlrev_b32 v94, 16, v7
    v_and_b32 v95, 0xffff0000, v7
    v_pk_add_f32 v[94:95], v[94:95], v[38:39]
    v_cvt_pk_bf16_f32 v7, v94, v95
    v_lshlrev_b32 v94, 16, v7
    v_and_b32 v95, 0xffff0000, v7
    v_max_f32 v94, 0, v94
    v_max_f32 v95, 0, v95
    v_pk_mul_f32 v[94:95], v[94:95], v[94:95]
    v_cvt_pk_bf16_f32 v51, v94, v95
    buffer_store_dwordx4 v[48:51], v1, s[8:11], s19 offen offset:2048
    v_pk_fma_f32 v[96:97], v[138:139], v[12:13], v[96:97]
    v_pk_mul_f32 v[96:97], v[96:97], v[14:15]
    v_cvt_pk_bf16_f32 v7, v96, v97
    v_lshlrev_b32 v96, 16, v7
    v_and_b32 v97, 0xffff0000, v7
    v_pk_add_f32 v[96:97], v[96:97], v[40:41]
    v_cvt_pk_bf16_f32 v7, v96, v97
    v_lshlrev_b32 v96, 16, v7
    v_and_b32 v97, 0xffff0000, v7
    v_max_f32 v96, 0, v96
    v_max_f32 v97, 0, v97
    v_pk_mul_f32 v[96:97], v[96:97], v[96:97]
    v_cvt_pk_bf16_f32 v52, v96, v97
    v_pk_fma_f32 v[98:99], v[140:141], v[12:13], v[98:99]
    v_pk_mul_f32 v[98:99], v[98:99], v[14:15]
    v_cvt_pk_bf16_f32 v7, v98, v99
    v_lshlrev_b32 v98, 16, v7
    v_and_b32 v99, 0xffff0000, v7
    v_pk_add_f32 v[98:99], v[98:99], v[42:43]
    v_cvt_pk_bf16_f32 v7, v98, v99
    v_lshlrev_b32 v98, 16, v7
    v_and_b32 v99, 0xffff0000, v7
    v_max_f32 v98, 0, v98
    v_max_f32 v99, 0, v99
    v_pk_mul_f32 v[98:99], v[98:99], v[98:99]
    v_cvt_pk_bf16_f32 v53, v98, v99
    v_pk_fma_f32 v[100:101], v[142:143], v[12:13], v[100:101]
    v_pk_mul_f32 v[100:101], v[100:101], v[14:15]
    v_cvt_pk_bf16_f32 v7, v100, v101
    v_lshlrev_b32 v100, 16, v7
    v_and_b32 v101, 0xffff0000, v7
    v_pk_add_f32 v[100:101], v[100:101], v[44:45]
    v_cvt_pk_bf16_f32 v7, v100, v101
    v_lshlrev_b32 v100, 16, v7
    v_and_b32 v101, 0xffff0000, v7
    v_max_f32 v100, 0, v100
    v_max_f32 v101, 0, v101
    v_pk_mul_f32 v[100:101], v[100:101], v[100:101]
    v_cvt_pk_bf16_f32 v54, v100, v101
    v_pk_fma_f32 v[102:103], v[144:145], v[12:13], v[102:103]
    v_pk_mul_f32 v[102:103], v[102:103], v[14:15]
    v_cvt_pk_bf16_f32 v7, v102, v103
    v_lshlrev_b32 v102, 16, v7
    v_and_b32 v103, 0xffff0000, v7
    v_pk_add_f32 v[102:103], v[102:103], v[46:47]
    v_cvt_pk_bf16_f32 v7, v102, v103
    v_lshlrev_b32 v102, 16, v7
    v_and_b32 v103, 0xffff0000, v7
    v_max_f32 v102, 0, v102
    v_max_f32 v103, 0, v103
    v_pk_mul_f32 v[102:103], v[102:103], v[102:103]
    v_cvt_pk_bf16_f32 v55, v102, v103
    buffer_store_dwordx4 v[52:55], v1, s[8:11], s19 offen offset:3072
    s_nop 11
K3_END_11370496:
    s_endpgm
.globl ffb0_kernel
.p2align 8
.type ffb0_kernel,@function
ffb0_kernel:
    s_load_dwordx2 s[6:7], s[0:1], 64
    s_load_dwordx2 s[22:23], s[0:1], 72
    s_load_dwordx2 s[4:5], s[0:1], 88
    s_cmp_ge_u32 s2, 224
    s_cbranch_scc1 K4_END_11370496
    v_lshrrev_b32 v1, 6, v0
    v_and_b32 v0, 63, v0
    v_readfirstlane_b32 s3, v1
    v_lshlrev_b32 v1, 4, v0
    v_and_b32 v2, 15, v0
    v_lshrrev_b32 v3, 4, v0
    s_waitcnt lgkmcnt(0)
    s_mov_b32 s8, s4
    s_and_b32 s9, s5, 0xffff
    s_mov_b32 s10, 0x10000000
    s_mov_b32 s11, 0x00020000
    s_mov_b32 s24, s6
    s_and_b32 s25, s7, 0xffff
    s_mov_b32 s26, 0x380
    s_mov_b32 s27, 0x00020000
    s_mov_b32 s28, s22
    s_and_b32 s29, s23, 0xffff
    s_mov_b32 s30, 0x1c0000
    s_mov_b32 s31, 0x00020000
    s_and_b32 s14, s2, 7
    s_lshr_b32 s15, s2, 3
    s_mul_hi_u32 s16, s15, 0x24924925
    s_mul_i32 s17, s16, 7
    s_sub_u32 s12, s15, s17
    s_lshl_b32 s13, s14, 2
    s_add_u32 s13, s13, s16
    s_mul_i32 s19, s3, 14
    s_lshl_b32 s20, s12, 2
    s_add_u32 s20, s20, 0
    s_mul_i32 s20, s20, 56
    s_add_u32 s20, s20, s19
    s_lshl_b32 s20, s20, 10
    s_add_u32 s40, s20, 5308416
    s_lshl_b32 s20, s13, 2
    s_add_u32 s20, s20, 0
    s_mul_i32 s20, s20, 56
    s_add_u32 s20, s20, s19
    s_lshl_b32 s20, s20, 10
    s_add_u32 s44, s20, 16875520
    s_lshl_b32 s20, s12, 2
    s_add_u32 s20, s20, 1
    s_mul_i32 s20, s20, 56
    s_add_u32 s20, s20, s19
    s_lshl_b32 s20, s20, 10
    s_add_u32 s41, s20, 5308416
    s_lshl_b32 s20, s13, 2
    s_add_u32 s20, s20, 1
    s_mul_i32 s20, s20, 56
    s_add_u32 s20, s20, s19
    s_lshl_b32 s20, s20, 10
    s_add_u32 s45, s20, 16875520
    s_lshl_b32 s20, s12, 2
    s_add_u32 s20, s20, 2
    s_mul_i32 s20, s20, 56
    s_add_u32 s20, s20, s19
    s_lshl_b32 s20, s20, 10
    s_add_u32 s42, s20, 5308416
    s_lshl_b32 s20, s13, 2
    s_add_u32 s20, s20, 2
    s_mul_i32 s20, s20, 56
    s_add_u32 s20, s20, s19
    s_lshl_b32 s20, s20, 10
    s_add_u32 s46, s20, 16875520
    s_lshl_b32 s20, s12, 2
    s_add_u32 s20, s20, 3
    s_mul_i32 s20, s20, 56
    s_add_u32 s20, s20, s19
    s_lshl_b32 s20, s20, 10
    s_add_u32 s43, s20, 5308416
    s_lshl_b32 s20, s13, 2
    s_add_u32 s20, s20, 3
    s_mul_i32 s20, s20, 56
    s_add_u32 s20, s20, s19
    s_lshl_b32 s20, s20, 10
    s_add_u32 s47, s20, 16875520
    buffer_load_dwordx4 v[16:19], v1, s[8:11], s40 offen
    buffer_load_dwordx4 v[20:23], v1, s[8:11], s41 offen
    buffer_load_dwordx4 v[24:27], v1, s[8:11], s42 offen
    buffer_load_dwordx4 v[28:31], v1, s[8:11], s43 offen
    buffer_load_dwordx4 v[32:35], v1, s[8:11], s44 offen
    buffer_load_dwordx4 v[36:39], v1, s[8:11], s45 offen
    buffer_load_dwordx4 v[40:43], v1, s[8:11], s46 offen
    buffer_load_dwordx4 v[44:47], v1, s[8:11], s47 offen
    s_add_u32 s40, s40, 1024
    s_add_u32 s41, s41, 1024
    s_add_u32 s42, s42, 1024
    s_add_u32 s43, s43, 1024
    s_add_u32 s44, s44, 1024
    s_add_u32 s45, s45, 1024
    s_add_u32 s46, s46, 1024
    s_add_u32 s47, s47, 1024
    buffer_load_dwordx4 v[48:51], v1, s[8:11], s40 offen
    buffer_load_dwordx4 v[52:55], v1, s[8:11], s41 offen
    buffer_load_dwordx4 v[56:59], v1, s[8:11], s42 offen
    buffer_load_dwordx4 v[60:63], v1, s[8:11], s43 offen
    buffer_load_dwordx4 v[64:67], v1, s[8:11], s44 offen
    buffer_load_dwordx4 v[68:71], v1, s[8:11], s45 offen
    buffer_load_dwordx4 v[72:75], v1, s[8:11], s46 offen
    buffer_load_dwordx4 v[76:79], v1, s[8:11], s47 offen
    s_add_u32 s40, s40, 1024
    s_add_u32 s41, s41, 1024
    s_add_u32 s42, s42, 1024
    s_add_u32 s43, s43, 1024
    s_add_u32 s44, s44, 1024
    s_add_u32 s45, s45, 1024
    s_add_u32 s46, s46, 1024
    s_add_u32 s47, s47, 1024
    buffer_load_dwordx4 v[80:83], v1, s[8:11], s40 offen
    buffer_load_dwordx4 v[84:87], v1, s[8:11], s41 offen
    buffer_load_dwordx4 v[88:91], v1, s[8:11], s42 offen
    buffer_load_dwordx4 v[92:95], v1, s[8:11], s43 offen
    buffer_load_dwordx4 v[96:99], v1, s[8:11], s44 offen
    buffer_load_dwordx4 v[100:103], v1, s[8:11], s45 offen
    buffer_load_dwordx4 v[104:107], v1, s[8:11], s46 offen
    buffer_load_dwordx4 v[108:111], v1, s[8:11], s47 offen
    s_add_u32 s40, s40, 1024
    s_add_u32 s41, s41, 1024
    s_add_u32 s42, s42, 1024
    s_add_u32 s43, s43, 1024
    s_add_u32 s44, s44, 1024
    s_add_u32 s45, s45, 1024
    s_add_u32 s46, s46, 1024
    s_add_u32 s47, s47, 1024
    buffer_load_dwordx4 v[112:115], v1, s[8:11], s40 offen
    buffer_load_dwordx4 v[116:119], v1, s[8:11], s41 offen
    buffer_load_dwordx4 v[120:123], v1, s[8:11], s42 offen
    buffer_load_dwordx4 v[124:127], v1, s[8:11], s43 offen
    buffer_load_dwordx4 v[128:131], v1, s[8:11], s44 offen
    buffer_load_dwordx4 v[132:135], v1, s[8:11], s45 offen
    buffer_load_dwordx4 v[136:139], v1, s[8:11], s46 offen
    buffer_load_dwordx4 v[140:143], v1, s[8:11], s47 offen
    s_add_u32 s40, s40, 1024
    s_add_u32 s41, s41, 1024
    s_add_u32 s42, s42, 1024
    s_add_u32 s43, s43, 1024
    s_add_u32 s44, s44, 1024
    s_add_u32 s45, s45, 1024
    s_add_u32 s46, s46, 1024
    s_add_u32 s47, s47, 1024
    buffer_load_dwordx4 v[144:147], v1, s[8:11], s40 offen
    buffer_load_dwordx4 v[148:151], v1, s[8:11], s41 offen
    buffer_load_dwordx4 v[152:155], v1, s[8:11], s42 offen
    buffer_load_dwordx4 v[156:159], v1, s[8:11], s43 offen
    buffer_load_dwordx4 v[160:163], v1, s[8:11], s44 offen
    buffer_load_dwordx4 v[164:167], v1, s[8:11], s45 offen
    buffer_load_dwordx4 v[168:171], v1, s[8:11], s46 offen
    buffer_load_dwordx4 v[172:175], v1, s[8:11], s47 offen
    s_add_u32 s40, s40, 1024
    s_add_u32 s41, s41, 1024
    s_add_u32 s42, s42, 1024
    s_add_u32 s43, s43, 1024
    s_add_u32 s44, s44, 1024
    s_add_u32 s45, s45, 1024
    s_add_u32 s46, s46, 1024
    s_add_u32 s47, s47, 1024
    buffer_load_dwordx4 v[176:179], v1, s[8:11], s40 offen
    buffer_load_dwordx4 v[180:183], v1, s[8:11], s41 offen
    buffer_load_dwordx4 v[184:187], v1, s[8:11], s42 offen
    buffer_load_dwordx4 v[188:191], v1, s[8:11], s43 offen
    buffer_load_dwordx4 v[192:195], v1, s[8:11], s44 offen
    buffer_load_dwordx4 v[196:199], v1, s[8:11], s45 offen
    buffer_load_dwordx4 v[200:203], v1, s[8:11], s46 offen
    buffer_load_dwordx4 v[204:207], v1, s[8:11], s47 offen
    s_add_u32 s40, s40, 1024
    s_add_u32 s41, s41, 1024
    s_add_u32 s42, s42, 1024
    s_add_u32 s43, s43, 1024
    s_add_u32 s44, s44, 1024
    s_add_u32 s45, s45, 1024
    s_add_u32 s46, s46, 1024
    s_add_u32 s47, s47, 1024
    s_waitcnt vmcnt(40)
    v_mfma_f32_16x16x32_bf16 a[0:3], v[16:19], v[32:35], 0
    v_mfma_f32_16x16x32_bf16 a[4:7], v[16:19], v[36:39], 0
    v_mfma_f32_16x16x32_bf16 a[8:11], v[16:19], v[40:43], 0
    v_mfma_f32_16x16x32_bf16 a[12:15], v[16:19], v[44:47], 0
    v_mfma_f32_16x16x32_bf16 a[16:19], v[20:23], v[32:35], 0
    v_mfma_f32_16x16x32_bf16 a[20:23], v[20:23], v[36:39], 0
    v_mfma_f32_16x16x32_bf16 a[24:27], v[20:23], v[40:43], 0
    v_mfma_f32_16x16x32_bf16 a[28:31], v[20:23], v[44:47], 0
    v_mfma_f32_16x16x32_bf16 a[32:35], v[24:27], v[32:35], 0
    v_mfma_f32_16x16x32_bf16 a[36:39], v[24:27], v[36:39], 0
    v_mfma_f32_16x16x32_bf16 a[40:43], v[24:27], v[40:43], 0
    v_mfma_f32_16x16x32_bf16 a[44:47], v[24:27], v[44:47], 0
    v_mfma_f32_16x16x32_bf16 a[48:51], v[28:31], v[32:35], 0
    v_mfma_f32_16x16x32_bf16 a[52:55], v[28:31], v[36:39], 0
    v_mfma_f32_16x16x32_bf16 a[56:59], v[28:31], v[40:43], 0
    v_mfma_f32_16x16x32_bf16 a[60:63], v[28:31], v[44:47], 0
    buffer_load_dwordx4 v[16:19], v1, s[8:11], s40 offen
    buffer_load_dwordx4 v[20:23], v1, s[8:11], s41 offen
    buffer_load_dwordx4 v[24:27], v1, s[8:11], s42 offen
    buffer_load_dwordx4 v[28:31], v1, s[8:11], s43 offen
    buffer_load_dwordx4 v[32:35], v1, s[8:11], s44 offen
    buffer_load_dwordx4 v[36:39], v1, s[8:11], s45 offen
    buffer_load_dwordx4 v[40:43], v1, s[8:11], s46 offen
    buffer_load_dwordx4 v[44:47], v1, s[8:11], s47 offen
    s_add_u32 s40, s40, 1024
    s_add_u32 s41, s41, 1024
    s_add_u32 s42, s42, 1024
    s_add_u32 s43, s43, 1024
    s_add_u32 s44, s44, 1024
    s_add_u32 s45, s45, 1024
    s_add_u32 s46, s46, 1024
    s_add_u32 s47, s47, 1024
    s_waitcnt vmcnt(40)
    v_mfma_f32_16x16x32_bf16 a[0:3], v[48:51], v[64:67], a[0:3]
    v_mfma_f32_16x16x32_bf16 a[4:7], v[48:51], v[68:71], a[4:7]
    v_mfma_f32_16x16x32_bf16 a[8:11], v[48:51], v[72:75], a[8:11]
    v_mfma_f32_16x16x32_bf16 a[12:15], v[48:51], v[76:79], a[12:15]
    v_mfma_f32_16x16x32_bf16 a[16:19], v[52:55], v[64:67], a[16:19]
    v_mfma_f32_16x16x32_bf16 a[20:23], v[52:55], v[68:71], a[20:23]
    v_mfma_f32_16x16x32_bf16 a[24:27], v[52:55], v[72:75], a[24:27]
    v_mfma_f32_16x16x32_bf16 a[28:31], v[52:55], v[76:79], a[28:31]
    v_mfma_f32_16x16x32_bf16 a[32:35], v[56:59], v[64:67], a[32:35]
    v_mfma_f32_16x16x32_bf16 a[36:39], v[56:59], v[68:71], a[36:39]
    v_mfma_f32_16x16x32_bf16 a[40:43], v[56:59], v[72:75], a[40:43]
    v_mfma_f32_16x16x32_bf16 a[44:47], v[56:59], v[76:79], a[44:47]
    v_mfma_f32_16x16x32_bf16 a[48:51], v[60:63], v[64:67], a[48:51]
    v_mfma_f32_16x16x32_bf16 a[52:55], v[60:63], v[68:71], a[52:55]
    v_mfma_f32_16x16x32_bf16 a[56:59], v[60:63], v[72:75], a[56:59]
    v_mfma_f32_16x16x32_bf16 a[60:63], v[60:63], v[76:79], a[60:63]
    buffer_load_dwordx4 v[48:51], v1, s[8:11], s40 offen
    buffer_load_dwordx4 v[52:55], v1, s[8:11], s41 offen
    buffer_load_dwordx4 v[56:59], v1, s[8:11], s42 offen
    buffer_load_dwordx4 v[60:63], v1, s[8:11], s43 offen
    buffer_load_dwordx4 v[64:67], v1, s[8:11], s44 offen
    buffer_load_dwordx4 v[68:71], v1, s[8:11], s45 offen
    buffer_load_dwordx4 v[72:75], v1, s[8:11], s46 offen
    buffer_load_dwordx4 v[76:79], v1, s[8:11], s47 offen
    s_add_u32 s40, s40, 1024
    s_add_u32 s41, s41, 1024
    s_add_u32 s42, s42, 1024
    s_add_u32 s43, s43, 1024
    s_add_u32 s44, s44, 1024
    s_add_u32 s45, s45, 1024
    s_add_u32 s46, s46, 1024
    s_add_u32 s47, s47, 1024
    s_waitcnt vmcnt(40)
    v_mfma_f32_16x16x32_bf16 a[0:3], v[80:83], v[96:99], a[0:3]
    v_mfma_f32_16x16x32_bf16 a[4:7], v[80:83], v[100:103], a[4:7]
    v_mfma_f32_16x16x32_bf16 a[8:11], v[80:83], v[104:107], a[8:11]
    v_mfma_f32_16x16x32_bf16 a[12:15], v[80:83], v[108:111], a[12:15]
    v_mfma_f32_16x16x32_bf16 a[16:19], v[84:87], v[96:99], a[16:19]
    v_mfma_f32_16x16x32_bf16 a[20:23], v[84:87], v[100:103], a[20:23]
    v_mfma_f32_16x16x32_bf16 a[24:27], v[84:87], v[104:107], a[24:27]
    v_mfma_f32_16x16x32_bf16 a[28:31], v[84:87], v[108:111], a[28:31]
    v_mfma_f32_16x16x32_bf16 a[32:35], v[88:91], v[96:99], a[32:35]
    v_mfma_f32_16x16x32_bf16 a[36:39], v[88:91], v[100:103], a[36:39]
    v_mfma_f32_16x16x32_bf16 a[40:43], v[88:91], v[104:107], a[40:43]
    v_mfma_f32_16x16x32_bf16 a[44:47], v[88:91], v[108:111], a[44:47]
    v_mfma_f32_16x16x32_bf16 a[48:51], v[92:95], v[96:99], a[48:51]
    v_mfma_f32_16x16x32_bf16 a[52:55], v[92:95], v[100:103], a[52:55]
    v_mfma_f32_16x16x32_bf16 a[56:59], v[92:95], v[104:107], a[56:59]
    v_mfma_f32_16x16x32_bf16 a[60:63], v[92:95], v[108:111], a[60:63]
    buffer_load_dwordx4 v[80:83], v1, s[8:11], s40 offen
    buffer_load_dwordx4 v[84:87], v1, s[8:11], s41 offen
    buffer_load_dwordx4 v[88:91], v1, s[8:11], s42 offen
    buffer_load_dwordx4 v[92:95], v1, s[8:11], s43 offen
    buffer_load_dwordx4 v[96:99], v1, s[8:11], s44 offen
    buffer_load_dwordx4 v[100:103], v1, s[8:11], s45 offen
    buffer_load_dwordx4 v[104:107], v1, s[8:11], s46 offen
    buffer_load_dwordx4 v[108:111], v1, s[8:11], s47 offen
    s_add_u32 s40, s40, 1024
    s_add_u32 s41, s41, 1024
    s_add_u32 s42, s42, 1024
    s_add_u32 s43, s43, 1024
    s_add_u32 s44, s44, 1024
    s_add_u32 s45, s45, 1024
    s_add_u32 s46, s46, 1024
    s_add_u32 s47, s47, 1024
    s_waitcnt vmcnt(40)
    v_mfma_f32_16x16x32_bf16 a[0:3], v[112:115], v[128:131], a[0:3]
    v_mfma_f32_16x16x32_bf16 a[4:7], v[112:115], v[132:135], a[4:7]
    v_mfma_f32_16x16x32_bf16 a[8:11], v[112:115], v[136:139], a[8:11]
    v_mfma_f32_16x16x32_bf16 a[12:15], v[112:115], v[140:143], a[12:15]
    v_mfma_f32_16x16x32_bf16 a[16:19], v[116:119], v[128:131], a[16:19]
    v_mfma_f32_16x16x32_bf16 a[20:23], v[116:119], v[132:135], a[20:23]
    v_mfma_f32_16x16x32_bf16 a[24:27], v[116:119], v[136:139], a[24:27]
    v_mfma_f32_16x16x32_bf16 a[28:31], v[116:119], v[140:143], a[28:31]
    v_mfma_f32_16x16x32_bf16 a[32:35], v[120:123], v[128:131], a[32:35]
    v_mfma_f32_16x16x32_bf16 a[36:39], v[120:123], v[132:135], a[36:39]
    v_mfma_f32_16x16x32_bf16 a[40:43], v[120:123], v[136:139], a[40:43]
    v_mfma_f32_16x16x32_bf16 a[44:47], v[120:123], v[140:143], a[44:47]
    v_mfma_f32_16x16x32_bf16 a[48:51], v[124:127], v[128:131], a[48:51]
    v_mfma_f32_16x16x32_bf16 a[52:55], v[124:127], v[132:135], a[52:55]
    v_mfma_f32_16x16x32_bf16 a[56:59], v[124:127], v[136:139], a[56:59]
    v_mfma_f32_16x16x32_bf16 a[60:63], v[124:127], v[140:143], a[60:63]
    buffer_load_dwordx4 v[112:115], v1, s[8:11], s40 offen
    buffer_load_dwordx4 v[116:119], v1, s[8:11], s41 offen
    buffer_load_dwordx4 v[120:123], v1, s[8:11], s42 offen
    buffer_load_dwordx4 v[124:127], v1, s[8:11], s43 offen
    buffer_load_dwordx4 v[128:131], v1, s[8:11], s44 offen
    buffer_load_dwordx4 v[132:135], v1, s[8:11], s45 offen
    buffer_load_dwordx4 v[136:139], v1, s[8:11], s46 offen
    buffer_load_dwordx4 v[140:143], v1, s[8:11], s47 offen
    s_add_u32 s40, s40, 1024
    s_add_u32 s41, s41, 1024
    s_add_u32 s42, s42, 1024
    s_add_u32 s43, s43, 1024
    s_add_u32 s44, s44, 1024
    s_add_u32 s45, s45, 1024
    s_add_u32 s46, s46, 1024
    s_add_u32 s47, s47, 1024
    s_waitcnt vmcnt(40)
    v_mfma_f32_16x16x32_bf16 a[0:3], v[144:147], v[160:163], a[0:3]
    v_mfma_f32_16x16x32_bf16 a[4:7], v[144:147], v[164:167], a[4:7]
    v_mfma_f32_16x16x32_bf16 a[8:11], v[144:147], v[168:171], a[8:11]
    v_mfma_f32_16x16x32_bf16 a[12:15], v[144:147], v[172:175], a[12:15]
    v_mfma_f32_16x16x32_bf16 a[16:19], v[148:151], v[160:163], a[16:19]
    v_mfma_f32_16x16x32_bf16 a[20:23], v[148:151], v[164:167], a[20:23]
    v_mfma_f32_16x16x32_bf16 a[24:27], v[148:151], v[168:171], a[24:27]
    v_mfma_f32_16x16x32_bf16 a[28:31], v[148:151], v[172:175], a[28:31]
    v_mfma_f32_16x16x32_bf16 a[32:35], v[152:155], v[160:163], a[32:35]
    v_mfma_f32_16x16x32_bf16 a[36:39], v[152:155], v[164:167], a[36:39]
    v_mfma_f32_16x16x32_bf16 a[40:43], v[152:155], v[168:171], a[40:43]
    v_mfma_f32_16x16x32_bf16 a[44:47], v[152:155], v[172:175], a[44:47]
    v_mfma_f32_16x16x32_bf16 a[48:51], v[156:159], v[160:163], a[48:51]
    v_mfma_f32_16x16x32_bf16 a[52:55], v[156:159], v[164:167], a[52:55]
    v_mfma_f32_16x16x32_bf16 a[56:59], v[156:159], v[168:171], a[56:59]
    v_mfma_f32_16x16x32_bf16 a[60:63], v[156:159], v[172:175], a[60:63]
    buffer_load_dwordx4 v[144:147], v1, s[8:11], s40 offen
    buffer_load_dwordx4 v[148:151], v1, s[8:11], s41 offen
    buffer_load_dwordx4 v[152:155], v1, s[8:11], s42 offen
    buffer_load_dwordx4 v[156:159], v1, s[8:11], s43 offen
    buffer_load_dwordx4 v[160:163], v1, s[8:11], s44 offen
    buffer_load_dwordx4 v[164:167], v1, s[8:11], s45 offen
    buffer_load_dwordx4 v[168:171], v1, s[8:11], s46 offen
    buffer_load_dwordx4 v[172:175], v1, s[8:11], s47 offen
    s_add_u32 s40, s40, 1024
    s_add_u32 s41, s41, 1024
    s_add_u32 s42, s42, 1024
    s_add_u32 s43, s43, 1024
    s_add_u32 s44, s44, 1024
    s_add_u32 s45, s45, 1024
    s_add_u32 s46, s46, 1024
    s_add_u32 s47, s47, 1024
    s_waitcnt vmcnt(40)
    v_mfma_f32_16x16x32_bf16 a[0:3], v[176:179], v[192:195], a[0:3]
    v_mfma_f32_16x16x32_bf16 a[4:7], v[176:179], v[196:199], a[4:7]
    v_mfma_f32_16x16x32_bf16 a[8:11], v[176:179], v[200:203], a[8:11]
    v_mfma_f32_16x16x32_bf16 a[12:15], v[176:179], v[204:207], a[12:15]
    v_mfma_f32_16x16x32_bf16 a[16:19], v[180:183], v[192:195], a[16:19]
    v_mfma_f32_16x16x32_bf16 a[20:23], v[180:183], v[196:199], a[20:23]
    v_mfma_f32_16x16x32_bf16 a[24:27], v[180:183], v[200:203], a[24:27]
    v_mfma_f32_16x16x32_bf16 a[28:31], v[180:183], v[204:207], a[28:31]
    v_mfma_f32_16x16x32_bf16 a[32:35], v[184:187], v[192:195], a[32:35]
    v_mfma_f32_16x16x32_bf16 a[36:39], v[184:187], v[196:199], a[36:39]
    v_mfma_f32_16x16x32_bf16 a[40:43], v[184:187], v[200:203], a[40:43]
    v_mfma_f32_16x16x32_bf16 a[44:47], v[184:187], v[204:207], a[44:47]
    v_mfma_f32_16x16x32_bf16 a[48:51], v[188:191], v[192:195], a[48:51]
    v_mfma_f32_16x16x32_bf16 a[52:55], v[188:191], v[196:199], a[52:55]
    v_mfma_f32_16x16x32_bf16 a[56:59], v[188:191], v[200:203], a[56:59]
    v_mfma_f32_16x16x32_bf16 a[60:63], v[188:191], v[204:207], a[60:63]
    buffer_load_dwordx4 v[176:179], v1, s[8:11], s40 offen
    buffer_load_dwordx4 v[180:183], v1, s[8:11], s41 offen
    buffer_load_dwordx4 v[184:187], v1, s[8:11], s42 offen
    buffer_load_dwordx4 v[188:191], v1, s[8:11], s43 offen
    buffer_load_dwordx4 v[192:195], v1, s[8:11], s44 offen
    buffer_load_dwordx4 v[196:199], v1, s[8:11], s45 offen
    buffer_load_dwordx4 v[200:203], v1, s[8:11], s46 offen
    buffer_load_dwordx4 v[204:207], v1, s[8:11], s47 offen
    s_add_u32 s40, s40, 1024
    s_add_u32 s41, s41, 1024
    s_add_u32 s42, s42, 1024
    s_add_u32 s43, s43, 1024
    s_add_u32 s44, s44, 1024
    s_add_u32 s45, s45, 1024
    s_add_u32 s46, s46, 1024
    s_add_u32 s47, s47, 1024
    s_waitcnt vmcnt(40)
    v_mfma_f32_16x16x32_bf16 a[0:3], v[16:19], v[32:35], a[0:3]
    v_mfma_f32_16x16x32_bf16 a[4:7], v[16:19], v[36:39], a[4:7]
    v_mfma_f32_16x16x32_bf16 a[8:11], v[16:19], v[40:43], a[8:11]
    v_mfma_f32_16x16x32_bf16 a[12:15], v[16:19], v[44:47], a[12:15]
    v_mfma_f32_16x16x32_bf16 a[16:19], v[20:23], v[32:35], a[16:19]
    v_mfma_f32_16x16x32_bf16 a[20:23], v[20:23], v[36:39], a[20:23]
    v_mfma_f32_16x16x32_bf16 a[24:27], v[20:23], v[40:43], a[24:27]
    v_mfma_f32_16x16x32_bf16 a[28:31], v[20:23], v[44:47], a[28:31]
    v_mfma_f32_16x16x32_bf16 a[32:35], v[24:27], v[32:35], a[32:35]
    v_mfma_f32_16x16x32_bf16 a[36:39], v[24:27], v[36:39], a[36:39]
    v_mfma_f32_16x16x32_bf16 a[40:43], v[24:27], v[40:43], a[40:43]
    v_mfma_f32_16x16x32_bf16 a[44:47], v[24:27], v[44:47], a[44:47]
    v_mfma_f32_16x16x32_bf16 a[48:51], v[28:31], v[32:35], a[48:51]
    v_mfma_f32_16x16x32_bf16 a[52:55], v[28:31], v[36:39], a[52:55]
    v_mfma_f32_16x16x32_bf16 a[56:59], v[28:31], v[40:43], a[56:59]
    v_mfma_f32_16x16x32_bf16 a[60:63], v[28:31], v[44:47], a[60:63]
    buffer_load_dwordx4 v[16:19], v1, s[8:11], s40 offen
    buffer_load_dwordx4 v[20:23], v1, s[8:11], s41 offen
    buffer_load_dwordx4 v[24:27], v1, s[8:11], s42 offen
    buffer_load_dwordx4 v[28:31], v1, s[8:11], s43 offen
    buffer_load_dwordx4 v[32:35], v1, s[8:11], s44 offen
    buffer_load_dwordx4 v[36:39], v1, s[8:11], s45 offen
    buffer_load_dwordx4 v[40:43], v1, s[8:11], s46 offen
    buffer_load_dwordx4 v[44:47], v1, s[8:11], s47 offen
    s_add_u32 s40, s40, 1024
    s_add_u32 s41, s41, 1024
    s_add_u32 s42, s42, 1024
    s_add_u32 s43, s43, 1024
    s_add_u32 s44, s44, 1024
    s_add_u32 s45, s45, 1024
    s_add_u32 s46, s46, 1024
    s_add_u32 s47, s47, 1024
    s_waitcnt vmcnt(40)
    v_mfma_f32_16x16x32_bf16 a[0:3], v[48:51], v[64:67], a[0:3]
    v_mfma_f32_16x16x32_bf16 a[4:7], v[48:51], v[68:71], a[4:7]
    v_mfma_f32_16x16x32_bf16 a[8:11], v[48:51], v[72:75], a[8:11]
    v_mfma_f32_16x16x32_bf16 a[12:15], v[48:51], v[76:79], a[12:15]
    v_mfma_f32_16x16x32_bf16 a[16:19], v[52:55], v[64:67], a[16:19]
    v_mfma_f32_16x16x32_bf16 a[20:23], v[52:55], v[68:71], a[20:23]
    v_mfma_f32_16x16x32_bf16 a[24:27], v[52:55], v[72:75], a[24:27]
    v_mfma_f32_16x16x32_bf16 a[28:31], v[52:55], v[76:79], a[28:31]
    v_mfma_f32_16x16x32_bf16 a[32:35], v[56:59], v[64:67], a[32:35]
    v_mfma_f32_16x16x32_bf16 a[36:39], v[56:59], v[68:71], a[36:39]
    v_mfma_f32_16x16x32_bf16 a[40:43], v[56:59], v[72:75], a[40:43]
    v_mfma_f32_16x16x32_bf16 a[44:47], v[56:59], v[76:79], a[44:47]
    v_mfma_f32_16x16x32_bf16 a[48:51], v[60:63], v[64:67], a[48:51]
    v_mfma_f32_16x16x32_bf16 a[52:55], v[60:63], v[68:71], a[52:55]
    v_mfma_f32_16x16x32_bf16 a[56:59], v[60:63], v[72:75], a[56:59]
    v_mfma_f32_16x16x32_bf16 a[60:63], v[60:63], v[76:79], a[60:63]
    buffer_load_dwordx4 v[48:51], v1, s[8:11], s40 offen
    buffer_load_dwordx4 v[52:55], v1, s[8:11], s41 offen
    buffer_load_dwordx4 v[56:59], v1, s[8:11], s42 offen
    buffer_load_dwordx4 v[60:63], v1, s[8:11], s43 offen
    buffer_load_dwordx4 v[64:67], v1, s[8:11], s44 offen
    buffer_load_dwordx4 v[68:71], v1, s[8:11], s45 offen
    buffer_load_dwordx4 v[72:75], v1, s[8:11], s46 offen
    buffer_load_dwordx4 v[76:79], v1, s[8:11], s47 offen
    s_add_u32 s40, s40, 1024
    s_add_u32 s41, s41, 1024
    s_add_u32 s42, s42, 1024
    s_add_u32 s43, s43, 1024
    s_add_u32 s44, s44, 1024
    s_add_u32 s45, s45, 1024
    s_add_u32 s46, s46, 1024
    s_add_u32 s47, s47, 1024
    s_waitcnt vmcnt(40)
    v_mfma_f32_16x16x32_bf16 a[0:3], v[80:83], v[96:99], a[0:3]
    v_mfma_f32_16x16x32_bf16 a[4:7], v[80:83], v[100:103], a[4:7]
    v_mfma_f32_16x16x32_bf16 a[8:11], v[80:83], v[104:107], a[8:11]
    v_mfma_f32_16x16x32_bf16 a[12:15], v[80:83], v[108:111], a[12:15]
    v_mfma_f32_16x16x32_bf16 a[16:19], v[84:87], v[96:99], a[16:19]
    v_mfma_f32_16x16x32_bf16 a[20:23], v[84:87], v[100:103], a[20:23]
    v_mfma_f32_16x16x32_bf16 a[24:27], v[84:87], v[104:107], a[24:27]
    v_mfma_f32_16x16x32_bf16 a[28:31], v[84:87], v[108:111], a[28:31]
    v_mfma_f32_16x16x32_bf16 a[32:35], v[88:91], v[96:99], a[32:35]
    v_mfma_f32_16x16x32_bf16 a[36:39], v[88:91], v[100:103], a[36:39]
    v_mfma_f32_16x16x32_bf16 a[40:43], v[88:91], v[104:107], a[40:43]
    v_mfma_f32_16x16x32_bf16 a[44:47], v[88:91], v[108:111], a[44:47]
    v_mfma_f32_16x16x32_bf16 a[48:51], v[92:95], v[96:99], a[48:51]
    v_mfma_f32_16x16x32_bf16 a[52:55], v[92:95], v[100:103], a[52:55]
    v_mfma_f32_16x16x32_bf16 a[56:59], v[92:95], v[104:107], a[56:59]
    v_mfma_f32_16x16x32_bf16 a[60:63], v[92:95], v[108:111], a[60:63]
    s_waitcnt vmcnt(32)
    v_mfma_f32_16x16x32_bf16 a[0:3], v[112:115], v[128:131], a[0:3]
    v_mfma_f32_16x16x32_bf16 a[4:7], v[112:115], v[132:135], a[4:7]
    v_mfma_f32_16x16x32_bf16 a[8:11], v[112:115], v[136:139], a[8:11]
    v_mfma_f32_16x16x32_bf16 a[12:15], v[112:115], v[140:143], a[12:15]
    v_mfma_f32_16x16x32_bf16 a[16:19], v[116:119], v[128:131], a[16:19]
    v_mfma_f32_16x16x32_bf16 a[20:23], v[116:119], v[132:135], a[20:23]
    v_mfma_f32_16x16x32_bf16 a[24:27], v[116:119], v[136:139], a[24:27]
    v_mfma_f32_16x16x32_bf16 a[28:31], v[116:119], v[140:143], a[28:31]
    v_mfma_f32_16x16x32_bf16 a[32:35], v[120:123], v[128:131], a[32:35]
    v_mfma_f32_16x16x32_bf16 a[36:39], v[120:123], v[132:135], a[36:39]
    v_mfma_f32_16x16x32_bf16 a[40:43], v[120:123], v[136:139], a[40:43]
    v_mfma_f32_16x16x32_bf16 a[44:47], v[120:123], v[140:143], a[44:47]
    v_mfma_f32_16x16x32_bf16 a[48:51], v[124:127], v[128:131], a[48:51]
    v_mfma_f32_16x16x32_bf16 a[52:55], v[124:127], v[132:135], a[52:55]
    v_mfma_f32_16x16x32_bf16 a[56:59], v[124:127], v[136:139], a[56:59]
    v_mfma_f32_16x16x32_bf16 a[60:63], v[124:127], v[140:143], a[60:63]
    s_waitcnt vmcnt(24)
    v_mfma_f32_16x16x32_bf16 a[0:3], v[144:147], v[160:163], a[0:3]
    v_mfma_f32_16x16x32_bf16 a[4:7], v[144:147], v[164:167], a[4:7]
    v_mfma_f32_16x16x32_bf16 a[8:11], v[144:147], v[168:171], a[8:11]
    v_mfma_f32_16x16x32_bf16 a[12:15], v[144:147], v[172:175], a[12:15]
    v_mfma_f32_16x16x32_bf16 a[16:19], v[148:151], v[160:163], a[16:19]
    v_mfma_f32_16x16x32_bf16 a[20:23], v[148:151], v[164:167], a[20:23]
    v_mfma_f32_16x16x32_bf16 a[24:27], v[148:151], v[168:171], a[24:27]
    v_mfma_f32_16x16x32_bf16 a[28:31], v[148:151], v[172:175], a[28:31]
    v_mfma_f32_16x16x32_bf16 a[32:35], v[152:155], v[160:163], a[32:35]
    v_mfma_f32_16x16x32_bf16 a[36:39], v[152:155], v[164:167], a[36:39]
    v_mfma_f32_16x16x32_bf16 a[40:43], v[152:155], v[168:171], a[40:43]
    v_mfma_f32_16x16x32_bf16 a[44:47], v[152:155], v[172:175], a[44:47]
    v_mfma_f32_16x16x32_bf16 a[48:51], v[156:159], v[160:163], a[48:51]
    v_mfma_f32_16x16x32_bf16 a[52:55], v[156:159], v[164:167], a[52:55]
    v_mfma_f32_16x16x32_bf16 a[56:59], v[156:159], v[168:171], a[56:59]
    v_mfma_f32_16x16x32_bf16 a[60:63], v[156:159], v[172:175], a[60:63]
    s_waitcnt vmcnt(16)
    v_mfma_f32_16x16x32_bf16 a[0:3], v[176:179], v[192:195], a[0:3]
    v_mfma_f32_16x16x32_bf16 a[4:7], v[176:179], v[196:199], a[4:7]
    v_mfma_f32_16x16x32_bf16 a[8:11], v[176:179], v[200:203], a[8:11]
    v_mfma_f32_16x16x32_bf16 a[12:15], v[176:179], v[204:207], a[12:15]
    v_mfma_f32_16x16x32_bf16 a[16:19], v[180:183], v[192:195], a[16:19]
    v_mfma_f32_16x16x32_bf16 a[20:23], v[180:183], v[196:199], a[20:23]
    v_mfma_f32_16x16x32_bf16 a[24:27], v[180:183], v[200:203], a[24:27]
    v_mfma_f32_16x16x32_bf16 a[28:31], v[180:183], v[204:207], a[28:31]
    v_mfma_f32_16x16x32_bf16 a[32:35], v[184:187], v[192:195], a[32:35]
    v_mfma_f32_16x16x32_bf16 a[36:39], v[184:187], v[196:199], a[36:39]
    v_mfma_f32_16x16x32_bf16 a[40:43], v[184:187], v[200:203], a[40:43]
    v_mfma_f32_16x16x32_bf16 a[44:47], v[184:187], v[204:207], a[44:47]
    v_mfma_f32_16x16x32_bf16 a[48:51], v[188:191], v[192:195], a[48:51]
    v_mfma_f32_16x16x32_bf16 a[52:55], v[188:191], v[196:199], a[52:55]
    v_mfma_f32_16x16x32_bf16 a[56:59], v[188:191], v[200:203], a[56:59]
    v_mfma_f32_16x16x32_bf16 a[60:63], v[188:191], v[204:207], a[60:63]
    s_waitcnt vmcnt(8)
    v_mfma_f32_16x16x32_bf16 a[0:3], v[16:19], v[32:35], a[0:3]
    v_mfma_f32_16x16x32_bf16 a[4:7], v[16:19], v[36:39], a[4:7]
    v_mfma_f32_16x16x32_bf16 a[8:11], v[16:19], v[40:43], a[8:11]
    v_mfma_f32_16x16x32_bf16 a[12:15], v[16:19], v[44:47], a[12:15]
    v_mfma_f32_16x16x32_bf16 a[16:19], v[20:23], v[32:35], a[16:19]
    v_mfma_f32_16x16x32_bf16 a[20:23], v[20:23], v[36:39], a[20:23]
    v_mfma_f32_16x16x32_bf16 a[24:27], v[20:23], v[40:43], a[24:27]
    v_mfma_f32_16x16x32_bf16 a[28:31], v[20:23], v[44:47], a[28:31]
    v_mfma_f32_16x16x32_bf16 a[32:35], v[24:27], v[32:35], a[32:35]
    v_mfma_f32_16x16x32_bf16 a[36:39], v[24:27], v[36:39], a[36:39]
    v_mfma_f32_16x16x32_bf16 a[40:43], v[24:27], v[40:43], a[40:43]
    v_mfma_f32_16x16x32_bf16 a[44:47], v[24:27], v[44:47], a[44:47]
    v_mfma_f32_16x16x32_bf16 a[48:51], v[28:31], v[32:35], a[48:51]
    v_mfma_f32_16x16x32_bf16 a[52:55], v[28:31], v[36:39], a[52:55]
    v_mfma_f32_16x16x32_bf16 a[56:59], v[28:31], v[40:43], a[56:59]
    v_mfma_f32_16x16x32_bf16 a[60:63], v[28:31], v[44:47], a[60:63]
    s_waitcnt vmcnt(0)
    v_mfma_f32_16x16x32_bf16 a[0:3], v[48:51], v[64:67], a[0:3]
    v_mfma_f32_16x16x32_bf16 a[4:7], v[48:51], v[68:71], a[4:7]
    v_mfma_f32_16x16x32_bf16 a[8:11], v[48:51], v[72:75], a[8:11]
    v_mfma_f32_16x16x32_bf16 a[12:15], v[48:51], v[76:79], a[12:15]
    v_mfma_f32_16x16x32_bf16 a[16:19], v[52:55], v[64:67], a[16:19]
    v_mfma_f32_16x16x32_bf16 a[20:23], v[52:55], v[68:71], a[20:23]
    v_mfma_f32_16x16x32_bf16 a[24:27], v[52:55], v[72:75], a[24:27]
    v_mfma_f32_16x16x32_bf16 a[28:31], v[52:55], v[76:79], a[28:31]
    v_mfma_f32_16x16x32_bf16 a[32:35], v[56:59], v[64:67], a[32:35]
    v_mfma_f32_16x16x32_bf16 a[36:39], v[56:59], v[68:71], a[36:39]
    v_mfma_f32_16x16x32_bf16 a[40:43], v[56:59], v[72:75], a[40:43]
    v_mfma_f32_16x16x32_bf16 a[44:47], v[56:59], v[76:79], a[44:47]
    v_mfma_f32_16x16x32_bf16 a[48:51], v[60:63], v[64:67], a[48:51]
    v_mfma_f32_16x16x32_bf16 a[52:55], v[60:63], v[68:71], a[52:55]
    v_mfma_f32_16x16x32_bf16 a[56:59], v[60:63], v[72:75], a[56:59]
    v_mfma_f32_16x16x32_bf16 a[60:63], v[60:63], v[76:79], a[60:63]
    s_lshl_b32 s19, s3, 14
    v_add_u32 v4, s19, v1
    ds_write_b128 v4, a[0:3] offset:0
    ds_write_b128 v4, a[4:7] offset:1024
    ds_write_b128 v4, a[8:11] offset:2048
    ds_write_b128 v4, a[12:15] offset:3072
    ds_write_b128 v4, a[16:19] offset:4096
    ds_write_b128 v4, a[20:23] offset:5120
    ds_write_b128 v4, a[24:27] offset:6144
    ds_write_b128 v4, a[28:31] offset:7168
    ds_write_b128 v4, a[32:35] offset:8192
    ds_write_b128 v4, a[36:39] offset:9216
    ds_write_b128 v4, a[40:43] offset:10240
    ds_write_b128 v4, a[44:47] offset:11264
    ds_write_b128 v4, a[48:51] offset:12288
    ds_write_b128 v4, a[52:55] offset:13312
    ds_write_b128 v4, a[56:59] offset:14336
    ds_write_b128 v4, a[60:63] offset:15360
    s_lshl_b32 s19, s13, 2
    s_add_u32 s19, s19, s3
    s_mul_i32 s19, s19, 14336
    s_lshl_b32 s20, s12, 11
    s_add_u32 s19, s19, s20
    s_add_u32 s21, s19, 11370496
    buffer_load_dwordx4 v[80:83], v1, s[8:11], s21 offen
    buffer_load_dwordx4 v[84:87], v1, s[8:11], s21 offen offset:1024
    s_lshl_b32 s20, s12, 7
    v_lshl_add_u32 v5, v3, 3, s20
    buffer_load_dwordx2 v[88:89], v5, s[24:27], 0 offen offset:0
    buffer_load_dwordx2 v[90:91], v5, s[24:27], 0 offen offset:32
    buffer_load_dwordx2 v[92:93], v5, s[24:27], 0 offen offset:64
    buffer_load_dwordx2 v[94:95], v5, s[24:27], 0 offen offset:96
    s_waitcnt lgkmcnt(0)
    s_barrier
    s_lshl_b32 s20, s3, 10
    v_add_u32 v4, s20, v1
    ds_read_b128 v[16:19], v4 offset:0
    ds_read_b128 v[20:23], v4 offset:4096
    ds_read_b128 v[24:27], v4 offset:8192
    ds_read_b128 v[28:31], v4 offset:12288
    ds_read_b128 v[32:35], v4 offset:16384
    ds_read_b128 v[36:39], v4 offset:20480
    ds_read_b128 v[40:43], v4 offset:24576
    ds_read_b128 v[44:47], v4 offset:28672
    ds_read_b128 v[48:51], v4 offset:32768
    ds_read_b128 v[52:55], v4 offset:36864
    ds_read_b128 v[56:59], v4 offset:40960
    ds_read_b128 v[60:63], v4 offset:45056
    ds_read_b128 v[64:67], v4 offset:49152
    ds_read_b128 v[68:71], v4 offset:53248
    ds_read_b128 v[72:75], v4 offset:57344
    ds_read_b128 v[76:79], v4 offset:61440
    s_waitcnt lgkmcnt(8)
    v_add_f32 v16, v16, v32
    v_add_f32 v17, v17, v33
    v_add_f32 v18, v18, v34
    v_add_f32 v19, v19, v35
    v_add_f32 v20, v20, v36
    v_add_f32 v21, v21, v37
    v_add_f32 v22, v22, v38
    v_add_f32 v23, v23, v39
    v_add_f32 v24, v24, v40
    v_add_f32 v25, v25, v41
    v_add_f32 v26, v26, v42
    v_add_f32 v27, v27, v43
    v_add_f32 v28, v28, v44
    v_add_f32 v29, v29, v45
    v_add_f32 v30, v30, v46
    v_add_f32 v31, v31, v47
    s_waitcnt lgkmcnt(0)
    v_add_f32 v48, v48, v64
    v_add_f32 v16, v16, v48
    v_add_f32 v49, v49, v65
    v_add_f32 v17, v17, v49
    v_add_f32 v50, v50, v66
    v_add_f32 v18, v18, v50
    v_add_f32 v51, v51, v67
    v_add_f32 v19, v19, v51
    v_add_f32 v52, v52, v68
    v_add_f32 v20, v20, v52
    v_add_f32 v53, v53, v69
    v_add_f32 v21, v21, v53
    v_add_f32 v54, v54, v70
    v_add_f32 v22, v22, v54
    v_add_f32 v55, v55, v71
    v_add_f32 v23, v23, v55
    v_add_f32 v56, v56, v72
    v_add_f32 v24, v24, v56
    v_add_f32 v57, v57, v73
    v_add_f32 v25, v25, v57
    v_add_f32 v58, v58, v74
    v_add_f32 v26, v26, v58
    v_add_f32 v59, v59, v75
    v_add_f32 v27, v27, v59
    v_add_f32 v60, v60, v76
    v_add_f32 v28, v28, v60
    v_add_f32 v61, v61, v77
    v_add_f32 v29, v29, v61
    v_add_f32 v62, v62, v78
    v_add_f32 v30, v30, v62
    v_add_f32 v63, v63, v79
    v_add_f32 v31, v31, v63
    s_waitcnt vmcnt(0)
    v_cvt_pk_bf16_f32 v6, v16, v17
    v_lshlrev_b32 v16, 16, v6
    v_and_b32 v17, 0xffff0000, v6
    v_lshlrev_b32 v7, 16, v88
    v_and_b32 v8, 0xffff0000, v88
    v_add_f32 v16, v16, v7
    v_add_f32 v17, v17, v8
    v_cvt_pk_bf16_f32 v6, v16, v17
    v_lshlrev_b32 v16, 16, v6
    v_and_b32 v17, 0xffff0000, v6
    v_lshlrev_b32 v7, 16, v80
    v_and_b32 v8, 0xffff0000, v80
    v_add_f32 v16, v16, v7
    v_add_f32 v17, v17, v8
    v_cvt_pk_bf16_f32 v96, v16, v17
    v_cvt_pk_bf16_f32 v6, v18, v19
    v_lshlrev_b32 v18, 16, v6
    v_and_b32 v19, 0xffff0000, v6
    v_lshlrev_b32 v7, 16, v89
    v_and_b32 v8, 0xffff0000, v89
    v_add_f32 v18, v18, v7
    v_add_f32 v19, v19, v8
    v_cvt_pk_bf16_f32 v6, v18, v19
    v_lshlrev_b32 v18, 16, v6
    v_and_b32 v19, 0xffff0000, v6
    v_lshlrev_b32 v7, 16, v81
    v_and_b32 v8, 0xffff0000, v81
    v_add_f32 v18, v18, v7
    v_add_f32 v19, v19, v8
    v_cvt_pk_bf16_f32 v97, v18, v19
    v_cvt_pk_bf16_f32 v6, v20, v21
    v_lshlrev_b32 v20, 16, v6
    v_and_b32 v21, 0xffff0000, v6
    v_lshlrev_b32 v7, 16, v90
    v_and_b32 v8, 0xffff0000, v90
    v_add_f32 v20, v20, v7
    v_add_f32 v21, v21, v8
    v_cvt_pk_bf16_f32 v6, v20, v21
    v_lshlrev_b32 v20, 16, v6
    v_and_b32 v21, 0xffff0000, v6
    v_lshlrev_b32 v7, 16, v82
    v_and_b32 v8, 0xffff0000, v82
    v_add_f32 v20, v20, v7
    v_add_f32 v21, v21, v8
    v_cvt_pk_bf16_f32 v98, v20, v21
    v_cvt_pk_bf16_f32 v6, v22, v23
    v_lshlrev_b32 v22, 16, v6
    v_and_b32 v23, 0xffff0000, v6
    v_lshlrev_b32 v7, 16, v91
    v_and_b32 v8, 0xffff0000, v91
    v_add_f32 v22, v22, v7
    v_add_f32 v23, v23, v8
    v_cvt_pk_bf16_f32 v6, v22, v23
    v_lshlrev_b32 v22, 16, v6
    v_and_b32 v23, 0xffff0000, v6
    v_lshlrev_b32 v7, 16, v83
    v_and_b32 v8, 0xffff0000, v83
    v_add_f32 v22, v22, v7
    v_add_f32 v23, v23, v8
    v_cvt_pk_bf16_f32 v99, v22, v23
    v_cvt_pk_bf16_f32 v6, v24, v25
    v_lshlrev_b32 v24, 16, v6
    v_and_b32 v25, 0xffff0000, v6
    v_lshlrev_b32 v7, 16, v92
    v_and_b32 v8, 0xffff0000, v92
    v_add_f32 v24, v24, v7
    v_add_f32 v25, v25, v8
    v_cvt_pk_bf16_f32 v6, v24, v25
    v_lshlrev_b32 v24, 16, v6
    v_and_b32 v25, 0xffff0000, v6
    v_lshlrev_b32 v7, 16, v84
    v_and_b32 v8, 0xffff0000, v84
    v_add_f32 v24, v24, v7
    v_add_f32 v25, v25, v8
    v_cvt_pk_bf16_f32 v100, v24, v25
    v_cvt_pk_bf16_f32 v6, v26, v27
    v_lshlrev_b32 v26, 16, v6
    v_and_b32 v27, 0xffff0000, v6
    v_lshlrev_b32 v7, 16, v93
    v_and_b32 v8, 0xffff0000, v93
    v_add_f32 v26, v26, v7
    v_add_f32 v27, v27, v8
    v_cvt_pk_bf16_f32 v6, v26, v27
    v_lshlrev_b32 v26, 16, v6
    v_and_b32 v27, 0xffff0000, v6
    v_lshlrev_b32 v7, 16, v85
    v_and_b32 v8, 0xffff0000, v85
    v_add_f32 v26, v26, v7
    v_add_f32 v27, v27, v8
    v_cvt_pk_bf16_f32 v101, v26, v27
    v_cvt_pk_bf16_f32 v6, v28, v29
    v_lshlrev_b32 v28, 16, v6
    v_and_b32 v29, 0xffff0000, v6
    v_lshlrev_b32 v7, 16, v94
    v_and_b32 v8, 0xffff0000, v94
    v_add_f32 v28, v28, v7
    v_add_f32 v29, v29, v8
    v_cvt_pk_bf16_f32 v6, v28, v29
    v_lshlrev_b32 v28, 16, v6
    v_and_b32 v29, 0xffff0000, v6
    v_lshlrev_b32 v7, 16, v86
    v_and_b32 v8, 0xffff0000, v86
    v_add_f32 v28, v28, v7
    v_add_f32 v29, v29, v8
    v_cvt_pk_bf16_f32 v102, v28, v29
    v_cvt_pk_bf16_f32 v6, v30, v31
    v_lshlrev_b32 v30, 16, v6
    v_and_b32 v31, 0xffff0000, v6
    v_lshlrev_b32 v7, 16, v95
    v_and_b32 v8, 0xffff0000, v95
    v_add_f32 v30, v30, v7
    v_add_f32 v31, v31, v8
    v_cvt_pk_bf16_f32 v6, v30, v31
    v_lshlrev_b32 v30, 16, v6
    v_and_b32 v31, 0xffff0000, v6
    v_lshlrev_b32 v7, 16, v87
    v_and_b32 v8, 0xffff0000, v87
    v_add_f32 v30, v30, v7
    v_add_f32 v31, v31, v8
    v_cvt_pk_bf16_f32 v103, v30, v31
    s_add_u32 s21, s19, 13205504
    buffer_store_dwordx4 v[96:99], v1, s[8:11], s21 offen
    buffer_store_dwordx4 v[100:103], v1, s[8:11], s21 offen offset:1024
    s_nop 11
K4_END_11370496:
    s_endpgm
.globl qkv1_kernel
.p2align 8
.type qkv1_kernel,@function
qkv1_kernel:
    s_load_dwordx2 s[4:5], s[0:1], 88
    s_cmp_ge_u32 s2, 256
    s_cbranch_scc1 K1_END_13205504
    v_lshrrev_b32 v1, 6, v0
    v_and_b32 v0, 63, v0
    v_readfirstlane_b32 s3, v1
    v_lshlrev_b32 v1, 4, v0
    v_and_b32 v2, 15, v0
    v_lshrrev_b32 v3, 4, v0
    s_waitcnt lgkmcnt(0)
    s_mov_b32 s8, s4
    s_and_b32 s9, s5, 0xffff
    s_mov_b32 s10, 0x10000000
    s_mov_b32 s11, 0x00020000
    s_and_b32 s12, s2, 7
    s_lshr_b32 s13, s2, 3
    s_and_b32 s14, s12, 1
    s_lshl_b32 s14, s14, 3
    s_lshr_b32 s15, s13, 2
    s_add_u32 s14, s14, s15
    s_lshr_b32 s15, s12, 1
    s_lshl_b32 s15, s15, 2
    s_and_b32 s16, s13, 3
    s_add_u32 s15, s15, s16
    s_mul_i32 s16, s14, 86016
    s_add_u32 s16, s16, 1835008
    s_lshl_b32 s17, s15, 3
    s_add_u32 s17, s17, s3
    s_mov_b32 s30, s17
    s_mul_i32 s17, s17, 14336
    s_add_u32 s17, s17, 13205504
    s_lshl_b32 s19, s14, 11
    s_add_u32 s19, s19, 3211264
    buffer_load_dwordx4 v[140:143], v1, s[8:11], s19 offen
    buffer_load_dwordx4 v[144:147], v1, s[8:11], s19 offen offset:1024
    v_mov_b32 v104, 0x3f803f80
    v_mov_b32 v105, 0x3f803f80
    v_mov_b32 v106, 0x3f803f80
    v_mov_b32 v107, 0x3f803f80
    s_add_u32 s19, s3, 0
    s_add_u32 s19, s19, 0
    s_lshl_b32 s19, s19, 10
    s_mov_b32 m0, s19
    s_add_u32 s19, s19, s16
    buffer_load_dwordx4 v1, s[8:11], s19 offen lds
    s_add_u32 s19, s3, 8
    s_add_u32 s19, s19, 0
    s_lshl_b32 s19, s19, 10
    s_mov_b32 m0, s19
    s_add_u32 s19, s19, s16
    buffer_load_dwordx4 v1, s[8:11], s19 offen lds
    s_add_u32 s19, s3, 16
    s_add_u32 s19, s19, 0
    s_lshl_b32 s19, s19, 10
    s_mov_b32 m0, s19
    s_add_u32 s19, s19, s16
    buffer_load_dwordx4 v1, s[8:11], s19 offen lds
    s_add_u32 s19, s17, 0
    buffer_load_dwordx4 v[16:19], v1, s[8:11], s19 offen
    s_add_u32 s19, s17, 1024
    buffer_load_dwordx4 v[20:23], v1, s[8:11], s19 offen
    s_add_u32 s19, s17, 2048
    buffer_load_dwordx4 v[24:27], v1, s[8:11], s19 offen
    s_add_u32 s19, s17, 3072
    buffer_load_dwordx4 v[28:31], v1, s[8:11], s19 offen
    s_add_u32 s19, s3, 0
    s_add_u32 s19, s19, 24
    s_lshl_b32 s19, s19, 10
    s_mov_b32 m0, s19
    s_add_u32 s19, s19, s16
    buffer_load_dwordx4 v1, s[8:11], s19 offen lds
    s_add_u32 s19, s3, 8
    s_add_u32 s19, s19, 24
    s_lshl_b32 s19, s19, 10
    s_mov_b32 m0, s19
    s_add_u32 s19, s19, s16
    buffer_load_dwordx4 v1, s[8:11], s19 offen lds
    s_add_u32 s19, s3, 16
    s_add_u32 s19, s19, 24
    s_lshl_b32 s19, s19, 10
    s_mov_b32 m0, s19
    s_add_u32 s19, s19, s16
    buffer_load_dwordx4 v1, s[8:11], s19 offen lds
    s_add_u32 s19, s17, 4096
    buffer_load_dwordx4 v[32:35], v1, s[8:11], s19 offen
    s_add_u32 s19, s17, 5120
    buffer_load_dwordx4 v[36:39], v1, s[8:11], s19 offen
    s_add_u32 s19, s17, 6144
    buffer_load_dwordx4 v[40:43], v1, s[8:11], s19 offen
    s_add_u32 s19, s17, 7168
    buffer_load_dwordx4 v[44:47], v1, s[8:11], s19 offen
    v_add_u32 v4, 0x10000, v1
    s_min_u32 s19, s3, 5
    s_lshl_b32 s19, s19, 10
    v_add_u32 v5, s19, v1
    v_add_u32 v6, 0x10000, v5
    s_waitcnt vmcnt(7)
    s_barrier
    ds_read_b128 a[0:3], v1 offset:0
    ds_read_b128 a[4:7], v1 offset:1024
    ds_read_b128 a[8:11], v1 offset:2048
    ds_read_b128 a[12:15], v1 offset:3072
    ds_read_b128 a[16:19], v1 offset:4096
    ds_read_b128 a[20:23], v1 offset:5120
    ds_read_b128 a[48:51], v5 offset:0
    ds_read_b128 a[24:27], v1 offset:6144
    ds_read_b128 a[28:31], v1 offset:7168
    ds_read_b128 a[32:35], v1 offset:8192
    ds_read_b128 a[36:39], v1 offset:9216
    ds_read_b128 a[40:43], v1 offset:10240
    ds_read_b128 a[44:47], v1 offset:11264
    ds_read_b128 a[52:55], v5 offset:6144
    s_waitcnt lgkmcnt(7)
    v_mfma_f32_16x16x32_bf16 v[72:75], a[0:3], v[16:19], 0
    v_mfma_f32_16x16x32_bf16 v[76:79], a[4:7], v[16:19], 0
    v_mfma_f32_16x16x32_bf16 v[80:83], a[8:11], v[16:19], 0
    v_mfma_f32_16x16x32_bf16 v[84:87], a[12:15], v[16:19], 0
    v_mfma_f32_16x16x32_bf16 v[88:91], a[16:19], v[16:19], 0
    v_mfma_f32_16x16x32_bf16 v[92:95], a[20:23], v[16:19], 0
    v_mfma_f32_16x16x32_bf16 v[110:113], a[48:51], v[104:107], 0
    v_dot2_f32_bf16 v108, v16, v104, 0
    v_dot2_f32_bf16 v109, v16, v16, 0
    v_dot2_f32_bf16 v108, v17, v104, v108
    v_dot2_f32_bf16 v109, v17, v17, v109
    v_dot2_f32_bf16 v108, v18, v104, v108
    v_dot2_f32_bf16 v109, v18, v18, v109
    v_dot2_f32_bf16 v108, v19, v104, v108
    v_dot2_f32_bf16 v109, v19, v19, v109
    ds_read_b128 a[0:3], v1 offset:12288
    ds_read_b128 a[4:7], v1 offset:13312
    ds_read_b128 a[8:11], v1 offset:14336
    ds_read_b128 a[12:15], v1 offset:15360
    ds_read_b128 a[16:19], v1 offset:16384
    ds_read_b128 a[20:23], v1 offset:17408
    ds_read_b128 a[48:51], v5 offset:12288
    s_waitcnt lgkmcnt(7)
    v_mfma_f32_16x16x32_bf16 v[72:75], a[24:27], v[20:23], v[72:75]
    v_mfma_f32_16x16x32_bf16 v[76:79], a[28:31], v[20:23], v[76:79]
    v_mfma_f32_16x16x32_bf16 v[80:83], a[32:35], v[20:23], v[80:83]
    v_mfma_f32_16x16x32_bf16 v[84:87], a[36:39], v[20:23], v[84:87]
    v_mfma_f32_16x16x32_bf16 v[88:91], a[40:43], v[20:23], v[88:91]
    v_mfma_f32_16x16x32_bf16 v[92:95], a[44:47], v[20:23], v[92:95]
    v_mfma_f32_16x16x32_bf16 v[110:113], a[52:55], v[104:107], v[110:113]
    v_dot2_f32_bf16 v108, v20, v104, v108
    v_dot2_f32_bf16 v109, v20, v20, v109
    v_dot2_f32_bf16 v108, v21, v104, v108
    v_dot2_f32_bf16 v109, v21, v21, v109
    v_dot2_f32_bf16 v108, v22, v104, v108
    v_dot2_f32_bf16 v109, v22, v22, v109
    v_dot2_f32_bf16 v108, v23, v104, v108
    v_dot2_f32_bf16 v109, v23, v23, v109
    ds_read_b128 a[24:27], v1 offset:18432
    ds_read_b128 a[28:31], v1 offset:19456
    ds_read_b128 a[32:35], v1 offset:20480
    ds_read_b128 a[36:39], v1 offset:21504
    ds_read_b128 a[40:43], v1 offset:22528
    ds_read_b128 a[44:47], v1 offset:23552
    ds_read_b128 a[52:55], v5 offset:18432
    s_waitcnt lgkmcnt(7)
    v_mfma_f32_16x16x32_bf16 v[72:75], a[0:3], v[24:27], v[72:75]
    v_mfma_f32_16x16x32_bf16 v[76:79], a[4:7], v[24:27], v[76:79]
    v_mfma_f32_16x16x32_bf16 v[80:83], a[8:11], v[24:27], v[80:83]
    v_mfma_f32_16x16x32_bf16 v[84:87], a[12:15], v[24:27], v[84:87]
    v_mfma_f32_16x16x32_bf16 v[88:91], a[16:19], v[24:27], v[88:91]
    v_mfma_f32_16x16x32_bf16 v[92:95], a[20:23], v[24:27], v[92:95]
    v_mfma_f32_16x16x32_bf16 v[110:113], a[48:51], v[104:107], v[110:113]
    v_dot2_f32_bf16 v108, v24, v104, v108
    v_dot2_f32_bf16 v109, v24, v24, v109
    v_dot2_f32_bf16 v108, v25, v104, v108
    v_dot2_f32_bf16 v109, v25, v25, v109
    v_dot2_f32_bf16 v108, v26, v104, v108
    v_dot2_f32_bf16 v109, v26, v26, v109
    v_dot2_f32_bf16 v108, v27, v104, v108
    v_dot2_f32_bf16 v109, v27, v27, v109
    s_waitcnt vmcnt(0)
    s_barrier
    s_add_u32 s19, s3, 0
    s_add_u32 s19, s19, 48
    s_lshl_b32 s19, s19, 10
    s_mov_b32 m0, s19
    s_add_u32 s19, s19, s16
    buffer_load_dwordx4 v1, s[8:11], s19 offen lds
    s_add_u32 s19, s3, 8
    s_add_u32 s19, s19, 48
    s_lshl_b32 s19, s19, 10
    s_mov_b32 m0, s19
    s_add_u32 s19, s19, s16
    buffer_load_dwordx4 v1, s[8:11], s19 offen lds
    s_add_u32 s19, s3, 16
    s_add_u32 s19, s19, 48
    s_lshl_b32 s19, s19, 10
    s_mov_b32 m0, s19
    s_add_u32 s19, s19, s16
    buffer_load_dwordx4 v1, s[8:11], s19 offen lds
    s_add_u32 s19, s17, 8192
    buffer_load_dwordx4 v[48:51], v1, s[8:11], s19 offen
    s_add_u32 s19, s17, 9216
    buffer_load_dwordx4 v[52:55], v1, s[8:11], s19 offen
    s_add_u32 s19, s17, 10240
    buffer_load_dwordx4 v[56:59], v1, s[8:11], s19 offen
    s_add_u32 s19, s17, 11264
    buffer_load_dwordx4 v[60:63], v1, s[8:11], s19 offen
    ds_read_b128 a[0:3], v1 offset:24576
    ds_read_b128 a[4:7], v1 offset:25600
    ds_read_b128 a[8:11], v1 offset:26624
    ds_read_b128 a[12:15], v1 offset:27648
    ds_read_b128 a[16:19], v1 offset:28672
    ds_read_b128 a[20:23], v1 offset:29696
    ds_read_b128 a[48:51], v5 offset:24576
    s_waitcnt lgkmcnt(7)
    v_mfma_f32_16x16x32_bf16 v[72:75], a[24:27], v[28:31], v[72:75]
    v_mfma_f32_16x16x32_bf16 v[76:79], a[28:31], v[28:31], v[76:79]
    v_mfma_f32_16x16x32_bf16 v[80:83], a[32:35], v[28:31], v[80:83]
    v_mfma_f32_16x16x32_bf16 v[84:87], a[36:39], v[28:31], v[84:87]
    v_mfma_f32_16x16x32_bf16 v[88:91], a[40:43], v[28:31], v[88:91]
    v_mfma_f32_16x16x32_bf16 v[92:95], a[44:47], v[28:31], v[92:95]
    v_mfma_f32_16x16x32_bf16 v[110:113], a[52:55], v[104:107], v[110:113]
    v_dot2_f32_bf16 v108, v28, v104, v108
    v_dot2_f32_bf16 v109, v28, v28, v109
    v_dot2_f32_bf16 v108, v29, v104, v108
    v_dot2_f32_bf16 v109, v29, v29, v109
    v_dot2_f32_bf16 v108, v30, v104, v108
    v_dot2_f32_bf16 v109, v30, v30, v109
    v_dot2_f32_bf16 v108, v31, v104, v108
    v_dot2_f32_bf16 v109, v31, v31, v109
    ds_read_b128 a[24:27], v1 offset:30720
    ds_read_b128 a[28:31], v1 offset:31744
    ds_read_b128 a[32:35], v1 offset:32768
    ds_read_b128 a[36:39], v1 offset:33792
    ds_read_b128 a[40:43], v1 offset:34816
    ds_read_b128 a[44:47], v1 offset:35840
    ds_read_b128 a[52:55], v5 offset:30720
    s_waitcnt lgkmcnt(7)
    v_mfma_f32_16x16x32_bf16 v[72:75], a[0:3], v[32:35], v[72:75]
    v_mfma_f32_16x16x32_bf16 v[76:79], a[4:7], v[32:35], v[76:79]
    v_mfma_f32_16x16x32_bf16 v[80:83], a[8:11], v[32:35], v[80:83]
    v_mfma_f32_16x16x32_bf16 v[84:87], a[12:15], v[32:35], v[84:87]
    v_mfma_f32_16x16x32_bf16 v[88:91], a[16:19], v[32:35], v[88:91]
    v_mfma_f32_16x16x32_bf16 v[92:95], a[20:23], v[32:35], v[92:95]
    v_mfma_f32_16x16x32_bf16 v[110:113], a[48:51], v[104:107], v[110:113]
    v_dot2_f32_bf16 v108, v32, v104, v108
    v_dot2_f32_bf16 v109, v32, v32, v109
    v_dot2_f32_bf16 v108, v33, v104, v108
    v_dot2_f32_bf16 v109, v33, v33, v109
    v_dot2_f32_bf16 v108, v34, v104, v108
    v_dot2_f32_bf16 v109, v34, v34, v109
    v_dot2_f32_bf16 v108, v35, v104, v108
    v_dot2_f32_bf16 v109, v35, v35, v109
    ds_read_b128 a[0:3], v1 offset:36864
    ds_read_b128 a[4:7], v1 offset:37888
    ds_read_b128 a[8:11], v1 offset:38912
    ds_read_b128 a[12:15], v1 offset:39936
    ds_read_b128 a[16:19], v1 offset:40960
    ds_read_b128 a[20:23], v1 offset:41984
    ds_read_b128 a[48:51], v5 offset:36864
    s_waitcnt lgkmcnt(7)
    v_mfma_f32_16x16x32_bf16 v[72:75], a[24:27], v[36:39], v[72:75]
    v_mfma_f32_16x16x32_bf16 v[76:79], a[28:31], v[36:39], v[76:79]
    v_mfma_f32_16x16x32_bf16 v[80:83], a[32:35], v[36:39], v[80:83]
    v_mfma_f32_16x16x32_bf16 v[84:87], a[36:39], v[36:39], v[84:87]
    v_mfma_f32_16x16x32_bf16 v[88:91], a[40:43], v[36:39], v[88:91]
    v_mfma_f32_16x16x32_bf16 v[92:95], a[44:47], v[36:39], v[92:95]
    v_mfma_f32_16x16x32_bf16 v[110:113], a[52:55], v[104:107], v[110:113]
    v_dot2_f32_bf16 v108, v36, v104, v108
    v_dot2_f32_bf16 v109, v36, v36, v109
    v_dot2_f32_bf16 v108, v37, v104, v108
    v_dot2_f32_bf16 v109, v37, v37, v109
    v_dot2_f32_bf16 v108, v38, v104, v108
    v_dot2_f32_bf16 v109, v38, v38, v109
    v_dot2_f32_bf16 v108, v39, v104, v108
    v_dot2_f32_bf16 v109, v39, v39, v109
    ds_read_b128 a[24:27], v1 offset:43008
    ds_read_b128 a[28:31], v1 offset:44032
    ds_read_b128 a[32:35], v1 offset:45056
    ds_read_b128 a[36:39], v1 offset:46080
    ds_read_b128 a[40:43], v1 offset:47104
    ds_read_b128 a[44:47], v1 offset:48128
    ds_read_b128 a[52:55], v5 offset:43008
    s_waitcnt lgkmcnt(7)
    v_mfma_f32_16x16x32_bf16 v[72:75], a[0:3], v[40:43], v[72:75]
    v_mfma_f32_16x16x32_bf16 v[76:79], a[4:7], v[40:43], v[76:79]
    v_mfma_f32_16x16x32_bf16 v[80:83], a[8:11], v[40:43], v[80:83]
    v_mfma_f32_16x16x32_bf16 v[84:87], a[12:15], v[40:43], v[84:87]
    v_mfma_f32_16x16x32_bf16 v[88:91], a[16:19], v[40:43], v[88:91]
    v_mfma_f32_16x16x32_bf16 v[92:95], a[20:23], v[40:43], v[92:95]
    v_mfma_f32_16x16x32_bf16 v[110:113], a[48:51], v[104:107], v[110:113]
    v_dot2_f32_bf16 v108, v40, v104, v108
    v_dot2_f32_bf16 v109, v40, v40, v109
    v_dot2_f32_bf16 v108, v41, v104, v108
    v_dot2_f32_bf16 v109, v41, v41, v109
    v_dot2_f32_bf16 v108, v42, v104, v108
    v_dot2_f32_bf16 v109, v42, v42, v109
    v_dot2_f32_bf16 v108, v43, v104, v108
    v_dot2_f32_bf16 v109, v43, v43, v109
    s_waitcnt vmcnt(0)
    s_barrier
    s_add_u32 s19, s3, 0
    s_add_u32 s19, s19, 72
    s_lshl_b32 s19, s19, 10
    s_mov_b32 m0, s19
    s_add_u32 s19, s19, s16
    buffer_load_dwordx4 v1, s[8:11], s19 offen lds
    s_add_u32 s19, s3, 8
    s_min_u32 s19, s19, 11
    s_add_u32 s19, s19, 72
    s_lshl_b32 s19, s19, 10
    s_mov_b32 m0, s19
    s_add_u32 s19, s19, s16
    buffer_load_dwordx4 v1, s[8:11], s19 offen lds
    s_add_u32 s19, s17, 12288
    buffer_load_dwordx4 v[64:67], v1, s[8:11], s19 offen
    s_add_u32 s19, s17, 13312
    buffer_load_dwordx4 v[68:71], v1, s[8:11], s19 offen
    ds_read_b128 a[0:3], v1 offset:49152
    ds_read_b128 a[4:7], v1 offset:50176
    ds_read_b128 a[8:11], v1 offset:51200
    ds_read_b128 a[12:15], v1 offset:52224
    ds_read_b128 a[16:19], v1 offset:53248
    ds_read_b128 a[20:23], v1 offset:54272
    ds_read_b128 a[48:51], v5 offset:49152
    s_waitcnt lgkmcnt(7)
    v_mfma_f32_16x16x32_bf16 v[72:75], a[24:27], v[44:47], v[72:75]
    v_mfma_f32_16x16x32_bf16 v[76:79], a[28:31], v[44:47], v[76:79]
    v_mfma_f32_16x16x32_bf16 v[80:83], a[32:35], v[44:47], v[80:83]
    v_mfma_f32_16x16x32_bf16 v[84:87], a[36:39], v[44:47], v[84:87]
    v_mfma_f32_16x16x32_bf16 v[88:91], a[40:43], v[44:47], v[88:91]
    v_mfma_f32_16x16x32_bf16 v[92:95], a[44:47], v[44:47], v[92:95]
    v_mfma_f32_16x16x32_bf16 v[110:113], a[52:55], v[104:107], v[110:113]
    v_dot2_f32_bf16 v108, v44, v104, v108
    v_dot2_f32_bf16 v109, v44, v44, v109
    v_dot2_f32_bf16 v108, v45, v104, v108
    v_dot2_f32_bf16 v109, v45, v45, v109
    v_dot2_f32_bf16 v108, v46, v104, v108
    v_dot2_f32_bf16 v109, v46, v46, v109
    v_dot2_f32_bf16 v108, v47, v104, v108
    v_dot2_f32_bf16 v109, v47, v47, v109
    ds_read_b128 a[24:27], v1 offset:55296
    ds_read_b128 a[28:31], v1 offset:56320
    ds_read_b128 a[32:35], v1 offset:57344
    ds_read_b128 a[36:39], v1 offset:58368
    ds_read_b128 a[40:43], v1 offset:59392
    ds_read_b128 a[44:47], v1 offset:60416
    ds_read_b128 a[52:55], v5 offset:55296
    s_waitcnt lgkmcnt(7)
    v_mfma_f32_16x16x32_bf16 v[72:75], a[0:3], v[48:51], v[72:75]
    v_mfma_f32_16x16x32_bf16 v[76:79], a[4:7], v[48:51], v[76:79]
    v_mfma_f32_16x16x32_bf16 v[80:83], a[8:11], v[48:51], v[80:83]
    v_mfma_f32_16x16x32_bf16 v[84:87], a[12:15], v[48:51], v[84:87]
    v_mfma_f32_16x16x32_bf16 v[88:91], a[16:19], v[48:51], v[88:91]
    v_mfma_f32_16x16x32_bf16 v[92:95], a[20:23], v[48:51], v[92:95]
    v_mfma_f32_16x16x32_bf16 v[110:113], a[48:51], v[104:107], v[110:113]
    v_dot2_f32_bf16 v108, v48, v104, v108
    v_dot2_f32_bf16 v109, v48, v48, v109
    v_dot2_f32_bf16 v108, v49, v104, v108
    v_dot2_f32_bf16 v109, v49, v49, v109
    v_dot2_f32_bf16 v108, v50, v104, v108
    v_dot2_f32_bf16 v109, v50, v50, v109
    v_dot2_f32_bf16 v108, v51, v104, v108
    v_dot2_f32_bf16 v109, v51, v51, v109
    ds_read_b128 a[0:3], v1 offset:61440
    ds_read_b128 a[4:7], v1 offset:62464
    ds_read_b128 a[8:11], v1 offset:63488
    ds_read_b128 a[12:15], v1 offset:64512
    ds_read_b128 a[16:19], v4 offset:0
    ds_read_b128 a[20:23], v4 offset:1024
    ds_read_b128 a[48:51], v5 offset:61440
    s_waitcnt lgkmcnt(7)
    v_mfma_f32_16x16x32_bf16 v[72:75], a[24:27], v[52:55], v[72:75]
    v_mfma_f32_16x16x32_bf16 v[76:79], a[28:31], v[52:55], v[76:79]
    v_mfma_f32_16x16x32_bf16 v[80:83], a[32:35], v[52:55], v[80:83]
    v_mfma_f32_16x16x32_bf16 v[84:87], a[36:39], v[52:55], v[84:87]
    v_mfma_f32_16x16x32_bf16 v[88:91], a[40:43], v[52:55], v[88:91]
    v_mfma_f32_16x16x32_bf16 v[92:95], a[44:47], v[52:55], v[92:95]
    v_mfma_f32_16x16x32_bf16 v[110:113], a[52:55], v[104:107], v[110:113]
    v_dot2_f32_bf16 v108, v52, v104, v108
    v_dot2_f32_bf16 v109, v52, v52, v109
    v_dot2_f32_bf16 v108, v53, v104, v108
    v_dot2_f32_bf16 v109, v53, v53, v109
    v_dot2_f32_bf16 v108, v54, v104, v108
    v_dot2_f32_bf16 v109, v54, v54, v109
    v_dot2_f32_bf16 v108, v55, v104, v108
    v_dot2_f32_bf16 v109, v55, v55, v109
    ds_read_b128 a[24:27], v4 offset:2048
    ds_read_b128 a[28:31], v4 offset:3072
    ds_read_b128 a[32:35], v4 offset:4096
    ds_read_b128 a[36:39], v4 offset:5120
    ds_read_b128 a[40:43], v4 offset:6144
    ds_read_b128 a[44:47], v4 offset:7168
    ds_read_b128 a[52:55], v6 offset:2048
    s_waitcnt lgkmcnt(7)
    v_mfma_f32_16x16x32_bf16 v[72:75], a[0:3], v[56:59], v[72:75]
    v_mfma_f32_16x16x32_bf16 v[76:79], a[4:7], v[56:59], v[76:79]
    v_mfma_f32_16x16x32_bf16 v[80:83], a[8:11], v[56:59], v[80:83]
    v_mfma_f32_16x16x32_bf16 v[84:87], a[12:15], v[56:59], v[84:87]
    v_mfma_f32_16x16x32_bf16 v[88:91], a[16:19], v[56:59], v[88:91]
    v_mfma_f32_16x16x32_bf16 v[92:95], a[20:23], v[56:59], v[92:95]
    v_mfma_f32_16x16x32_bf16 v[110:113], a[48:51], v[104:107], v[110:113]
    v_dot2_f32_bf16 v108, v56, v104, v108
    v_dot2_f32_bf16 v109, v56, v56, v109
    v_dot2_f32_bf16 v108, v57, v104, v108
    v_dot2_f32_bf16 v109, v57, v57, v109
    v_dot2_f32_bf16 v108, v58, v104, v108
    v_dot2_f32_bf16 v109, v58, v58, v109
    v_dot2_f32_bf16 v108, v59, v104, v108
    v_dot2_f32_bf16 v109, v59, v59, v109
    s_waitcnt vmcnt(0)
    s_barrier
    ds_read_b128 a[0:3], v4 offset:8192
    ds_read_b128 a[4:7], v4 offset:9216
    ds_read_b128 a[8:11], v4 offset:10240
    ds_read_b128 a[12:15], v4 offset:11264
    ds_read_b128 a[16:19], v4 offset:12288
    ds_read_b128 a[20:23], v4 offset:13312
    ds_read_b128 a[48:51], v6 offset:8192
    s_waitcnt lgkmcnt(7)
    v_mfma_f32_16x16x32_bf16 v[72:75], a[24:27], v[60:63], v[72:75]
    v_mfma_f32_16x16x32_bf16 v[76:79], a[28:31], v[60:63], v[76:79]
    v_mfma_f32_16x16x32_bf16 v[80:83], a[32:35], v[60:63], v[80:83]
    v_mfma_f32_16x16x32_bf16 v[84:87], a[36:39], v[60:63], v[84:87]
    v_mfma_f32_16x16x32_bf16 v[88:91], a[40:43], v[60:63], v[88:91]
    v_mfma_f32_16x16x32_bf16 v[92:95], a[44:47], v[60:63], v[92:95]
    v_mfma_f32_16x16x32_bf16 v[110:113], a[52:55], v[104:107], v[110:113]
    v_dot2_f32_bf16 v108, v60, v104, v108
    v_dot2_f32_bf16 v109, v60, v60, v109
    v_dot2_f32_bf16 v108, v61, v104, v108
    v_dot2_f32_bf16 v109, v61, v61, v109
    v_dot2_f32_bf16 v108, v62, v104, v108
    v_dot2_f32_bf16 v109, v62, v62, v109
    v_dot2_f32_bf16 v108, v63, v104, v108
    v_dot2_f32_bf16 v109, v63, v63, v109
    ds_read_b128 a[24:27], v4 offset:14336
    ds_read_b128 a[28:31], v4 offset:15360
    ds_read_b128 a[32:35], v4 offset:16384
    ds_read_b128 a[36:39], v4 offset:17408
    ds_read_b128 a[40:43], v4 offset:18432
    ds_read_b128 a[44:47], v4 offset:19456
    ds_read_b128 a[52:55], v6 offset:14336
    s_waitcnt lgkmcnt(7)
    v_mfma_f32_16x16x32_bf16 v[72:75], a[0:3], v[64:67], v[72:75]
    v_mfma_f32_16x16x32_bf16 v[76:79], a[4:7], v[64:67], v[76:79]
    v_mfma_f32_16x16x32_bf16 v[80:83], a[8:11], v[64:67], v[80:83]
    v_mfma_f32_16x16x32_bf16 v[84:87], a[12:15], v[64:67], v[84:87]
    v_mfma_f32_16x16x32_bf16 v[88:91], a[16:19], v[64:67], v[88:91]
    v_mfma_f32_16x16x32_bf16 v[92:95], a[20:23], v[64:67], v[92:95]
    v_mfma_f32_16x16x32_bf16 v[110:113], a[48:51], v[104:107], v[110:113]
    v_dot2_f32_bf16 v108, v64, v104, v108
    v_dot2_f32_bf16 v109, v64, v64, v109
    v_dot2_f32_bf16 v108, v65, v104, v108
    v_dot2_f32_bf16 v109, v65, v65, v109
    v_dot2_f32_bf16 v108, v66, v104, v108
    v_dot2_f32_bf16 v109, v66, v66, v109
    v_dot2_f32_bf16 v108, v67, v104, v108
    v_dot2_f32_bf16 v109, v67, v67, v109
    s_waitcnt lgkmcnt(0)
    v_mfma_f32_16x16x32_bf16 v[72:75], a[24:27], v[68:71], v[72:75]
    v_mfma_f32_16x16x32_bf16 v[76:79], a[28:31], v[68:71], v[76:79]
    v_mfma_f32_16x16x32_bf16 v[80:83], a[32:35], v[68:71], v[80:83]
    v_mfma_f32_16x16x32_bf16 v[84:87], a[36:39], v[68:71], v[84:87]
    v_mfma_f32_16x16x32_bf16 v[88:91], a[40:43], v[68:71], v[88:91]
    v_mfma_f32_16x16x32_bf16 v[92:95], a[44:47], v[68:71], v[92:95]
    v_mfma_f32_16x16x32_bf16 v[110:113], a[52:55], v[104:107], v[110:113]
    v_dot2_f32_bf16 v108, v68, v104, v108
    v_dot2_f32_bf16 v109, v68, v68, v109
    v_dot2_f32_bf16 v108, v69, v104, v108
    v_dot2_f32_bf16 v109, v69, v69, v109
    v_dot2_f32_bf16 v108, v70, v104, v108
    v_dot2_f32_bf16 v109, v70, v70, v109
    v_dot2_f32_bf16 v108, v71, v104, v108
    v_dot2_f32_bf16 v109, v71, v71, v109
    s_min_u32 s19, s3, 5
    s_lshl_b32 s19, s19, 10
    v_add_u32 v5, s19, v1
    ds_write_b128 v6, v[110:113] offset:20480
    v_mov_b32 v7, v108
    s_nop 1
    v_permlane16_swap_b32 v108, v7
    v_add_f32 v108, v108, v7
    v_mov_b32 v7, v108
    s_nop 1
    v_permlane32_swap_b32 v108, v7
    v_add_f32 v108, v108, v7
    v_mov_b32 v7, v109
    s_nop 1
    v_permlane16_swap_b32 v109, v7
    v_add_f32 v109, v109, v7
    v_mov_b32 v7, v109
    s_nop 1
    v_permlane32_swap_b32 v109, v7
    v_add_f32 v109, v109, v7
    s_waitcnt lgkmcnt(0)
    s_barrier
    ds_read_b128 v[114:117], v4 offset:20480
    ds_read_b128 v[118:121], v4 offset:21504
    ds_read_b128 v[122:125], v4 offset:22528
    ds_read_b128 v[126:129], v4 offset:23552
    ds_read_b128 v[130:133], v4 offset:24576
    ds_read_b128 v[134:137], v4 offset:25600
    v_mul_f32 v10, 0x3b124925, v108
    v_mul_f32 v11, 0x3b124925, v109
    v_fma_f32 v11, -v10, v10, v11
    v_max_f32 v11, 0, v11
    v_cvt_pk_bf16_f32 v10, v10, v10
    v_lshlrev_b32 v8, 16, v10
    v_cvt_pk_bf16_f32 v10, v11, v11
    v_lshlrev_b32 v11, 16, v10
    v_add_f32 v11, 0x3727c5ac, v11
    v_cvt_pk_bf16_f32 v10, v11, v11
    v_lshlrev_b32 v11, 16, v10
    v_sqrt_f32 v11, v11
    s_nop 0
    v_cvt_pk_bf16_f32 v10, v11, v11
    v_lshlrev_b32 v11, 16, v10
    v_rcp_f32 v9, v11
    v_sub_f32 v8, 0, v8
    v_cmp_le_u32 s[32:33], 48, v0
    v_mov_b32 v12, 0xff800000
    v_mov_b32 v13, 0x7f800000
    v_mov_b32 v14, 1.0
    v_mov_b32 v15, 0x3fb8aa3b
    v_mul_u32_u24 v148, 1088, v3
    s_lshl_b32 s19, s3, 5
    v_lshl_add_u32 v148, v2, 1, v148
    v_add_u32 v148, s19, v148
    v_add_u32 v148, 94208, v148
    s_waitcnt lgkmcnt(0)
    v_fma_f32 v72, v8, v114, v72
    v_mul_f32 v72, v72, v9
    v_fma_f32 v73, v8, v115, v73
    v_mul_f32 v73, v73, v9
    v_fma_f32 v74, v8, v116, v74
    v_mul_f32 v74, v74, v9
    v_fma_f32 v75, v8, v117, v75
    v_mul_f32 v75, v75, v9
    v_fma_f32 v76, v8, v118, v76
    v_mul_f32 v76, v76, v9
    v_fma_f32 v77, v8, v119, v77
    v_mul_f32 v77, v77, v9
    v_fma_f32 v78, v8, v120, v78
    v_mul_f32 v78, v78, v9
    v_fma_f32 v79, v8, v121, v79
    v_mul_f32 v79, v79, v9
    v_fma_f32 v80, v8, v122, v80
    v_mul_f32 v80, v80, v9
    v_fma_f32 v81, v8, v123, v81
    v_mul_f32 v81, v81, v9
    v_fma_f32 v82, v8, v124, v82
    v_mul_f32 v82, v82, v9
    v_fma_f32 v83, v8, v125, v83
    v_mul_f32 v83, v83, v9
    v_fma_f32 v84, v8, v126, v84
    v_mul_f32 v84, v84, v9
    v_fma_f32 v85, v8, v127, v85
    v_mul_f32 v85, v85, v9
    v_fma_f32 v86, v8, v128, v86
    v_mul_f32 v86, v86, v9
    v_fma_f32 v87, v8, v129, v87
    v_mul_f32 v87, v87, v9
    v_fma_f32 v88, v8, v130, v88
    v_mul_f32 v88, v88, v9
    v_fma_f32 v89, v8, v131, v89
    v_mul_f32 v89, v89, v9
    v_fma_f32 v90, v8, v132, v90
    v_mul_f32 v90, v90, v9
    v_fma_f32 v91, v8, v133, v91
    v_mul_f32 v91, v91, v9
    v_fma_f32 v92, v8, v134, v92
    v_mul_f32 v92, v92, v9
    v_fma_f32 v93, v8, v135, v93
    v_mul_f32 v93, v93, v9
    v_fma_f32 v94, v8, v136, v94
    v_mul_f32 v94, v94, v9
    v_fma_f32 v95, v8, v137, v95
    v_mul_f32 v95, v95, v9
    v_cndmask_b32 v92, v92, v14, s[32:33]
    v_cvt_pk_bf16_f32 v16, v72, v73
    v_cvt_pk_bf16_f32 v17, v74, v75
    v_cvt_pk_bf16_f32 v18, v76, v77
    v_cvt_pk_bf16_f32 v19, v78, v79
    v_cvt_pk_bf16_f32 v20, v80, v81
    v_cvt_pk_bf16_f32 v21, v82, v83
    v_cvt_pk_bf16_f32 v22, v84, v85
    v_cvt_pk_bf16_f32 v23, v86, v87
    v_cvt_pk_bf16_f32 v24, v88, v89
    v_cvt_pk_bf16_f32 v25, v90, v91
    v_cvt_pk_bf16_f32 v26, v92, v93
    v_cvt_pk_bf16_f32 v27, v94, v95
    v_mfma_f32_16x16x32_bf16 v[36:39], v[140:143], v[16:19], 0
    v_mfma_f32_16x16x32_bf16 v[40:43], v[144:147], v[16:19], 0
    s_nop 6
    v_cvt_pk_bf16_f32 v150, v36, v37
    v_lshlrev_b32 v28, 16, v150
    v_and_b32 v29, 0xffff0000, v150
    v_cvt_pk_bf16_f32 v150, v38, v39
    v_lshlrev_b32 v30, 16, v150
    v_and_b32 v31, 0xffff0000, v150
    v_cvt_pk_bf16_f32 v150, v40, v41
    v_lshlrev_b32 v32, 16, v150
    v_and_b32 v33, 0xffff0000, v150
    v_cvt_pk_bf16_f32 v150, v42, v43
    v_lshlrev_b32 v34, 16, v150
    v_and_b32 v35, 0xffff0000, v150
    v_cndmask_b32 v150, v32, v12, s[32:33]
    v_cndmask_b32 v154, v32, v13, s[32:33]
    v_cndmask_b32 v151, v33, v12, s[32:33]
    v_cndmask_b32 v155, v33, v13, s[32:33]
    v_cndmask_b32 v152, v34, v12, s[32:33]
    v_cndmask_b32 v156, v34, v13, s[32:33]
    v_cndmask_b32 v153, v35, v12, s[32:33]
    v_cndmask_b32 v157, v35, v13, s[32:33]
    v_max3_f32 v158, v28, v29, v30
    v_min3_f32 v159, v28, v29, v30
    v_max3_f32 v158, v158, v31, v150
    v_min3_f32 v159, v159, v31, v154
    v_max3_f32 v158, v158, v151, v152
    v_min3_f32 v159, v159, v155, v156
    v_max_f32 v158, v158, v153
    v_min_f32 v159, v159, v157
    v_mov_b32 v160, v158
    s_nop 1
    v_permlane16_swap_b32 v158, v160
    v_max_f32 v158, v158, v160
    v_mov_b32 v160, v158
    s_nop 1
    v_permlane32_swap_b32 v158, v160
    v_max_f32 v158, v158, v160
    v_mov_b32 v160, v159
    s_nop 1
    v_permlane16_swap_b32 v159, v160
    v_min_f32 v159, v159, v160
    v_mov_b32 v160, v159
    s_nop 1
    v_permlane32_swap_b32 v159, v160
    v_min_f32 v159, v159, v160
    v_mul_f32 v158, v15, v158
    v_mul_f32 v159, v15, v159
    v_fma_f32 v162, v28, v15, -v158
    v_fma_f32 v170, -v28, v15, v159
    v_fma_f32 v163, v29, v15, -v158
    v_fma_f32 v171, -v29, v15, v159
    v_fma_f32 v164, v30, v15, -v158
    v_fma_f32 v172, -v30, v15, v159
    v_fma_f32 v165, v31, v15, -v158
    v_fma_f32 v173, -v31, v15, v159
    v_fma_f32 v166, v150, v15, -v158
    v_fma_f32 v174, -v154, v15, v159
    v_fma_f32 v167, v151, v15, -v158
    v_fma_f32 v175, -v155, v15, v159
    v_fma_f32 v168, v152, v15, -v158
    v_fma_f32 v176, -v156, v15, v159
    v_fma_f32 v169, v153, v15, -v158
    v_fma_f32 v177, -v157, v15, v159
    v_exp_f32 v162, v162
    v_exp_f32 v170, v170
    v_exp_f32 v163, v163
    v_exp_f32 v171, v171
    v_exp_f32 v164, v164
    v_exp_f32 v172, v172
    v_exp_f32 v165, v165
    v_exp_f32 v173, v173
    v_exp_f32 v166, v166
    v_exp_f32 v174, v174
    v_exp_f32 v167, v167
    v_exp_f32 v175, v175
    v_exp_f32 v168, v168
    v_exp_f32 v176, v176
    v_exp_f32 v169, v169
    v_exp_f32 v177, v177
    v_add_f32 v158, v162, v163
    v_add_f32 v159, v170, v171
    v_add_f32 v158, v158, v164
    v_add_f32 v159, v159, v172
    v_add_f32 v158, v158, v165
    v_add_f32 v159, v159, v173
    v_add_f32 v158, v158, v166
    v_add_f32 v159, v159, v174
    v_add_f32 v158, v158, v167
    v_add_f32 v159, v159, v175
    v_add_f32 v158, v158, v168
    v_add_f32 v159, v159, v176
    v_add_f32 v158, v158, v169
    v_add_f32 v159, v159, v177
    v_mov_b32 v160, v158
    s_nop 1
    v_permlane16_swap_b32 v158, v160
    v_add_f32 v158, v158, v160
    v_mov_b32 v160, v158
    s_nop 1
    v_permlane32_swap_b32 v158, v160
    v_add_f32 v158, v158, v160
    v_mov_b32 v160, v159
    s_nop 1
    v_permlane16_swap_b32 v159, v160
    v_add_f32 v159, v159, v160
    v_mov_b32 v160, v159
    s_nop 1
    v_permlane32_swap_b32 v159, v160
    v_add_f32 v159, v159, v160
    v_rcp_f32 v158, v158
    v_rcp_f32 v159, v159
    v_mul_f32 v162, v162, v158
    v_mul_f32 v170, v170, v159
    v_mul_f32 v163, v163, v158
    v_mul_f32 v171, v171, v159
    v_mul_f32 v164, v164, v158
    v_mul_f32 v172, v172, v159
    v_mul_f32 v165, v165, v158
    v_mul_f32 v173, v173, v159
    v_mul_f32 v166, v166, v158
    v_mul_f32 v174, v174, v159
    v_mul_f32 v167, v167, v158
    v_mul_f32 v175, v175, v159
    v_mul_f32 v168, v168, v158
    v_mul_f32 v176, v176, v159
    v_mul_f32 v169, v169, v158
    v_mul_f32 v177, v177, v159
    v_cvt_pk_bf16_f32 v44, v162, v163
    v_cvt_pk_bf16_f32 v48, v170, v171
    v_cvt_pk_bf16_f32 v45, v164, v165
    v_cvt_pk_bf16_f32 v49, v172, v173
    v_cvt_pk_bf16_f32 v46, v166, v167
    v_cvt_pk_bf16_f32 v50, v174, v175
    v_cvt_pk_bf16_f32 v47, v168, v169
    v_cvt_pk_bf16_f32 v51, v176, v177
    s_lshl_b32 s19, s30, 4
    s_add_u32 s19, s19, s14
    s_lshl_b32 s19, s19, 11
    s_add_u32 s19, s19, 7176192
    buffer_store_dwordx4 v[44:47], v1, s[8:11], s19 offen
    buffer_store_dwordx4 v[48:51], v1, s[8:11], s19 offen offset:1024
    v_mfma_f32_16x16x32_bf16 v[36:39], v[140:143], v[20:23], 0
    v_mfma_f32_16x16x32_bf16 v[40:43], v[144:147], v[20:23], 0
    s_nop 6
    v_cvt_pk_bf16_f32 v150, v36, v37
    v_lshlrev_b32 v28, 16, v150
    v_and_b32 v29, 0xffff0000, v150
    v_cvt_pk_bf16_f32 v150, v38, v39
    v_lshlrev_b32 v30, 16, v150
    v_and_b32 v31, 0xffff0000, v150
    v_cvt_pk_bf16_f32 v150, v40, v41
    v_lshlrev_b32 v32, 16, v150
    v_and_b32 v33, 0xffff0000, v150
    v_cvt_pk_bf16_f32 v150, v42, v43
    v_lshlrev_b32 v34, 16, v150
    v_and_b32 v35, 0xffff0000, v150
    v_cndmask_b32 v150, v32, v12, s[32:33]
    v_cndmask_b32 v154, v32, v13, s[32:33]
    v_cndmask_b32 v151, v33, v12, s[32:33]
    v_cndmask_b32 v155, v33, v13, s[32:33]
    v_cndmask_b32 v152, v34, v12, s[32:33]
    v_cndmask_b32 v156, v34, v13, s[32:33]
    v_cndmask_b32 v153, v35, v12, s[32:33]
    v_cndmask_b32 v157, v35, v13, s[32:33]
    v_max3_f32 v158, v28, v29, v30
    v_min3_f32 v159, v28, v29, v30
    v_max3_f32 v158, v158, v31, v150
    v_min3_f32 v159, v159, v31, v154
    v_max3_f32 v158, v158, v151, v152
    v_min3_f32 v159, v159, v155, v156
    v_max_f32 v158, v158, v153
    v_min_f32 v159, v159, v157
    v_mov_b32 v160, v158
    s_nop 1
    v_permlane16_swap_b32 v158, v160
    v_max_f32 v158, v158, v160
    v_mov_b32 v160, v158
    s_nop 1
    v_permlane32_swap_b32 v158, v160
    v_max_f32 v158, v158, v160
    v_mov_b32 v160, v159
    s_nop 1
    v_permlane16_swap_b32 v159, v160
    v_min_f32 v159, v159, v160
    v_mov_b32 v160, v159
    s_nop 1
    v_permlane32_swap_b32 v159, v160
    v_min_f32 v159, v159, v160
    v_mul_f32 v158, v15, v158
    v_mul_f32 v159, v15, v159
    v_fma_f32 v162, v28, v15, -v158
    v_fma_f32 v170, -v28, v15, v159
    v_fma_f32 v163, v29, v15, -v158
    v_fma_f32 v171, -v29, v15, v159
    v_fma_f32 v164, v30, v15, -v158
    v_fma_f32 v172, -v30, v15, v159
    v_fma_f32 v165, v31, v15, -v158
    v_fma_f32 v173, -v31, v15, v159
    v_fma_f32 v166, v150, v15, -v158
    v_fma_f32 v174, -v154, v15, v159
    v_fma_f32 v167, v151, v15, -v158
    v_fma_f32 v175, -v155, v15, v159
    v_fma_f32 v168, v152, v15, -v158
    v_fma_f32 v176, -v156, v15, v159
    v_fma_f32 v169, v153, v15, -v158
    v_fma_f32 v177, -v157, v15, v159
    v_exp_f32 v162, v162
    v_exp_f32 v170, v170
    v_exp_f32 v163, v163
    v_exp_f32 v171, v171
    v_exp_f32 v164, v164
    v_exp_f32 v172, v172
    v_exp_f32 v165, v165
    v_exp_f32 v173, v173
    v_exp_f32 v166, v166
    v_exp_f32 v174, v174
    v_exp_f32 v167, v167
    v_exp_f32 v175, v175
    v_exp_f32 v168, v168
    v_exp_f32 v176, v176
    v_exp_f32 v169, v169
    v_exp_f32 v177, v177
    v_add_f32 v158, v162, v163
    v_add_f32 v159, v170, v171
    v_add_f32 v158, v158, v164
    v_add_f32 v159, v159, v172
    v_add_f32 v158, v158, v165
    v_add_f32 v159, v159, v173
    v_add_f32 v158, v158, v166
    v_add_f32 v159, v159, v174
    v_add_f32 v158, v158, v167
    v_add_f32 v159, v159, v175
    v_add_f32 v158, v158, v168
    v_add_f32 v159, v159, v176
    v_add_f32 v158, v158, v169
    v_add_f32 v159, v159, v177
    v_mov_b32 v160, v158
    s_nop 1
    v_permlane16_swap_b32 v158, v160
    v_add_f32 v158, v158, v160
    v_mov_b32 v160, v158
    s_nop 1
    v_permlane32_swap_b32 v158, v160
    v_add_f32 v158, v158, v160
    v_mov_b32 v160, v159
    s_nop 1
    v_permlane16_swap_b32 v159, v160
    v_add_f32 v159, v159, v160
    v_mov_b32 v160, v159
    s_nop 1
    v_permlane32_swap_b32 v159, v160
    v_add_f32 v159, v159, v160
    v_rcp_f32 v158, v158
    v_rcp_f32 v159, v159
    v_mul_f32 v162, v162, v158
    v_mul_f32 v170, v170, v159
    v_mul_f32 v163, v163, v158
    v_mul_f32 v171, v171, v159
    v_mul_f32 v164, v164, v158
    v_mul_f32 v172, v172, v159
    v_mul_f32 v165, v165, v158
    v_mul_f32 v173, v173, v159
    v_mul_f32 v166, v166, v158
    v_mul_f32 v174, v174, v159
    v_mul_f32 v167, v167, v158
    v_mul_f32 v175, v175, v159
    v_mul_f32 v168, v168, v158
    v_mul_f32 v176, v176, v159
    v_mul_f32 v169, v169, v158
    v_mul_f32 v177, v177, v159
    v_cvt_pk_bf16_f32 v44, v162, v163
    v_cvt_pk_bf16_f32 v48, v170, v171
    v_cvt_pk_bf16_f32 v45, v164, v165
    v_cvt_pk_bf16_f32 v49, v172, v173
    v_cvt_pk_bf16_f32 v46, v166, v167
    v_cvt_pk_bf16_f32 v50, v174, v175
    v_cvt_pk_bf16_f32 v47, v168, v169
    v_cvt_pk_bf16_f32 v51, v176, v177
    ds_write_b16 v148, v44 offset:0
    ds_write_b16_d16_hi v148, v44 offset:272
    ds_write_b16 v148, v48 offset:8704
    ds_write_b16_d16_hi v148, v48 offset:8976
    ds_write_b16 v148, v24 offset:17408
    ds_write_b16_d16_hi v148, v24 offset:17680
    ds_write_b16 v148, v45 offset:544
    ds_write_b16_d16_hi v148, v45 offset:816
    ds_write_b16 v148, v49 offset:9248
    ds_write_b16_d16_hi v148, v49 offset:9520
    ds_write_b16 v148, v25 offset:17952
    ds_write_b16_d16_hi v148, v25 offset:18224
    ds_write_b16 v148, v46 offset:4352
    ds_write_b16_d16_hi v148, v46 offset:4624
    ds_write_b16 v148, v50 offset:13056
    ds_write_b16_d16_hi v148, v50 offset:13328
    ds_write_b16 v148, v26 offset:21760
    ds_write_b16_d16_hi v148, v26 offset:22032
    ds_write_b16 v148, v47 offset:4896
    ds_write_b16_d16_hi v148, v47 offset:5168
    ds_write_b16 v148, v51 offset:13600
    ds_write_b16_d16_hi v148, v51 offset:13872
    ds_write_b16 v148, v27 offset:22304
    ds_write_b16_d16_hi v148, v27 offset:22576
    s_waitcnt lgkmcnt(0)
    s_barrier
    s_cmp_ge_u32 s3, 4
    s_cbranch_scc1 K1_KVSKIP_13205504
    s_lshl_b32 s19, s3, 4
    v_add_u32 v41, s19, v2
    v_mul_u32_u24 v41, 272, v41
    v_lshl_add_u32 v41, v3, 4, v41
    v_add_u32 v41, 94208, v41
    v_mul_u32_u24 v42, 272, v2
    v_lshl_add_u32 v42, v3, 4, v42
    v_add_u32 v42, 111616, v42
    ds_read_b128 v[48:51], v41 offset:0
    ds_read_b128 v[64:67], v42 offset:0
    ds_read_b128 v[68:71], v42 offset:4352
    ds_read_b128 v[52:55], v41 offset:64
    ds_read_b128 v[72:75], v42 offset:64
    ds_read_b128 v[76:79], v42 offset:4416
    ds_read_b128 v[56:59], v41 offset:128
    ds_read_b128 v[80:83], v42 offset:128
    ds_read_b128 v[84:87], v42 offset:4480
    ds_read_b128 v[60:63], v41 offset:192
    ds_read_b128 v[88:91], v42 offset:192
    ds_read_b128 v[92:95], v42 offset:4544
    s_waitcnt lgkmcnt(9)
    v_mfma_f32_16x16x32_bf16 v[112:115], v[48:51], v[64:67], 0
    v_mfma_f32_16x16x32_bf16 v[116:119], v[48:51], v[68:71], 0
    s_waitcnt lgkmcnt(6)
    v_mfma_f32_16x16x32_bf16 v[112:115], v[52:55], v[72:75], v[112:115]
    v_mfma_f32_16x16x32_bf16 v[116:119], v[52:55], v[76:79], v[116:119]
    s_waitcnt lgkmcnt(3)
    v_mfma_f32_16x16x32_bf16 v[112:115], v[56:59], v[80:83], v[112:115]
    v_mfma_f32_16x16x32_bf16 v[116:119], v[56:59], v[84:87], v[116:119]
    s_waitcnt lgkmcnt(0)
    v_mfma_f32_16x16x32_bf16 v[112:115], v[60:63], v[88:91], v[112:115]
    v_mfma_f32_16x16x32_bf16 v[116:119], v[60:63], v[92:95], v[116:119]
    s_lshr_b32 s19, s3, 1
    s_lshl_b32 s19, s19, 11
    s_and_b32 s20, s3, 1
    s_lshl_b32 s20, s20, 4
    s_add_u32 s19, s19, s20
    v_lshlrev_b32 v43, 5, v0
    v_add_u32 v43, s19, v43
    v_add_u32 v43, 120320, v43
    ds_write_b128 v43, v[112:115] offset:0
    ds_write_b128 v43, v[116:119] offset:4096
    s_waitcnt lgkmcnt(0)
    s_nop 11
K1_KVSKIP_13205504:
    s_barrier
    v_lshlrev_b32 v43, 2, v0
    s_lshl_b32 s19, s3, 10
    v_add_u32 v44, s19, v43
    v_add_u32 v44, 120320, v44
    ds_read_b32 v48, v44 offset:0
    ds_read_b32 v49, v44 offset:256
    ds_read_b32 v50, v44 offset:512
    ds_read_b32 v51, v44 offset:768
    s_lshl_b32 s19, s14, 13
    s_lshl_b32 s20, s3, 10
    s_add_u32 s19, s19, s20
    s_add_u32 s19, s19, 7045120
    s_waitcnt lgkmcnt(3)
    buffer_atomic_add_f32 v48, v43, s[8:11], s19 offen offset:0
    s_waitcnt lgkmcnt(2)
    buffer_atomic_add_f32 v49, v43, s[8:11], s19 offen offset:256
    s_waitcnt lgkmcnt(1)
    buffer_atomic_add_f32 v50, v43, s[8:11], s19 offen offset:512
    s_waitcnt lgkmcnt(0)
    buffer_atomic_add_f32 v51, v43, s[8:11], s19 offen offset:768
    s_nop 11
K1_END_13205504:
    s_endpgm
.globl wo1_kernel
.p2align 8
.type wo1_kernel,@function
wo1_kernel:
    s_load_dwordx2 s[4:5], s[0:1], 88
    s_cmp_ge_u32 s2, 224
    s_cbranch_scc1 K2_END_13205504
    v_lshrrev_b32 v1, 6, v0
    v_and_b32 v0, 63, v0
    v_readfirstlane_b32 s3, v1
    v_lshlrev_b32 v1, 4, v0
    v_and_b32 v2, 15, v0
    v_lshrrev_b32 v3, 4, v0
    s_waitcnt lgkmcnt(0)
    s_mov_b32 s8, s4
    s_and_b32 s9, s5, 0xffff
    s_mov_b32 s10, 0x10000000
    s_mov_b32 s11, 0x00020000
    s_and_b32 s14, s2, 7
    s_lshr_b32 s15, s2, 3
    s_mul_hi_u32 s16, s15, 0x24924925
    s_mul_i32 s17, s16, 7
    s_sub_u32 s12, s15, s17
    s_lshl_b32 s13, s14, 2
    s_add_u32 s13, s13, s16
    v_lshlrev_b32 v4, 5, v0
    s_lshl_b32 s19, s3, 15
    s_add_u32 s19, s19, 7045120
    s_add_u32 s20, s19, 0
    buffer_load_dwordx4 v[16:19], v4, s[8:11], s20 offen
    buffer_load_dwordx4 v[20:23], v4, s[8:11], s20 offen offset:16
    s_add_u32 s20, s19, 2048
    buffer_load_dwordx4 v[24:27], v4, s[8:11], s20 offen
    buffer_load_dwordx4 v[28:31], v4, s[8:11], s20 offen offset:16
    s_add_u32 s20, s19, 4096
    buffer_load_dwordx4 v[32:35], v4, s[8:11], s20 offen
    buffer_load_dwordx4 v[36:39], v4, s[8:11], s20 offen offset:16
    s_add_u32 s20, s19, 6144
    buffer_load_dwordx4 v[40:43], v4, s[8:11], s20 offen
    buffer_load_dwordx4 v[44:47], v4, s[8:11], s20 offen offset:16
    s_add_u32 s20, s19, 8192
    buffer_load_dwordx4 v[48:51], v4, s[8:11], s20 offen
    buffer_load_dwordx4 v[52:55], v4, s[8:11], s20 offen offset:16
    s_add_u32 s20, s19, 10240
    buffer_load_dwordx4 v[56:59], v4, s[8:11], s20 offen
    buffer_load_dwordx4 v[60:63], v4, s[8:11], s20 offen offset:16
    s_add_u32 s20, s19, 12288
    buffer_load_dwordx4 v[64:67], v4, s[8:11], s20 offen
    buffer_load_dwordx4 v[68:71], v4, s[8:11], s20 offen offset:16
    s_add_u32 s20, s19, 14336
    buffer_load_dwordx4 v[72:75], v4, s[8:11], s20 offen
    buffer_load_dwordx4 v[76:79], v4, s[8:11], s20 offen offset:16
    s_add_u32 s20, s19, 16384
    buffer_load_dwordx4 v[80:83], v4, s[8:11], s20 offen
    buffer_load_dwordx4 v[84:87], v4, s[8:11], s20 offen offset:16
    s_add_u32 s20, s19, 18432
    buffer_load_dwordx4 v[88:91], v4, s[8:11], s20 offen
    buffer_load_dwordx4 v[92:95], v4, s[8:11], s20 offen offset:16
    s_add_u32 s20, s19, 20480
    buffer_load_dwordx4 v[96:99], v4, s[8:11], s20 offen
    buffer_load_dwordx4 v[100:103], v4, s[8:11], s20 offen offset:16
    s_add_u32 s20, s19, 22528
    buffer_load_dwordx4 v[104:107], v4, s[8:11], s20 offen
    buffer_load_dwordx4 v[108:111], v4, s[8:11], s20 offen offset:16
    s_add_u32 s20, s19, 24576
    buffer_load_dwordx4 v[112:115], v4, s[8:11], s20 offen
    buffer_load_dwordx4 v[116:119], v4, s[8:11], s20 offen offset:16
    s_add_u32 s20, s19, 26624
    buffer_load_dwordx4 v[120:123], v4, s[8:11], s20 offen
    buffer_load_dwordx4 v[124:127], v4, s[8:11], s20 offen offset:16
    s_add_u32 s20, s19, 28672
    buffer_load_dwordx4 v[128:131], v4, s[8:11], s20 offen
    buffer_load_dwordx4 v[132:135], v4, s[8:11], s20 offen offset:16
    s_add_u32 s20, s19, 30720
    buffer_load_dwordx4 v[136:139], v4, s[8:11], s20 offen
    buffer_load_dwordx4 v[140:143], v4, s[8:11], s20 offen offset:16
    s_lshl_b32 s20, s12, 2
    s_add_u32 s20, s20, 0
    s_lshl_b32 s20, s20, 4
    s_lshl_b32 s21, s3, 2
    s_add_u32 s20, s20, s21
    s_add_u32 s20, s20, 0
    s_lshl_b32 s20, s20, 10
    s_add_u32 s20, s20, 3244032
    buffer_load_dwordx4 a[0:3], v1, s[8:11], s20 offen
    s_lshl_b32 s20, s12, 2
    s_add_u32 s20, s20, 0
    s_lshl_b32 s20, s20, 4
    s_lshl_b32 s21, s3, 2
    s_add_u32 s20, s20, s21
    s_add_u32 s20, s20, 1
    s_lshl_b32 s20, s20, 10
    s_add_u32 s20, s20, 3244032
    buffer_load_dwordx4 a[4:7], v1, s[8:11], s20 offen
    s_lshl_b32 s20, s12, 2
    s_add_u32 s20, s20, 0
    s_lshl_b32 s20, s20, 4
    s_lshl_b32 s21, s3, 2
    s_add_u32 s20, s20, s21
    s_add_u32 s20, s20, 2
    s_lshl_b32 s20, s20, 10
    s_add_u32 s20, s20, 3244032
    buffer_load_dwordx4 a[8:11], v1, s[8:11], s20 offen
    s_lshl_b32 s20, s12, 2
    s_add_u32 s20, s20, 0
    s_lshl_b32 s20, s20, 4
    s_lshl_b32 s21, s3, 2
    s_add_u32 s20, s20, s21
    s_add_u32 s20, s20, 3
    s_lshl_b32 s20, s20, 10
    s_add_u32 s20, s20, 3244032
    buffer_load_dwordx4 a[12:15], v1, s[8:11], s20 offen
    s_lshl_b32 s20, s12, 2
    s_add_u32 s20, s20, 1
    s_lshl_b32 s20, s20, 4
    s_lshl_b32 s21, s3, 2
    s_add_u32 s20, s20, s21
    s_add_u32 s20, s20, 0
    s_lshl_b32 s20, s20, 10
    s_add_u32 s20, s20, 3244032
    buffer_load_dwordx4 a[16:19], v1, s[8:11], s20 offen
    s_lshl_b32 s20, s12, 2
    s_add_u32 s20, s20, 1
    s_lshl_b32 s20, s20, 4
    s_lshl_b32 s21, s3, 2
    s_add_u32 s20, s20, s21
    s_add_u32 s20, s20, 1
    s_lshl_b32 s20, s20, 10
    s_add_u32 s20, s20, 3244032
    buffer_load_dwordx4 a[20:23], v1, s[8:11], s20 offen
    s_lshl_b32 s20, s12, 2
    s_add_u32 s20, s20, 1
    s_lshl_b32 s20, s20, 4
    s_lshl_b32 s21, s3, 2
    s_add_u32 s20, s20, s21
    s_add_u32 s20, s20, 2
    s_lshl_b32 s20, s20, 10
    s_add_u32 s20, s20, 3244032
    buffer_load_dwordx4 a[24:27], v1, s[8:11], s20 offen
    s_lshl_b32 s20, s12, 2
    s_add_u32 s20, s20, 1
    s_lshl_b32 s20, s20, 4
    s_lshl_b32 s21, s3, 2
    s_add_u32 s20, s20, s21
    s_add_u32 s20, s20, 3
    s_lshl_b32 s20, s20, 10
    s_add_u32 s20, s20, 3244032
    buffer_load_dwordx4 a[28:31], v1, s[8:11], s20 offen
    s_lshl_b32 s20, s12, 2
    s_add_u32 s20, s20, 2
    s_lshl_b32 s20, s20, 4
    s_lshl_b32 s21, s3, 2
    s_add_u32 s20, s20, s21
    s_add_u32 s20, s20, 0
    s_lshl_b32 s20, s20, 10
    s_add_u32 s20, s20, 3244032
    buffer_load_dwordx4 a[32:35], v1, s[8:11], s20 offen
    s_lshl_b32 s20, s12, 2
    s_add_u32 s20, s20, 2
    s_lshl_b32 s20, s20, 4
    s_lshl_b32 s21, s3, 2
    s_add_u32 s20, s20, s21
    s_add_u32 s20, s20, 1
    s_lshl_b32 s20, s20, 10
    s_add_u32 s20, s20, 3244032
    buffer_load_dwordx4 a[36:39], v1, s[8:11], s20 offen
    s_lshl_b32 s20, s12, 2
    s_add_u32 s20, s20, 2
    s_lshl_b32 s20, s20, 4
    s_lshl_b32 s21, s3, 2
    s_add_u32 s20, s20, s21
    s_add_u32 s20, s20, 2
    s_lshl_b32 s20, s20, 10
    s_add_u32 s20, s20, 3244032
    buffer_load_dwordx4 a[40:43], v1, s[8:11], s20 offen
    s_lshl_b32 s20, s12, 2
    s_add_u32 s20, s20, 2
    s_lshl_b32 s20, s20, 4
    s_lshl_b32 s21, s3, 2
    s_add_u32 s20, s20, s21
    s_add_u32 s20, s20, 3
    s_lshl_b32 s20, s20, 10
    s_add_u32 s20, s20, 3244032
    buffer_load_dwordx4 a[44:47], v1, s[8:11], s20 offen
    s_lshl_b32 s20, s12, 2
    s_add_u32 s20, s20, 3
    s_lshl_b32 s20, s20, 4
    s_lshl_b32 s21, s3, 2
    s_add_u32 s20, s20, s21
    s_add_u32 s20, s20, 0
    s_lshl_b32 s20, s20, 10
    s_add_u32 s20, s20, 3244032
    buffer_load_dwordx4 a[48:51], v1, s[8:11], s20 offen
    s_lshl_b32 s20, s12, 2
    s_add_u32 s20, s20, 3
    s_lshl_b32 s20, s20, 4
    s_lshl_b32 s21, s3, 2
    s_add_u32 s20, s20, s21
    s_add_u32 s20, s20, 1
    s_lshl_b32 s20, s20, 10
    s_add_u32 s20, s20, 3244032
    buffer_load_dwordx4 a[52:55], v1, s[8:11], s20 offen
    s_lshl_b32 s20, s12, 2
    s_add_u32 s20, s20, 3
    s_lshl_b32 s20, s20, 4
    s_lshl_b32 s21, s3, 2
    s_add_u32 s20, s20, s21
    s_add_u32 s20, s20, 2
    s_lshl_b32 s20, s20, 10
    s_add_u32 s20, s20, 3244032
    buffer_load_dwordx4 a[56:59], v1, s[8:11], s20 offen
    s_lshl_b32 s20, s12, 2
    s_add_u32 s20, s20, 3
    s_lshl_b32 s20, s20, 4
    s_lshl_b32 s21, s3, 2
    s_add_u32 s20, s20, s21
    s_add_u32 s20, s20, 3
    s_lshl_b32 s20, s20, 10
    s_add_u32 s20, s20, 3244032
    buffer_load_dwordx4 a[60:63], v1, s[8:11], s20 offen
    s_lshl_b32 s20, s13, 2
    s_add_u32 s20, s20, 0
    s_lshl_b32 s20, s20, 4
    s_lshl_b32 s21, s3, 2
    s_add_u32 s20, s20, s21
    s_add_u32 s20, s20, 0
    s_lshl_b32 s20, s20, 11
    s_add_u32 s20, s20, 7176192
    buffer_load_dwordx4 a[64:67], v1, s[8:11], s20 offen
    buffer_load_dwordx4 a[68:71], v1, s[8:11], s20 offen offset:1024
    s_lshl_b32 s20, s13, 2
    s_add_u32 s20, s20, 0
    s_lshl_b32 s20, s20, 4
    s_lshl_b32 s21, s3, 2
    s_add_u32 s20, s20, s21
    s_add_u32 s20, s20, 1
    s_lshl_b32 s20, s20, 11
    s_add_u32 s20, s20, 7176192
    buffer_load_dwordx4 a[72:75], v1, s[8:11], s20 offen
    buffer_load_dwordx4 a[76:79], v1, s[8:11], s20 offen offset:1024
    s_lshl_b32 s20, s13, 2
    s_add_u32 s20, s20, 0
    s_lshl_b32 s20, s20, 4
    s_lshl_b32 s21, s3, 2
    s_add_u32 s20, s20, s21
    s_add_u32 s20, s20, 2
    s_lshl_b32 s20, s20, 11
    s_add_u32 s20, s20, 7176192
    buffer_load_dwordx4 a[80:83], v1, s[8:11], s20 offen
    buffer_load_dwordx4 a[84:87], v1, s[8:11], s20 offen offset:1024
    s_lshl_b32 s20, s13, 2
    s_add_u32 s20, s20, 0
    s_lshl_b32 s20, s20, 4
    s_lshl_b32 s21, s3, 2
    s_add_u32 s20, s20, s21
    s_add_u32 s20, s20, 3
    s_lshl_b32 s20, s20, 11
    s_add_u32 s20, s20, 7176192
    buffer_load_dwordx4 a[88:91], v1, s[8:11], s20 offen
    buffer_load_dwordx4 a[92:95], v1, s[8:11], s20 offen offset:1024
    s_lshl_b32 s20, s13, 2
    s_add_u32 s20, s20, 1
    s_lshl_b32 s20, s20, 4
    s_lshl_b32 s21, s3, 2
    s_add_u32 s20, s20, s21
    s_add_u32 s20, s20, 0
    s_lshl_b32 s20, s20, 11
    s_add_u32 s20, s20, 7176192
    buffer_load_dwordx4 a[96:99], v1, s[8:11], s20 offen
    buffer_load_dwordx4 a[100:103], v1, s[8:11], s20 offen offset:1024
    s_lshl_b32 s20, s13, 2
    s_add_u32 s20, s20, 1
    s_lshl_b32 s20, s20, 4
    s_lshl_b32 s21, s3, 2
    s_add_u32 s20, s20, s21
    s_add_u32 s20, s20, 1
    s_lshl_b32 s20, s20, 11
    s_add_u32 s20, s20, 7176192
    buffer_load_dwordx4 a[104:107], v1, s[8:11], s20 offen
    buffer_load_dwordx4 a[108:111], v1, s[8:11], s20 offen offset:1024
    s_lshl_b32 s20, s13, 2
    s_add_u32 s20, s20, 1
    s_lshl_b32 s20, s20, 4
    s_lshl_b32 s21, s3, 2
    s_add_u32 s20, s20, s21
    s_add_u32 s20, s20, 2
    s_lshl_b32 s20, s20, 11
    s_add_u32 s20, s20, 7176192
    buffer_load_dwordx4 a[112:115], v1, s[8:11], s20 offen
    buffer_load_dwordx4 a[116:119], v1, s[8:11], s20 offen offset:1024
    s_lshl_b32 s20, s13, 2
    s_add_u32 s20, s20, 1
    s_lshl_b32 s20, s20, 4
    s_lshl_b32 s21, s3, 2
    s_add_u32 s20, s20, s21
    s_add_u32 s20, s20, 3
    s_lshl_b32 s20, s20, 11
    s_add_u32 s20, s20, 7176192
    buffer_load_dwordx4 a[120:123], v1, s[8:11], s20 offen
    buffer_load_dwordx4 a[124:127], v1, s[8:11], s20 offen offset:1024
    v_add_u32 v5, 48, v2
    v_lshlrev_b32 v5, 2, v5
    v_mov_b32 v6, 0x358637bd
    s_waitcnt vmcnt(32)
    v_cvt_pk_bf16_f32 v144, v16, v17
    v_cvt_pk_bf16_f32 v145, v18, v19
    v_cvt_pk_bf16_f32 v146, v20, v21
    v_cvt_pk_bf16_f32 v147, v22, v23
    v_cvt_pk_bf16_f32 v148, v24, v25
    v_cvt_pk_bf16_f32 v149, v26, v27
    v_cvt_pk_bf16_f32 v150, v28, v29
    v_cvt_pk_bf16_f32 v151, v30, v31
    v_cvt_pk_bf16_f32 v152, v32, v33
    v_cvt_pk_bf16_f32 v153, v34, v35
    v_cvt_pk_bf16_f32 v154, v36, v37
    v_cvt_pk_bf16_f32 v155, v38, v39
    v_cvt_pk_bf16_f32 v156, v40, v41
    v_cvt_pk_bf16_f32 v157, v42, v43
    v_cvt_pk_bf16_f32 v158, v44, v45
    v_cvt_pk_bf16_f32 v159, v46, v47
    v_cvt_pk_bf16_f32 v160, v48, v49
    v_cvt_pk_bf16_f32 v161, v50, v51
    v_cvt_pk_bf16_f32 v162, v52, v53
    v_cvt_pk_bf16_f32 v163, v54, v55
    v_cvt_pk_bf16_f32 v164, v56, v57
    v_cvt_pk_bf16_f32 v165, v58, v59
    v_cvt_pk_bf16_f32 v166, v60, v61
    v_cvt_pk_bf16_f32 v167, v62, v63
    v_cvt_pk_bf16_f32 v168, v64, v65
    v_cvt_pk_bf16_f32 v169, v66, v67
    v_cvt_pk_bf16_f32 v170, v68, v69
    v_cvt_pk_bf16_f32 v171, v70, v71
    v_cvt_pk_bf16_f32 v172, v72, v73
    v_cvt_pk_bf16_f32 v173, v74, v75
    v_cvt_pk_bf16_f32 v174, v76, v77
    v_cvt_pk_bf16_f32 v175, v78, v79
    v_cvt_pk_bf16_f32 v176, v80, v81
    v_cvt_pk_bf16_f32 v177, v82, v83
    v_cvt_pk_bf16_f32 v178, v84, v85
    v_cvt_pk_bf16_f32 v179, v86, v87
    v_cvt_pk_bf16_f32 v180, v88, v89
    v_cvt_pk_bf16_f32 v181, v90, v91
    v_cvt_pk_bf16_f32 v182, v92, v93
    v_cvt_pk_bf16_f32 v183, v94, v95
    v_cvt_pk_bf16_f32 v184, v96, v97
    v_cvt_pk_bf16_f32 v185, v98, v99
    v_cvt_pk_bf16_f32 v186, v100, v101
    v_cvt_pk_bf16_f32 v187, v102, v103
    v_cvt_pk_bf16_f32 v188, v104, v105
    v_cvt_pk_bf16_f32 v189, v106, v107
    v_cvt_pk_bf16_f32 v190, v108, v109
    v_cvt_pk_bf16_f32 v191, v110, v111
    v_cvt_pk_bf16_f32 v192, v112, v113
    v_cvt_pk_bf16_f32 v193, v114, v115
    v_cvt_pk_bf16_f32 v194, v116, v117
    v_cvt_pk_bf16_f32 v195, v118, v119
    v_cvt_pk_bf16_f32 v196, v120, v121
    v_cvt_pk_bf16_f32 v197, v122, v123
    v_cvt_pk_bf16_f32 v198, v124, v125
    v_cvt_pk_bf16_f32 v199, v126, v127
    v_cvt_pk_bf16_f32 v200, v128, v129
    v_cvt_pk_bf16_f32 v201, v130, v131
    v_cvt_pk_bf16_f32 v202, v132, v133
    v_cvt_pk_bf16_f32 v203, v134, v135
    v_cvt_pk_bf16_f32 v204, v136, v137
    v_cvt_pk_bf16_f32 v205, v138, v139
    v_cvt_pk_bf16_f32 v206, v140, v141
    v_cvt_pk_bf16_f32 v207, v142, v143
    s_waitcnt vmcnt(16)
    s_waitcnt vmcnt(8)
    s_lshl_b32 s20, s13, 2
    s_add_u32 s20, s20, 2
    s_lshl_b32 s20, s20, 4
    s_lshl_b32 s21, s3, 2
    s_add_u32 s20, s20, s21
    s_add_u32 s20, s20, 0
    s_lshl_b32 s20, s20, 11
    s_add_u32 s20, s20, 7176192
    buffer_load_dwordx4 a[128:131], v1, s[8:11], s20 offen
    buffer_load_dwordx4 a[132:135], v1, s[8:11], s20 offen offset:1024
    s_lshl_b32 s20, s13, 2
    s_add_u32 s20, s20, 2
    s_lshl_b32 s20, s20, 4
    s_lshl_b32 s21, s3, 2
    s_add_u32 s20, s20, s21
    s_add_u32 s20, s20, 1
    s_lshl_b32 s20, s20, 11
    s_add_u32 s20, s20, 7176192
    buffer_load_dwordx4 a[136:139], v1, s[8:11], s20 offen
    buffer_load_dwordx4 a[140:143], v1, s[8:11], s20 offen offset:1024
    s_lshl_b32 s20, s13, 2
    s_add_u32 s20, s20, 2
    s_lshl_b32 s20, s20, 4
    s_lshl_b32 s21, s3, 2
    s_add_u32 s20, s20, s21
    s_add_u32 s20, s20, 2
    s_lshl_b32 s20, s20, 11
    s_add_u32 s20, s20, 7176192
    buffer_load_dwordx4 a[144:147], v1, s[8:11], s20 offen
    buffer_load_dwordx4 a[148:151], v1, s[8:11], s20 offen offset:1024
    s_lshl_b32 s20, s13, 2
    s_add_u32 s20, s20, 2
    s_lshl_b32 s20, s20, 4
    s_lshl_b32 s21, s3, 2
    s_add_u32 s20, s20, s21
    s_add_u32 s20, s20, 3
    s_lshl_b32 s20, s20, 11
    s_add_u32 s20, s20, 7176192
    buffer_load_dwordx4 a[152:155], v1, s[8:11], s20 offen
    buffer_load_dwordx4 a[156:159], v1, s[8:11], s20 offen offset:1024
    v_mfma_f32_16x16x32_bf16 v[80:83], v[144:147], a[64:67], 0
    v_mfma_f32_16x16x32_bf16 v[80:83], v[148:151], a[68:71], v[80:83]
    v_mfma_f32_16x16x32_bf16 v[84:87], v[152:155], a[64:67], 0
    v_mfma_f32_16x16x32_bf16 v[84:87], v[156:159], a[68:71], v[84:87]
    v_mfma_f32_16x16x32_bf16 v[88:91], v[160:163], a[72:75], 0
    v_mfma_f32_16x16x32_bf16 v[88:91], v[164:167], a[76:79], v[88:91]
    v_mfma_f32_16x16x32_bf16 v[92:95], v[168:171], a[72:75], 0
    v_mfma_f32_16x16x32_bf16 v[92:95], v[172:175], a[76:79], v[92:95]
    v_mfma_f32_16x16x32_bf16 v[96:99], v[176:179], a[80:83], 0
    v_mfma_f32_16x16x32_bf16 v[96:99], v[180:183], a[84:87], v[96:99]
    v_mfma_f32_16x16x32_bf16 v[100:103], v[184:187], a[80:83], 0
    v_mfma_f32_16x16x32_bf16 v[100:103], v[188:191], a[84:87], v[100:103]
    v_mfma_f32_16x16x32_bf16 v[104:107], v[192:195], a[88:91], 0
    v_mfma_f32_16x16x32_bf16 v[104:107], v[196:199], a[92:95], v[104:107]
    v_mfma_f32_16x16x32_bf16 v[108:111], v[200:203], a[88:91], 0
    v_mfma_f32_16x16x32_bf16 v[108:111], v[204:207], a[92:95], v[108:111]
    ds_bpermute_b32 v112, v5, v84
    ds_bpermute_b32 v113, v5, v92
    s_nop 1
    ds_bpermute_b32 v114, v5, v100
    s_nop 2
    ds_bpermute_b32 v115, v5, v108
    s_waitcnt lgkmcnt(0)
    v_cvt_pk_bf16_f32 v120, v112, v112
    v_lshlrev_b32 v112, 16, v120
    v_add_f32 v112, v112, v6
    v_cvt_pk_bf16_f32 v120, v112, v112
    v_lshlrev_b32 v112, 16, v120
    v_rcp_f32 v112, v112
    v_cvt_pk_bf16_f32 v120, v80, v81
    v_lshlrev_b32 v80, 16, v120
    v_and_b32 v81, 0xffff0000, v120
    v_mul_f32 v80, v80, v112
    v_mul_f32 v81, v81, v112
    v_cvt_pk_bf16_f32 v116, v80, v81
    v_cvt_pk_bf16_f32 v120, v82, v83
    v_lshlrev_b32 v82, 16, v120
    v_and_b32 v83, 0xffff0000, v120
    v_mul_f32 v82, v82, v112
    v_mul_f32 v83, v83, v112
    v_cvt_pk_bf16_f32 v117, v82, v83
    v_cvt_pk_bf16_f32 v120, v84, v85
    v_lshlrev_b32 v84, 16, v120
    v_and_b32 v85, 0xffff0000, v120
    v_mul_f32 v84, v84, v112
    v_mul_f32 v85, v85, v112
    v_cvt_pk_bf16_f32 v118, v84, v85
    v_cvt_pk_bf16_f32 v120, v86, v87
    v_lshlrev_b32 v86, 16, v120
    v_and_b32 v87, 0xffff0000, v120
    v_mul_f32 v86, v86, v112
    v_mul_f32 v87, v87, v112
    v_cvt_pk_bf16_f32 v119, v86, v87
    s_nop 1
    v_mfma_f32_16x16x32_bf16 v[16:19], a[0:3], v[116:119], 0
    v_mfma_f32_16x16x32_bf16 v[32:35], a[16:19], v[116:119], 0
    v_mfma_f32_16x16x32_bf16 v[48:51], a[32:35], v[116:119], 0
    v_mfma_f32_16x16x32_bf16 v[64:67], a[48:51], v[116:119], 0
    v_cvt_pk_bf16_f32 v120, v113, v113
    v_lshlrev_b32 v113, 16, v120
    v_add_f32 v113, v113, v6
    v_cvt_pk_bf16_f32 v120, v113, v113
    v_lshlrev_b32 v113, 16, v120
    v_rcp_f32 v113, v113
    v_cvt_pk_bf16_f32 v120, v88, v89
    v_lshlrev_b32 v88, 16, v120
    v_and_b32 v89, 0xffff0000, v120
    v_mul_f32 v88, v88, v113
    v_mul_f32 v89, v89, v113
    v_cvt_pk_bf16_f32 v116, v88, v89
    v_cvt_pk_bf16_f32 v120, v90, v91
    v_lshlrev_b32 v90, 16, v120
    v_and_b32 v91, 0xffff0000, v120
    v_mul_f32 v90, v90, v113
    v_mul_f32 v91, v91, v113
    v_cvt_pk_bf16_f32 v117, v90, v91
    v_cvt_pk_bf16_f32 v120, v92, v93
    v_lshlrev_b32 v92, 16, v120
    v_and_b32 v93, 0xffff0000, v120
    v_mul_f32 v92, v92, v113
    v_mul_f32 v93, v93, v113
    v_cvt_pk_bf16_f32 v118, v92, v93
    v_cvt_pk_bf16_f32 v120, v94, v95
    v_lshlrev_b32 v94, 16, v120
    v_and_b32 v95, 0xffff0000, v120
    v_mul_f32 v94, v94, v113
    v_mul_f32 v95, v95, v113
    v_cvt_pk_bf16_f32 v119, v94, v95
    s_nop 1
    v_mfma_f32_16x16x32_bf16 v[16:19], a[4:7], v[116:119], v[16:19]
    v_mfma_f32_16x16x32_bf16 v[32:35], a[20:23], v[116:119], v[32:35]
    v_mfma_f32_16x16x32_bf16 v[48:51], a[36:39], v[116:119], v[48:51]
    v_mfma_f32_16x16x32_bf16 v[64:67], a[52:55], v[116:119], v[64:67]
    v_cvt_pk_bf16_f32 v120, v114, v114
    v_lshlrev_b32 v114, 16, v120
    v_add_f32 v114, v114, v6
    v_cvt_pk_bf16_f32 v120, v114, v114
    v_lshlrev_b32 v114, 16, v120
    v_rcp_f32 v114, v114
    v_cvt_pk_bf16_f32 v120, v96, v97
    v_lshlrev_b32 v96, 16, v120
    v_and_b32 v97, 0xffff0000, v120
    v_mul_f32 v96, v96, v114
    v_mul_f32 v97, v97, v114
    v_cvt_pk_bf16_f32 v116, v96, v97
    v_cvt_pk_bf16_f32 v120, v98, v99
    v_lshlrev_b32 v98, 16, v120
    v_and_b32 v99, 0xffff0000, v120
    v_mul_f32 v98, v98, v114
    v_mul_f32 v99, v99, v114
    v_cvt_pk_bf16_f32 v117, v98, v99
    v_cvt_pk_bf16_f32 v120, v100, v101
    v_lshlrev_b32 v100, 16, v120
    v_and_b32 v101, 0xffff0000, v120
    v_mul_f32 v100, v100, v114
    v_mul_f32 v101, v101, v114
    v_cvt_pk_bf16_f32 v118, v100, v101
    v_cvt_pk_bf16_f32 v120, v102, v103
    v_lshlrev_b32 v102, 16, v120
    v_and_b32 v103, 0xffff0000, v120
    v_mul_f32 v102, v102, v114
    v_mul_f32 v103, v103, v114
    v_cvt_pk_bf16_f32 v119, v102, v103
    s_nop 1
    v_mfma_f32_16x16x32_bf16 v[16:19], a[8:11], v[116:119], v[16:19]
    v_mfma_f32_16x16x32_bf16 v[32:35], a[24:27], v[116:119], v[32:35]
    v_mfma_f32_16x16x32_bf16 v[48:51], a[40:43], v[116:119], v[48:51]
    v_mfma_f32_16x16x32_bf16 v[64:67], a[56:59], v[116:119], v[64:67]
    v_cvt_pk_bf16_f32 v120, v115, v115
    v_lshlrev_b32 v115, 16, v120
    v_add_f32 v115, v115, v6
    v_cvt_pk_bf16_f32 v120, v115, v115
    v_lshlrev_b32 v115, 16, v120
    v_rcp_f32 v115, v115
    v_cvt_pk_bf16_f32 v120, v104, v105
    v_lshlrev_b32 v104, 16, v120
    v_and_b32 v105, 0xffff0000, v120
    v_mul_f32 v104, v104, v115
    v_mul_f32 v105, v105, v115
    v_cvt_pk_bf16_f32 v116, v104, v105
    v_cvt_pk_bf16_f32 v120, v106, v107
    v_lshlrev_b32 v106, 16, v120
    v_and_b32 v107, 0xffff0000, v120
    v_mul_f32 v106, v106, v115
    v_mul_f32 v107, v107, v115
    v_cvt_pk_bf16_f32 v117, v106, v107
    v_cvt_pk_bf16_f32 v120, v108, v109
    v_lshlrev_b32 v108, 16, v120
    v_and_b32 v109, 0xffff0000, v120
    v_mul_f32 v108, v108, v115
    v_mul_f32 v109, v109, v115
    v_cvt_pk_bf16_f32 v118, v108, v109
    v_cvt_pk_bf16_f32 v120, v110, v111
    v_lshlrev_b32 v110, 16, v120
    v_and_b32 v111, 0xffff0000, v120
    v_mul_f32 v110, v110, v115
    v_mul_f32 v111, v111, v115
    v_cvt_pk_bf16_f32 v119, v110, v111
    s_nop 1
    v_mfma_f32_16x16x32_bf16 v[16:19], a[12:15], v[116:119], v[16:19]
    v_mfma_f32_16x16x32_bf16 v[32:35], a[28:31], v[116:119], v[32:35]
    v_mfma_f32_16x16x32_bf16 v[48:51], a[44:47], v[116:119], v[48:51]
    v_mfma_f32_16x16x32_bf16 v[64:67], a[60:63], v[116:119], v[64:67]
    s_waitcnt vmcnt(8)
    s_lshl_b32 s20, s13, 2
    s_add_u32 s20, s20, 3
    s_lshl_b32 s20, s20, 4
    s_lshl_b32 s21, s3, 2
    s_add_u32 s20, s20, s21
    s_add_u32 s20, s20, 0
    s_lshl_b32 s20, s20, 11
    s_add_u32 s20, s20, 7176192
    buffer_load_dwordx4 a[160:163], v1, s[8:11], s20 offen
    buffer_load_dwordx4 a[164:167], v1, s[8:11], s20 offen offset:1024
    s_lshl_b32 s20, s13, 2
    s_add_u32 s20, s20, 3
    s_lshl_b32 s20, s20, 4
    s_lshl_b32 s21, s3, 2
    s_add_u32 s20, s20, s21
    s_add_u32 s20, s20, 1
    s_lshl_b32 s20, s20, 11
    s_add_u32 s20, s20, 7176192
    buffer_load_dwordx4 a[168:171], v1, s[8:11], s20 offen
    buffer_load_dwordx4 a[172:175], v1, s[8:11], s20 offen offset:1024
    s_lshl_b32 s20, s13, 2
    s_add_u32 s20, s20, 3
    s_lshl_b32 s20, s20, 4
    s_lshl_b32 s21, s3, 2
    s_add_u32 s20, s20, s21
    s_add_u32 s20, s20, 2
    s_lshl_b32 s20, s20, 11
    s_add_u32 s20, s20, 7176192
    buffer_load_dwordx4 a[176:179], v1, s[8:11], s20 offen
    buffer_load_dwordx4 a[180:183], v1, s[8:11], s20 offen offset:1024
    s_lshl_b32 s20, s13, 2
    s_add_u32 s20, s20, 3
    s_lshl_b32 s20, s20, 4
    s_lshl_b32 s21, s3, 2
    s_add_u32 s20, s20, s21
    s_add_u32 s20, s20, 3
    s_lshl_b32 s20, s20, 11
    s_add_u32 s20, s20, 7176192
    buffer_load_dwordx4 a[184:187], v1, s[8:11], s20 offen
    buffer_load_dwordx4 a[188:191], v1, s[8:11], s20 offen offset:1024
    v_mfma_f32_16x16x32_bf16 v[80:83], v[144:147], a[96:99], 0
    v_mfma_f32_16x16x32_bf16 v[80:83], v[148:151], a[100:103], v[80:83]
    v_mfma_f32_16x16x32_bf16 v[84:87], v[152:155], a[96:99], 0
    v_mfma_f32_16x16x32_bf16 v[84:87], v[156:159], a[100:103], v[84:87]
    v_mfma_f32_16x16x32_bf16 v[88:91], v[160:163], a[104:107], 0
    v_mfma_f32_16x16x32_bf16 v[88:91], v[164:167], a[108:111], v[88:91]
    v_mfma_f32_16x16x32_bf16 v[92:95], v[168:171], a[104:107], 0
    v_mfma_f32_16x16x32_bf16 v[92:95], v[172:175], a[108:111], v[92:95]
    v_mfma_f32_16x16x32_bf16 v[96:99], v[176:179], a[112:115], 0
    v_mfma_f32_16x16x32_bf16 v[96:99], v[180:183], a[116:119], v[96:99]
    v_mfma_f32_16x16x32_bf16 v[100:103], v[184:187], a[112:115], 0
    v_mfma_f32_16x16x32_bf16 v[100:103], v[188:191], a[116:119], v[100:103]
    v_mfma_f32_16x16x32_bf16 v[104:107], v[192:195], a[120:123], 0
    v_mfma_f32_16x16x32_bf16 v[104:107], v[196:199], a[124:127], v[104:107]
    v_mfma_f32_16x16x32_bf16 v[108:111], v[200:203], a[120:123], 0
    v_mfma_f32_16x16x32_bf16 v[108:111], v[204:207], a[124:127], v[108:111]
    ds_bpermute_b32 v112, v5, v84
    ds_bpermute_b32 v113, v5, v92
    s_nop 1
    ds_bpermute_b32 v114, v5, v100
    s_nop 2
    ds_bpermute_b32 v115, v5, v108
    s_waitcnt lgkmcnt(0)
    v_cvt_pk_bf16_f32 v120, v112, v112
    v_lshlrev_b32 v112, 16, v120
    v_add_f32 v112, v112, v6
    v_cvt_pk_bf16_f32 v120, v112, v112
    v_lshlrev_b32 v112, 16, v120
    v_rcp_f32 v112, v112
    v_cvt_pk_bf16_f32 v120, v80, v81
    v_lshlrev_b32 v80, 16, v120
    v_and_b32 v81, 0xffff0000, v120
    v_mul_f32 v80, v80, v112
    v_mul_f32 v81, v81, v112
    v_cvt_pk_bf16_f32 v116, v80, v81
    v_cvt_pk_bf16_f32 v120, v82, v83
    v_lshlrev_b32 v82, 16, v120
    v_and_b32 v83, 0xffff0000, v120
    v_mul_f32 v82, v82, v112
    v_mul_f32 v83, v83, v112
    v_cvt_pk_bf16_f32 v117, v82, v83
    v_cvt_pk_bf16_f32 v120, v84, v85
    v_lshlrev_b32 v84, 16, v120
    v_and_b32 v85, 0xffff0000, v120
    v_mul_f32 v84, v84, v112
    v_mul_f32 v85, v85, v112
    v_cvt_pk_bf16_f32 v118, v84, v85
    v_cvt_pk_bf16_f32 v120, v86, v87
    v_lshlrev_b32 v86, 16, v120
    v_and_b32 v87, 0xffff0000, v120
    v_mul_f32 v86, v86, v112
    v_mul_f32 v87, v87, v112
    v_cvt_pk_bf16_f32 v119, v86, v87
    s_nop 1
    v_mfma_f32_16x16x32_bf16 v[20:23], a[0:3], v[116:119], 0
    v_mfma_f32_16x16x32_bf16 v[36:39], a[16:19], v[116:119], 0
    v_mfma_f32_16x16x32_bf16 v[52:55], a[32:35], v[116:119], 0
    v_mfma_f32_16x16x32_bf16 v[68:71], a[48:51], v[116:119], 0
    v_cvt_pk_bf16_f32 v120, v113, v113
    v_lshlrev_b32 v113, 16, v120
    v_add_f32 v113, v113, v6
    v_cvt_pk_bf16_f32 v120, v113, v113
    v_lshlrev_b32 v113, 16, v120
    v_rcp_f32 v113, v113
    v_cvt_pk_bf16_f32 v120, v88, v89
    v_lshlrev_b32 v88, 16, v120
    v_and_b32 v89, 0xffff0000, v120
    v_mul_f32 v88, v88, v113
    v_mul_f32 v89, v89, v113
    v_cvt_pk_bf16_f32 v116, v88, v89
    v_cvt_pk_bf16_f32 v120, v90, v91
    v_lshlrev_b32 v90, 16, v120
    v_and_b32 v91, 0xffff0000, v120
    v_mul_f32 v90, v90, v113
    v_mul_f32 v91, v91, v113
    v_cvt_pk_bf16_f32 v117, v90, v91
    v_cvt_pk_bf16_f32 v120, v92, v93
    v_lshlrev_b32 v92, 16, v120
    v_and_b32 v93, 0xffff0000, v120
    v_mul_f32 v92, v92, v113
    v_mul_f32 v93, v93, v113
    v_cvt_pk_bf16_f32 v118, v92, v93
    v_cvt_pk_bf16_f32 v120, v94, v95
    v_lshlrev_b32 v94, 16, v120
    v_and_b32 v95, 0xffff0000, v120
    v_mul_f32 v94, v94, v113
    v_mul_f32 v95, v95, v113
    v_cvt_pk_bf16_f32 v119, v94, v95
    s_nop 1
    v_mfma_f32_16x16x32_bf16 v[20:23], a[4:7], v[116:119], v[20:23]
    v_mfma_f32_16x16x32_bf16 v[36:39], a[20:23], v[116:119], v[36:39]
    v_mfma_f32_16x16x32_bf16 v[52:55], a[36:39], v[116:119], v[52:55]
    v_mfma_f32_16x16x32_bf16 v[68:71], a[52:55], v[116:119], v[68:71]
    v_cvt_pk_bf16_f32 v120, v114, v114
    v_lshlrev_b32 v114, 16, v120
    v_add_f32 v114, v114, v6
    v_cvt_pk_bf16_f32 v120, v114, v114
    v_lshlrev_b32 v114, 16, v120
    v_rcp_f32 v114, v114
    v_cvt_pk_bf16_f32 v120, v96, v97
    v_lshlrev_b32 v96, 16, v120
    v_and_b32 v97, 0xffff0000, v120
    v_mul_f32 v96, v96, v114
    v_mul_f32 v97, v97, v114
    v_cvt_pk_bf16_f32 v116, v96, v97
    v_cvt_pk_bf16_f32 v120, v98, v99
    v_lshlrev_b32 v98, 16, v120
    v_and_b32 v99, 0xffff0000, v120
    v_mul_f32 v98, v98, v114
    v_mul_f32 v99, v99, v114
    v_cvt_pk_bf16_f32 v117, v98, v99
    v_cvt_pk_bf16_f32 v120, v100, v101
    v_lshlrev_b32 v100, 16, v120
    v_and_b32 v101, 0xffff0000, v120
    v_mul_f32 v100, v100, v114
    v_mul_f32 v101, v101, v114
    v_cvt_pk_bf16_f32 v118, v100, v101
    v_cvt_pk_bf16_f32 v120, v102, v103
    v_lshlrev_b32 v102, 16, v120
    v_and_b32 v103, 0xffff0000, v120
    v_mul_f32 v102, v102, v114
    v_mul_f32 v103, v103, v114
    v_cvt_pk_bf16_f32 v119, v102, v103
    s_nop 1
    v_mfma_f32_16x16x32_bf16 v[20:23], a[8:11], v[116:119], v[20:23]
    v_mfma_f32_16x16x32_bf16 v[36:39], a[24:27], v[116:119], v[36:39]
    v_mfma_f32_16x16x32_bf16 v[52:55], a[40:43], v[116:119], v[52:55]
    v_mfma_f32_16x16x32_bf16 v[68:71], a[56:59], v[116:119], v[68:71]
    v_cvt_pk_bf16_f32 v120, v115, v115
    v_lshlrev_b32 v115, 16, v120
    v_add_f32 v115, v115, v6
    v_cvt_pk_bf16_f32 v120, v115, v115
    v_lshlrev_b32 v115, 16, v120
    v_rcp_f32 v115, v115
    v_cvt_pk_bf16_f32 v120, v104, v105
    v_lshlrev_b32 v104, 16, v120
    v_and_b32 v105, 0xffff0000, v120
    v_mul_f32 v104, v104, v115
    v_mul_f32 v105, v105, v115
    v_cvt_pk_bf16_f32 v116, v104, v105
    v_cvt_pk_bf16_f32 v120, v106, v107
    v_lshlrev_b32 v106, 16, v120
    v_and_b32 v107, 0xffff0000, v120
    v_mul_f32 v106, v106, v115
    v_mul_f32 v107, v107, v115
    v_cvt_pk_bf16_f32 v117, v106, v107
    v_cvt_pk_bf16_f32 v120, v108, v109
    v_lshlrev_b32 v108, 16, v120
    v_and_b32 v109, 0xffff0000, v120
    v_mul_f32 v108, v108, v115
    v_mul_f32 v109, v109, v115
    v_cvt_pk_bf16_f32 v118, v108, v109
    v_cvt_pk_bf16_f32 v120, v110, v111
    v_lshlrev_b32 v110, 16, v120
    v_and_b32 v111, 0xffff0000, v120
    v_mul_f32 v110, v110, v115
    v_mul_f32 v111, v111, v115
    v_cvt_pk_bf16_f32 v119, v110, v111
    s_nop 1
    v_mfma_f32_16x16x32_bf16 v[20:23], a[12:15], v[116:119], v[20:23]
    v_mfma_f32_16x16x32_bf16 v[36:39], a[28:31], v[116:119], v[36:39]
    v_mfma_f32_16x16x32_bf16 v[52:55], a[44:47], v[116:119], v[52:55]
    v_mfma_f32_16x16x32_bf16 v[68:71], a[60:63], v[116:119], v[68:71]
    s_waitcnt vmcnt(8)
    v_mfma_f32_16x16x32_bf16 v[80:83], v[144:147], a[128:131], 0
    v_mfma_f32_16x16x32_bf16 v[80:83], v[148:151], a[132:135], v[80:83]
    v_mfma_f32_16x16x32_bf16 v[84:87], v[152:155], a[128:131], 0
    v_mfma_f32_16x16x32_bf16 v[84:87], v[156:159], a[132:135], v[84:87]
    v_mfma_f32_16x16x32_bf16 v[88:91], v[160:163], a[136:139], 0
    v_mfma_f32_16x16x32_bf16 v[88:91], v[164:167], a[140:143], v[88:91]
    v_mfma_f32_16x16x32_bf16 v[92:95], v[168:171], a[136:139], 0
    v_mfma_f32_16x16x32_bf16 v[92:95], v[172:175], a[140:143], v[92:95]
    v_mfma_f32_16x16x32_bf16 v[96:99], v[176:179], a[144:147], 0
    v_mfma_f32_16x16x32_bf16 v[96:99], v[180:183], a[148:151], v[96:99]
    v_mfma_f32_16x16x32_bf16 v[100:103], v[184:187], a[144:147], 0
    v_mfma_f32_16x16x32_bf16 v[100:103], v[188:191], a[148:151], v[100:103]
    v_mfma_f32_16x16x32_bf16 v[104:107], v[192:195], a[152:155], 0
    v_mfma_f32_16x16x32_bf16 v[104:107], v[196:199], a[156:159], v[104:107]
    v_mfma_f32_16x16x32_bf16 v[108:111], v[200:203], a[152:155], 0
    v_mfma_f32_16x16x32_bf16 v[108:111], v[204:207], a[156:159], v[108:111]
    ds_bpermute_b32 v112, v5, v84
    ds_bpermute_b32 v113, v5, v92
    s_nop 1
    ds_bpermute_b32 v114, v5, v100
    s_nop 2
    ds_bpermute_b32 v115, v5, v108
    s_waitcnt lgkmcnt(0)
    v_cvt_pk_bf16_f32 v120, v112, v112
    v_lshlrev_b32 v112, 16, v120
    v_add_f32 v112, v112, v6
    v_cvt_pk_bf16_f32 v120, v112, v112
    v_lshlrev_b32 v112, 16, v120
    v_rcp_f32 v112, v112
    v_cvt_pk_bf16_f32 v120, v80, v81
    v_lshlrev_b32 v80, 16, v120
    v_and_b32 v81, 0xffff0000, v120
    v_mul_f32 v80, v80, v112
    v_mul_f32 v81, v81, v112
    v_cvt_pk_bf16_f32 v116, v80, v81
    v_cvt_pk_bf16_f32 v120, v82, v83
    v_lshlrev_b32 v82, 16, v120
    v_and_b32 v83, 0xffff0000, v120
    v_mul_f32 v82, v82, v112
    v_mul_f32 v83, v83, v112
    v_cvt_pk_bf16_f32 v117, v82, v83
    v_cvt_pk_bf16_f32 v120, v84, v85
    v_lshlrev_b32 v84, 16, v120
    v_and_b32 v85, 0xffff0000, v120
    v_mul_f32 v84, v84, v112
    v_mul_f32 v85, v85, v112
    v_cvt_pk_bf16_f32 v118, v84, v85
    v_cvt_pk_bf16_f32 v120, v86, v87
    v_lshlrev_b32 v86, 16, v120
    v_and_b32 v87, 0xffff0000, v120
    v_mul_f32 v86, v86, v112
    v_mul_f32 v87, v87, v112
    v_cvt_pk_bf16_f32 v119, v86, v87
    s_nop 1
    v_mfma_f32_16x16x32_bf16 v[24:27], a[0:3], v[116:119], 0
    v_mfma_f32_16x16x32_bf16 v[40:43], a[16:19], v[116:119], 0
    v_mfma_f32_16x16x32_bf16 v[56:59], a[32:35], v[116:119], 0
    v_mfma_f32_16x16x32_bf16 v[72:75], a[48:51], v[116:119], 0
    v_cvt_pk_bf16_f32 v120, v113, v113
    v_lshlrev_b32 v113, 16, v120
    v_add_f32 v113, v113, v6
    v_cvt_pk_bf16_f32 v120, v113, v113
    v_lshlrev_b32 v113, 16, v120
    v_rcp_f32 v113, v113
    v_cvt_pk_bf16_f32 v120, v88, v89
    v_lshlrev_b32 v88, 16, v120
    v_and_b32 v89, 0xffff0000, v120
    v_mul_f32 v88, v88, v113
    v_mul_f32 v89, v89, v113
    v_cvt_pk_bf16_f32 v116, v88, v89
    v_cvt_pk_bf16_f32 v120, v90, v91
    v_lshlrev_b32 v90, 16, v120
    v_and_b32 v91, 0xffff0000, v120
    v_mul_f32 v90, v90, v113
    v_mul_f32 v91, v91, v113
    v_cvt_pk_bf16_f32 v117, v90, v91
    v_cvt_pk_bf16_f32 v120, v92, v93
    v_lshlrev_b32 v92, 16, v120
    v_and_b32 v93, 0xffff0000, v120
    v_mul_f32 v92, v92, v113
    v_mul_f32 v93, v93, v113
    v_cvt_pk_bf16_f32 v118, v92, v93
    v_cvt_pk_bf16_f32 v120, v94, v95
    v_lshlrev_b32 v94, 16, v120
    v_and_b32 v95, 0xffff0000, v120
    v_mul_f32 v94, v94, v113
    v_mul_f32 v95, v95, v113
    v_cvt_pk_bf16_f32 v119, v94, v95
    s_nop 1
    v_mfma_f32_16x16x32_bf16 v[24:27], a[4:7], v[116:119], v[24:27]
    v_mfma_f32_16x16x32_bf16 v[40:43], a[20:23], v[116:119], v[40:43]
    v_mfma_f32_16x16x32_bf16 v[56:59], a[36:39], v[116:119], v[56:59]
    v_mfma_f32_16x16x32_bf16 v[72:75], a[52:55], v[116:119], v[72:75]
    v_cvt_pk_bf16_f32 v120, v114, v114
    v_lshlrev_b32 v114, 16, v120
    v_add_f32 v114, v114, v6
    v_cvt_pk_bf16_f32 v120, v114, v114
    v_lshlrev_b32 v114, 16, v120
    v_rcp_f32 v114, v114
    v_cvt_pk_bf16_f32 v120, v96, v97
    v_lshlrev_b32 v96, 16, v120
    v_and_b32 v97, 0xffff0000, v120
    v_mul_f32 v96, v96, v114
    v_mul_f32 v97, v97, v114
    v_cvt_pk_bf16_f32 v116, v96, v97
    v_cvt_pk_bf16_f32 v120, v98, v99
    v_lshlrev_b32 v98, 16, v120
    v_and_b32 v99, 0xffff0000, v120
    v_mul_f32 v98, v98, v114
    v_mul_f32 v99, v99, v114
    v_cvt_pk_bf16_f32 v117, v98, v99
    v_cvt_pk_bf16_f32 v120, v100, v101
    v_lshlrev_b32 v100, 16, v120
    v_and_b32 v101, 0xffff0000, v120
    v_mul_f32 v100, v100, v114
    v_mul_f32 v101, v101, v114
    v_cvt_pk_bf16_f32 v118, v100, v101
    v_cvt_pk_bf16_f32 v120, v102, v103
    v_lshlrev_b32 v102, 16, v120
    v_and_b32 v103, 0xffff0000, v120
    v_mul_f32 v102, v102, v114
    v_mul_f32 v103, v103, v114
    v_cvt_pk_bf16_f32 v119, v102, v103
    s_nop 1
    v_mfma_f32_16x16x32_bf16 v[24:27], a[8:11], v[116:119], v[24:27]
    v_mfma_f32_16x16x32_bf16 v[40:43], a[24:27], v[116:119], v[40:43]
    v_mfma_f32_16x16x32_bf16 v[56:59], a[40:43], v[116:119], v[56:59]
    v_mfma_f32_16x16x32_bf16 v[72:75], a[56:59], v[116:119], v[72:75]
    v_cvt_pk_bf16_f32 v120, v115, v115
    v_lshlrev_b32 v115, 16, v120
    v_add_f32 v115, v115, v6
    v_cvt_pk_bf16_f32 v120, v115, v115
    v_lshlrev_b32 v115, 16, v120
    v_rcp_f32 v115, v115
    v_cvt_pk_bf16_f32 v120, v104, v105
    v_lshlrev_b32 v104, 16, v120
    v_and_b32 v105, 0xffff0000, v120
    v_mul_f32 v104, v104, v115
    v_mul_f32 v105, v105, v115
    v_cvt_pk_bf16_f32 v116, v104, v105
    v_cvt_pk_bf16_f32 v120, v106, v107
    v_lshlrev_b32 v106, 16, v120
    v_and_b32 v107, 0xffff0000, v120
    v_mul_f32 v106, v106, v115
    v_mul_f32 v107, v107, v115
    v_cvt_pk_bf16_f32 v117, v106, v107
    v_cvt_pk_bf16_f32 v120, v108, v109
    v_lshlrev_b32 v108, 16, v120
    v_and_b32 v109, 0xffff0000, v120
    v_mul_f32 v108, v108, v115
    v_mul_f32 v109, v109, v115
    v_cvt_pk_bf16_f32 v118, v108, v109
    v_cvt_pk_bf16_f32 v120, v110, v111
    v_lshlrev_b32 v110, 16, v120
    v_and_b32 v111, 0xffff0000, v120
    v_mul_f32 v110, v110, v115
    v_mul_f32 v111, v111, v115
    v_cvt_pk_bf16_f32 v119, v110, v111
    s_nop 1
    v_mfma_f32_16x16x32_bf16 v[24:27], a[12:15], v[116:119], v[24:27]
    v_mfma_f32_16x16x32_bf16 v[40:43], a[28:31], v[116:119], v[40:43]
    v_mfma_f32_16x16x32_bf16 v[56:59], a[44:47], v[116:119], v[56:59]
    v_mfma_f32_16x16x32_bf16 v[72:75], a[60:63], v[116:119], v[72:75]
    s_waitcnt vmcnt(0)
    v_mfma_f32_16x16x32_bf16 v[80:83], v[144:147], a[160:163], 0
    v_mfma_f32_16x16x32_bf16 v[80:83], v[148:151], a[164:167], v[80:83]
    v_mfma_f32_16x16x32_bf16 v[84:87], v[152:155], a[160:163], 0
    v_mfma_f32_16x16x32_bf16 v[84:87], v[156:159], a[164:167], v[84:87]
    v_mfma_f32_16x16x32_bf16 v[88:91], v[160:163], a[168:171], 0
    v_mfma_f32_16x16x32_bf16 v[88:91], v[164:167], a[172:175], v[88:91]
    v_mfma_f32_16x16x32_bf16 v[92:95], v[168:171], a[168:171], 0
    v_mfma_f32_16x16x32_bf16 v[92:95], v[172:175], a[172:175], v[92:95]
    v_mfma_f32_16x16x32_bf16 v[96:99], v[176:179], a[176:179], 0
    v_mfma_f32_16x16x32_bf16 v[96:99], v[180:183], a[180:183], v[96:99]
    v_mfma_f32_16x16x32_bf16 v[100:103], v[184:187], a[176:179], 0
    v_mfma_f32_16x16x32_bf16 v[100:103], v[188:191], a[180:183], v[100:103]
    v_mfma_f32_16x16x32_bf16 v[104:107], v[192:195], a[184:187], 0
    v_mfma_f32_16x16x32_bf16 v[104:107], v[196:199], a[188:191], v[104:107]
    v_mfma_f32_16x16x32_bf16 v[108:111], v[200:203], a[184:187], 0
    v_mfma_f32_16x16x32_bf16 v[108:111], v[204:207], a[188:191], v[108:111]
    ds_bpermute_b32 v112, v5, v84
    ds_bpermute_b32 v113, v5, v92
    s_nop 1
    ds_bpermute_b32 v114, v5, v100
    s_nop 2
    ds_bpermute_b32 v115, v5, v108
    s_waitcnt lgkmcnt(0)
    v_cvt_pk_bf16_f32 v120, v112, v112
    v_lshlrev_b32 v112, 16, v120
    v_add_f32 v112, v112, v6
    v_cvt_pk_bf16_f32 v120, v112, v112
    v_lshlrev_b32 v112, 16, v120
    v_rcp_f32 v112, v112
    v_cvt_pk_bf16_f32 v120, v80, v81
    v_lshlrev_b32 v80, 16, v120
    v_and_b32 v81, 0xffff0000, v120
    v_mul_f32 v80, v80, v112
    v_mul_f32 v81, v81, v112
    v_cvt_pk_bf16_f32 v116, v80, v81
    v_cvt_pk_bf16_f32 v120, v82, v83
    v_lshlrev_b32 v82, 16, v120
    v_and_b32 v83, 0xffff0000, v120
    v_mul_f32 v82, v82, v112
    v_mul_f32 v83, v83, v112
    v_cvt_pk_bf16_f32 v117, v82, v83
    v_cvt_pk_bf16_f32 v120, v84, v85
    v_lshlrev_b32 v84, 16, v120
    v_and_b32 v85, 0xffff0000, v120
    v_mul_f32 v84, v84, v112
    v_mul_f32 v85, v85, v112
    v_cvt_pk_bf16_f32 v118, v84, v85
    v_cvt_pk_bf16_f32 v120, v86, v87
    v_lshlrev_b32 v86, 16, v120
    v_and_b32 v87, 0xffff0000, v120
    v_mul_f32 v86, v86, v112
    v_mul_f32 v87, v87, v112
    v_cvt_pk_bf16_f32 v119, v86, v87
    s_nop 1
    v_mfma_f32_16x16x32_bf16 v[28:31], a[0:3], v[116:119], 0
    v_mfma_f32_16x16x32_bf16 v[44:47], a[16:19], v[116:119], 0
    v_mfma_f32_16x16x32_bf16 v[60:63], a[32:35], v[116:119], 0
    v_mfma_f32_16x16x32_bf16 v[76:79], a[48:51], v[116:119], 0
    v_cvt_pk_bf16_f32 v120, v113, v113
    v_lshlrev_b32 v113, 16, v120
    v_add_f32 v113, v113, v6
    v_cvt_pk_bf16_f32 v120, v113, v113
    v_lshlrev_b32 v113, 16, v120
    v_rcp_f32 v113, v113
    v_cvt_pk_bf16_f32 v120, v88, v89
    v_lshlrev_b32 v88, 16, v120
    v_and_b32 v89, 0xffff0000, v120
    v_mul_f32 v88, v88, v113
    v_mul_f32 v89, v89, v113
    v_cvt_pk_bf16_f32 v116, v88, v89
    v_cvt_pk_bf16_f32 v120, v90, v91
    v_lshlrev_b32 v90, 16, v120
    v_and_b32 v91, 0xffff0000, v120
    v_mul_f32 v90, v90, v113
    v_mul_f32 v91, v91, v113
    v_cvt_pk_bf16_f32 v117, v90, v91
    v_cvt_pk_bf16_f32 v120, v92, v93
    v_lshlrev_b32 v92, 16, v120
    v_and_b32 v93, 0xffff0000, v120
    v_mul_f32 v92, v92, v113
    v_mul_f32 v93, v93, v113
    v_cvt_pk_bf16_f32 v118, v92, v93
    v_cvt_pk_bf16_f32 v120, v94, v95
    v_lshlrev_b32 v94, 16, v120
    v_and_b32 v95, 0xffff0000, v120
    v_mul_f32 v94, v94, v113
    v_mul_f32 v95, v95, v113
    v_cvt_pk_bf16_f32 v119, v94, v95
    s_nop 1
    v_mfma_f32_16x16x32_bf16 v[28:31], a[4:7], v[116:119], v[28:31]
    v_mfma_f32_16x16x32_bf16 v[44:47], a[20:23], v[116:119], v[44:47]
    v_mfma_f32_16x16x32_bf16 v[60:63], a[36:39], v[116:119], v[60:63]
    v_mfma_f32_16x16x32_bf16 v[76:79], a[52:55], v[116:119], v[76:79]
    v_cvt_pk_bf16_f32 v120, v114, v114
    v_lshlrev_b32 v114, 16, v120
    v_add_f32 v114, v114, v6
    v_cvt_pk_bf16_f32 v120, v114, v114
    v_lshlrev_b32 v114, 16, v120
    v_rcp_f32 v114, v114
    v_cvt_pk_bf16_f32 v120, v96, v97
    v_lshlrev_b32 v96, 16, v120
    v_and_b32 v97, 0xffff0000, v120
    v_mul_f32 v96, v96, v114
    v_mul_f32 v97, v97, v114
    v_cvt_pk_bf16_f32 v116, v96, v97
    v_cvt_pk_bf16_f32 v120, v98, v99
    v_lshlrev_b32 v98, 16, v120
    v_and_b32 v99, 0xffff0000, v120
    v_mul_f32 v98, v98, v114
    v_mul_f32 v99, v99, v114
    v_cvt_pk_bf16_f32 v117, v98, v99
    v_cvt_pk_bf16_f32 v120, v100, v101
    v_lshlrev_b32 v100, 16, v120
    v_and_b32 v101, 0xffff0000, v120
    v_mul_f32 v100, v100, v114
    v_mul_f32 v101, v101, v114
    v_cvt_pk_bf16_f32 v118, v100, v101
    v_cvt_pk_bf16_f32 v120, v102, v103
    v_lshlrev_b32 v102, 16, v120
    v_and_b32 v103, 0xffff0000, v120
    v_mul_f32 v102, v102, v114
    v_mul_f32 v103, v103, v114
    v_cvt_pk_bf16_f32 v119, v102, v103
    s_nop 1
    v_mfma_f32_16x16x32_bf16 v[28:31], a[8:11], v[116:119], v[28:31]
    v_mfma_f32_16x16x32_bf16 v[44:47], a[24:27], v[116:119], v[44:47]
    v_mfma_f32_16x16x32_bf16 v[60:63], a[40:43], v[116:119], v[60:63]
    v_mfma_f32_16x16x32_bf16 v[76:79], a[56:59], v[116:119], v[76:79]
    v_cvt_pk_bf16_f32 v120, v115, v115
    v_lshlrev_b32 v115, 16, v120
    v_add_f32 v115, v115, v6
    v_cvt_pk_bf16_f32 v120, v115, v115
    v_lshlrev_b32 v115, 16, v120
    v_rcp_f32 v115, v115
    v_cvt_pk_bf16_f32 v120, v104, v105
    v_lshlrev_b32 v104, 16, v120
    v_and_b32 v105, 0xffff0000, v120
    v_mul_f32 v104, v104, v115
    v_mul_f32 v105, v105, v115
    v_cvt_pk_bf16_f32 v116, v104, v105
    v_cvt_pk_bf16_f32 v120, v106, v107
    v_lshlrev_b32 v106, 16, v120
    v_and_b32 v107, 0xffff0000, v120
    v_mul_f32 v106, v106, v115
    v_mul_f32 v107, v107, v115
    v_cvt_pk_bf16_f32 v117, v106, v107
    v_cvt_pk_bf16_f32 v120, v108, v109
    v_lshlrev_b32 v108, 16, v120
    v_and_b32 v109, 0xffff0000, v120
    v_mul_f32 v108, v108, v115
    v_mul_f32 v109, v109, v115
    v_cvt_pk_bf16_f32 v118, v108, v109
    v_cvt_pk_bf16_f32 v120, v110, v111
    v_lshlrev_b32 v110, 16, v120
    v_and_b32 v111, 0xffff0000, v120
    v_mul_f32 v110, v110, v115
    v_mul_f32 v111, v111, v115
    v_cvt_pk_bf16_f32 v119, v110, v111
    s_nop 1
    v_mfma_f32_16x16x32_bf16 v[28:31], a[12:15], v[116:119], v[28:31]
    v_mfma_f32_16x16x32_bf16 v[44:47], a[28:31], v[116:119], v[44:47]
    v_mfma_f32_16x16x32_bf16 v[60:63], a[44:47], v[116:119], v[60:63]
    v_mfma_f32_16x16x32_bf16 v[76:79], a[60:63], v[116:119], v[76:79]
    s_lshl_b32 s19, s3, 14
    v_add_u32 v4, s19, v1
    ds_write_b128 v4, v[16:19] offset:0
    ds_write_b128 v4, v[20:23] offset:1024
    ds_write_b128 v4, v[24:27] offset:2048
    ds_write_b128 v4, v[28:31] offset:3072
    ds_write_b128 v4, v[32:35] offset:4096
    ds_write_b128 v4, v[36:39] offset:5120
    ds_write_b128 v4, v[40:43] offset:6144
    ds_write_b128 v4, v[44:47] offset:7168
    ds_write_b128 v4, v[48:51] offset:8192
    ds_write_b128 v4, v[52:55] offset:9216
    ds_write_b128 v4, v[56:59] offset:10240
    ds_write_b128 v4, v[60:63] offset:11264
    ds_write_b128 v4, v[64:67] offset:12288
    ds_write_b128 v4, v[68:71] offset:13312
    ds_write_b128 v4, v[72:75] offset:14336
    ds_write_b128 v4, v[76:79] offset:15360
    s_lshl_b32 s19, s13, 2
    s_add_u32 s19, s19, s3
    s_mul_i32 s19, s19, 14336
    s_lshl_b32 s20, s12, 11
    s_add_u32 s19, s19, s20
    s_add_u32 s21, s19, 13205504
    buffer_load_dwordx4 v[80:83], v1, s[8:11], s21 offen
    buffer_load_dwordx4 v[84:87], v1, s[8:11], s21 offen offset:1024
    s_waitcnt lgkmcnt(0)
    s_barrier
    s_lshl_b32 s20, s3, 10
    v_add_u32 v4, s20, v1
    ds_read_b128 v[16:19], v4 offset:0
    ds_read_b128 v[20:23], v4 offset:4096
    ds_read_b128 v[24:27], v4 offset:8192
    ds_read_b128 v[28:31], v4 offset:12288
    ds_read_b128 v[32:35], v4 offset:16384
    ds_read_b128 v[36:39], v4 offset:20480
    ds_read_b128 v[40:43], v4 offset:24576
    ds_read_b128 v[44:47], v4 offset:28672
    ds_read_b128 v[48:51], v4 offset:32768
    ds_read_b128 v[52:55], v4 offset:36864
    ds_read_b128 v[56:59], v4 offset:40960
    ds_read_b128 v[60:63], v4 offset:45056
    ds_read_b128 v[64:67], v4 offset:49152
    ds_read_b128 v[68:71], v4 offset:53248
    ds_read_b128 v[72:75], v4 offset:57344
    ds_read_b128 v[76:79], v4 offset:61440
    s_waitcnt lgkmcnt(8)
    v_add_f32 v16, v16, v32
    v_add_f32 v17, v17, v33
    v_add_f32 v18, v18, v34
    v_add_f32 v19, v19, v35
    v_add_f32 v20, v20, v36
    v_add_f32 v21, v21, v37
    v_add_f32 v22, v22, v38
    v_add_f32 v23, v23, v39
    v_add_f32 v24, v24, v40
    v_add_f32 v25, v25, v41
    v_add_f32 v26, v26, v42
    v_add_f32 v27, v27, v43
    v_add_f32 v28, v28, v44
    v_add_f32 v29, v29, v45
    v_add_f32 v30, v30, v46
    v_add_f32 v31, v31, v47
    s_waitcnt lgkmcnt(0)
    v_add_f32 v48, v48, v64
    v_add_f32 v16, v16, v48
    v_add_f32 v49, v49, v65
    v_add_f32 v17, v17, v49
    v_add_f32 v50, v50, v66
    v_add_f32 v18, v18, v50
    v_add_f32 v51, v51, v67
    v_add_f32 v19, v19, v51
    v_add_f32 v52, v52, v68
    v_add_f32 v20, v20, v52
    v_add_f32 v53, v53, v69
    v_add_f32 v21, v21, v53
    v_add_f32 v54, v54, v70
    v_add_f32 v22, v22, v54
    v_add_f32 v55, v55, v71
    v_add_f32 v23, v23, v55
    v_add_f32 v56, v56, v72
    v_add_f32 v24, v24, v56
    v_add_f32 v57, v57, v73
    v_add_f32 v25, v25, v57
    v_add_f32 v58, v58, v74
    v_add_f32 v26, v26, v58
    v_add_f32 v59, v59, v75
    v_add_f32 v27, v27, v59
    v_add_f32 v60, v60, v76
    v_add_f32 v28, v28, v60
    v_add_f32 v61, v61, v77
    v_add_f32 v29, v29, v61
    v_add_f32 v62, v62, v78
    v_add_f32 v30, v30, v62
    v_add_f32 v63, v63, v79
    v_add_f32 v31, v31, v63
    s_waitcnt vmcnt(0)
    v_cvt_pk_bf16_f32 v6, v16, v17
    v_lshlrev_b32 v16, 16, v6
    v_and_b32 v17, 0xffff0000, v6
    v_lshlrev_b32 v7, 16, v80
    v_and_b32 v8, 0xffff0000, v80
    v_add_f32 v16, v16, v7
    v_add_f32 v17, v17, v8
    v_cvt_pk_bf16_f32 v96, v16, v17
    v_cvt_pk_bf16_f32 v6, v18, v19
    v_lshlrev_b32 v18, 16, v6
    v_and_b32 v19, 0xffff0000, v6
    v_lshlrev_b32 v7, 16, v81
    v_and_b32 v8, 0xffff0000, v81
    v_add_f32 v18, v18, v7
    v_add_f32 v19, v19, v8
    v_cvt_pk_bf16_f32 v97, v18, v19
    v_cvt_pk_bf16_f32 v6, v20, v21
    v_lshlrev_b32 v20, 16, v6
    v_and_b32 v21, 0xffff0000, v6
    v_lshlrev_b32 v7, 16, v82
    v_and_b32 v8, 0xffff0000, v82
    v_add_f32 v20, v20, v7
    v_add_f32 v21, v21, v8
    v_cvt_pk_bf16_f32 v98, v20, v21
    v_cvt_pk_bf16_f32 v6, v22, v23
    v_lshlrev_b32 v22, 16, v6
    v_and_b32 v23, 0xffff0000, v6
    v_lshlrev_b32 v7, 16, v83
    v_and_b32 v8, 0xffff0000, v83
    v_add_f32 v22, v22, v7
    v_add_f32 v23, v23, v8
    v_cvt_pk_bf16_f32 v99, v22, v23
    v_cvt_pk_bf16_f32 v6, v24, v25
    v_lshlrev_b32 v24, 16, v6
    v_and_b32 v25, 0xffff0000, v6
    v_lshlrev_b32 v7, 16, v84
    v_and_b32 v8, 0xffff0000, v84
    v_add_f32 v24, v24, v7
    v_add_f32 v25, v25, v8
    v_cvt_pk_bf16_f32 v100, v24, v25
    v_cvt_pk_bf16_f32 v6, v26, v27
    v_lshlrev_b32 v26, 16, v6
    v_and_b32 v27, 0xffff0000, v6
    v_lshlrev_b32 v7, 16, v85
    v_and_b32 v8, 0xffff0000, v85
    v_add_f32 v26, v26, v7
    v_add_f32 v27, v27, v8
    v_cvt_pk_bf16_f32 v101, v26, v27
    v_cvt_pk_bf16_f32 v6, v28, v29
    v_lshlrev_b32 v28, 16, v6
    v_and_b32 v29, 0xffff0000, v6
    v_lshlrev_b32 v7, 16, v86
    v_and_b32 v8, 0xffff0000, v86
    v_add_f32 v28, v28, v7
    v_add_f32 v29, v29, v8
    v_cvt_pk_bf16_f32 v102, v28, v29
    v_cvt_pk_bf16_f32 v6, v30, v31
    v_lshlrev_b32 v30, 16, v6
    v_and_b32 v31, 0xffff0000, v6
    v_lshlrev_b32 v7, 16, v87
    v_and_b32 v8, 0xffff0000, v87
    v_add_f32 v30, v30, v7
    v_add_f32 v31, v31, v8
    v_cvt_pk_bf16_f32 v103, v30, v31
    s_add_u32 s21, s19, 15040512
    buffer_store_dwordx4 v[96:99], v1, s[8:11], s21 offen
    buffer_store_dwordx4 v[100:103], v1, s[8:11], s21 offen offset:1024
    s_nop 11
K2_END_13205504:
    s_endpgm
.globl ffa1_kernel
.p2align 8
.type ffa1_kernel,@function
ffa1_kernel:
    s_load_dwordx2 s[6:7], s[0:1], 48
    s_load_dwordx2 s[4:5], s[0:1], 88
    s_cmp_ge_u32 s2, 224
    s_cbranch_scc1 K3_END_15040512
    v_lshrrev_b32 v1, 6, v0
    v_and_b32 v0, 63, v0
    v_readfirstlane_b32 s3, v1
    v_lshlrev_b32 v1, 4, v0
    v_and_b32 v2, 15, v0
    v_lshrrev_b32 v3, 4, v0
    s_waitcnt lgkmcnt(0)
    s_mov_b32 s8, s4
    s_and_b32 s9, s5, 0xffff
    s_mov_b32 s10, 0x10000000
    s_mov_b32 s11, 0x00020000
    s_mov_b32 s24, s6
    s_and_b32 s25, s7, 0xffff
    s_mov_b32 s26, 0xe00
    s_mov_b32 s27, 0x00020000
    s_and_b32 s14, s2, 7
    s_lshr_b32 s15, s2, 3
    s_and_b32 s12, s14, 1
    s_mul_i32 s12, s12, 7
    s_lshr_b32 s16, s15, 2
    s_add_u32 s12, s12, s16
    s_lshr_b32 s13, s14, 1
    s_lshl_b32 s13, s13, 2
    s_and_b32 s16, s15, 3
    s_add_u32 s13, s13, s16
    s_mul_i32 s16, s12, 114688
    s_add_u32 s16, s16, 3702784
    s_lshl_b32 s17, s13, 3
    s_add_u32 s17, s17, s3
    s_mov_b32 s30, s17
    s_mul_i32 s17, s17, 14336
    s_add_u32 s17, s17, 15040512
    s_lshl_b32 s20, s12, 8
    v_lshl_add_u32 v5, v3, 3, s20
    buffer_load_dwordx2 v[150:151], v5, s[24:27], 0 offen offset:0
    buffer_load_dwordx2 v[152:153], v5, s[24:27], 0 offen offset:32
    buffer_load_dwordx2 v[154:155], v5, s[24:27], 0 offen offset:64
    buffer_load_dwordx2 v[156:157], v5, s[24:27], 0 offen offset:96
    buffer_load_dwordx2 v[158:159], v5, s[24:27], 0 offen offset:128
    buffer_load_dwordx2 v[160:161], v5, s[24:27], 0 offen offset:160
    buffer_load_dwordx2 v[162:163], v5, s[24:27], 0 offen offset:192
    buffer_load_dwordx2 v[164:165], v5, s[24:27], 0 offen offset:224
    v_mov_b32 v104, 0x3f803f80
    v_mov_b32 v105, 0x3f803f80
    v_mov_b32 v106, 0x3f803f80
    v_mov_b32 v107, 0x3f803f80
    s_add_u32 s19, s3, 0
    s_add_u32 s19, s19, 0
    s_lshl_b32 s19, s19, 10
    s_mov_b32 m0, s19
    s_add_u32 s19, s19, s16
    buffer_load_dwordx4 v1, s[8:11], s19 offen lds
    s_add_u32 s19, s3, 8
    s_add_u32 s19, s19, 0
    s_lshl_b32 s19, s19, 10
    s_mov_b32 m0, s19
    s_add_u32 s19, s19, s16
    buffer_load_dwordx4 v1, s[8:11], s19 offen lds
    s_add_u32 s19, s3, 16
    s_add_u32 s19, s19, 0
    s_lshl_b32 s19, s19, 10
    s_mov_b32 m0, s19
    s_add_u32 s19, s19, s16
    buffer_load_dwordx4 v1, s[8:11], s19 offen lds
    s_add_u32 s19, s3, 24
    s_add_u32 s19, s19, 0
    s_lshl_b32 s19, s19, 10
    s_mov_b32 m0, s19
    s_add_u32 s19, s19, s16
    buffer_load_dwordx4 v1, s[8:11], s19 offen lds
    s_add_u32 s19, s17, 0
    buffer_load_dwordx4 v[16:19], v1, s[8:11], s19 offen
    s_add_u32 s19, s17, 1024
    buffer_load_dwordx4 v[20:23], v1, s[8:11], s19 offen
    s_add_u32 s19, s17, 2048
    buffer_load_dwordx4 v[24:27], v1, s[8:11], s19 offen
    s_add_u32 s19, s17, 3072
    buffer_load_dwordx4 v[28:31], v1, s[8:11], s19 offen
    s_add_u32 s19, s3, 0
    s_add_u32 s19, s19, 32
    s_lshl_b32 s19, s19, 10
    s_mov_b32 m0, s19
    s_add_u32 s19, s19, s16
    buffer_load_dwordx4 v1, s[8:11], s19 offen lds
    s_add_u32 s19, s3, 8
    s_add_u32 s19, s19, 32
    s_lshl_b32 s19, s19, 10
    s_mov_b32 m0, s19
    s_add_u32 s19, s19, s16
    buffer_load_dwordx4 v1, s[8:11], s19 offen lds
    s_add_u32 s19, s3, 16
    s_add_u32 s19, s19, 32
    s_lshl_b32 s19, s19, 10
    s_mov_b32 m0, s19
    s_add_u32 s19, s19, s16
    buffer_load_dwordx4 v1, s[8:11], s19 offen lds
    s_add_u32 s19, s3, 24
    s_add_u32 s19, s19, 32
    s_lshl_b32 s19, s19, 10
    s_mov_b32 m0, s19
    s_add_u32 s19, s19, s16
    buffer_load_dwordx4 v1, s[8:11], s19 offen lds
    s_add_u32 s19, s17, 4096
    buffer_load_dwordx4 v[32:35], v1, s[8:11], s19 offen
    s_add_u32 s19, s17, 5120
    buffer_load_dwordx4 v[36:39], v1, s[8:11], s19 offen
    s_add_u32 s19, s17, 6144
    buffer_load_dwordx4 v[40:43], v1, s[8:11], s19 offen
    s_add_u32 s19, s17, 7168
    buffer_load_dwordx4 v[44:47], v1, s[8:11], s19 offen
    v_add_u32 v4, 0x10000, v1
    s_min_u32 s19, s3, 7
    s_lshl_b32 s19, s19, 10
    v_add_u32 v5, s19, v1
    v_add_u32 v6, 0x10000, v5
    s_waitcnt vmcnt(8)
    s_barrier
    ds_read_b128 a[0:3], v1 offset:0
    ds_read_b128 a[4:7], v1 offset:1024
    ds_read_b128 a[8:11], v1 offset:2048
    ds_read_b128 a[12:15], v1 offset:3072
    ds_read_b128 a[16:19], v1 offset:4096
    ds_read_b128 a[20:23], v1 offset:5120
    ds_read_b128 a[24:27], v1 offset:6144
    ds_read_b128 a[28:31], v1 offset:7168
    ds_read_b128 a[64:67], v5 offset:0
    ds_read_b128 a[32:35], v1 offset:8192
    ds_read_b128 a[36:39], v1 offset:9216
    ds_read_b128 a[40:43], v1 offset:10240
    ds_read_b128 a[44:47], v1 offset:11264
    ds_read_b128 a[48:51], v1 offset:12288
    ds_read_b128 a[52:55], v1 offset:13312
    ds_read_b128 a[56:59], v1 offset:14336
    ds_read_b128 a[60:63], v1 offset:15360
    ds_read_b128 a[68:71], v5 offset:8192
    s_waitcnt lgkmcnt(9)
    v_mfma_f32_16x16x32_bf16 v[72:75], a[0:3], v[16:19], 0
    v_mfma_f32_16x16x32_bf16 v[76:79], a[4:7], v[16:19], 0
    v_mfma_f32_16x16x32_bf16 v[80:83], a[8:11], v[16:19], 0
    v_mfma_f32_16x16x32_bf16 v[84:87], a[12:15], v[16:19], 0
    v_mfma_f32_16x16x32_bf16 v[88:91], a[16:19], v[16:19], 0
    v_mfma_f32_16x16x32_bf16 v[92:95], a[20:23], v[16:19], 0
    v_mfma_f32_16x16x32_bf16 v[96:99], a[24:27], v[16:19], 0
    v_mfma_f32_16x16x32_bf16 v[100:103], a[28:31], v[16:19], 0
    v_mfma_f32_16x16x32_bf16 v[110:113], a[64:67], v[104:107], 0
    v_dot2_f32_bf16 v108, v16, v104, 0
    v_dot2_f32_bf16 v109, v16, v16, 0
    v_dot2_f32_bf16 v108, v17, v104, v108
    v_dot2_f32_bf16 v109, v17, v17, v109
    v_dot2_f32_bf16 v108, v18, v104, v108
    v_dot2_f32_bf16 v109, v18, v18, v109
    v_dot2_f32_bf16 v108, v19, v104, v108
    v_dot2_f32_bf16 v109, v19, v19, v109
    ds_read_b128 a[0:3], v1 offset:16384
    ds_read_b128 a[4:7], v1 offset:17408
    ds_read_b128 a[8:11], v1 offset:18432
    ds_read_b128 a[12:15], v1 offset:19456
    ds_read_b128 a[16:19], v1 offset:20480
    ds_read_b128 a[20:23], v1 offset:21504
    ds_read_b128 a[24:27], v1 offset:22528
    ds_read_b128 a[28:31], v1 offset:23552
    ds_read_b128 a[64:67], v5 offset:16384
    s_waitcnt lgkmcnt(9)
    v_mfma_f32_16x16x32_bf16 v[72:75], a[32:35], v[20:23], v[72:75]
    v_mfma_f32_16x16x32_bf16 v[76:79], a[36:39], v[20:23], v[76:79]
    v_mfma_f32_16x16x32_bf16 v[80:83], a[40:43], v[20:23], v[80:83]
    v_mfma_f32_16x16x32_bf16 v[84:87], a[44:47], v[20:23], v[84:87]
    v_mfma_f32_16x16x32_bf16 v[88:91], a[48:51], v[20:23], v[88:91]
    v_mfma_f32_16x16x32_bf16 v[92:95], a[52:55], v[20:23], v[92:95]
    v_mfma_f32_16x16x32_bf16 v[96:99], a[56:59], v[20:23], v[96:99]
    v_mfma_f32_16x16x32_bf16 v[100:103], a[60:63], v[20:23], v[100:103]
    v_mfma_f32_16x16x32_bf16 v[110:113], a[68:71], v[104:107], v[110:113]
    v_dot2_f32_bf16 v108, v20, v104, v108
    v_dot2_f32_bf16 v109, v20, v20, v109
    v_dot2_f32_bf16 v108, v21, v104, v108
    v_dot2_f32_bf16 v109, v21, v21, v109
    v_dot2_f32_bf16 v108, v22, v104, v108
    v_dot2_f32_bf16 v109, v22, v22, v109
    v_dot2_f32_bf16 v108, v23, v104, v108
    v_dot2_f32_bf16 v109, v23, v23, v109
    ds_read_b128 a[32:35], v1 offset:24576
    ds_read_b128 a[36:39], v1 offset:25600
    ds_read_b128 a[40:43], v1 offset:26624
    ds_read_b128 a[44:47], v1 offset:27648
    ds_read_b128 a[48:51], v1 offset:28672
    ds_read_b128 a[52:55], v1 offset:29696
    ds_read_b128 a[56:59], v1 offset:30720
    ds_read_b128 a[60:63], v1 offset:31744
    ds_read_b128 a[68:71], v5 offset:24576
    s_waitcnt lgkmcnt(9)
    v_mfma_f32_16x16x32_bf16 v[72:75], a[0:3], v[24:27], v[72:75]
    v_mfma_f32_16x16x32_bf16 v[76:79], a[4:7], v[24:27], v[76:79]
    v_mfma_f32_16x16x32_bf16 v[80:83], a[8:11], v[24:27], v[80:83]
    v_mfma_f32_16x16x32_bf16 v[84:87], a[12:15], v[24:27], v[84:87]
    v_mfma_f32_16x16x32_bf16 v[88:91], a[16:19], v[24:27], v[88:91]
    v_mfma_f32_16x16x32_bf16 v[92:95], a[20:23], v[24:27], v[92:95]
    v_mfma_f32_16x16x32_bf16 v[96:99], a[24:27], v[24:27], v[96:99]
    v_mfma_f32_16x16x32_bf16 v[100:103], a[28:31], v[24:27], v[100:103]
    v_mfma_f32_16x16x32_bf16 v[110:113], a[64:67], v[104:107], v[110:113]
    v_dot2_f32_bf16 v108, v24, v104, v108
    v_dot2_f32_bf16 v109, v24, v24, v109
    v_dot2_f32_bf16 v108, v25, v104, v108
    v_dot2_f32_bf16 v109, v25, v25, v109
    v_dot2_f32_bf16 v108, v26, v104, v108
    v_dot2_f32_bf16 v109, v26, v26, v109
    v_dot2_f32_bf16 v108, v27, v104, v108
    v_dot2_f32_bf16 v109, v27, v27, v109
    s_waitcnt vmcnt(0)
    s_barrier
    s_add_u32 s19, s3, 0
    s_add_u32 s19, s19, 64
    s_lshl_b32 s19, s19, 10
    s_mov_b32 m0, s19
    s_add_u32 s19, s19, s16
    buffer_load_dwordx4 v1, s[8:11], s19 offen lds
    s_add_u32 s19, s3, 8
    s_add_u32 s19, s19, 64
    s_lshl_b32 s19, s19, 10
    s_mov_b32 m0, s19
    s_add_u32 s19, s19, s16
    buffer_load_dwordx4 v1, s[8:11], s19 offen lds
    s_add_u32 s19, s3, 16
    s_add_u32 s19, s19, 64
    s_lshl_b32 s19, s19, 10
    s_mov_b32 m0, s19
    s_add_u32 s19, s19, s16
    buffer_load_dwordx4 v1, s[8:11], s19 offen lds
    s_add_u32 s19, s3, 24
    s_add_u32 s19, s19, 64
    s_lshl_b32 s19, s19, 10
    s_mov_b32 m0, s19
    s_add_u32 s19, s19, s16
    buffer_load_dwordx4 v1, s[8:11], s19 offen lds
    s_add_u32 s19, s17, 8192
    buffer_load_dwordx4 v[48:51], v1, s[8:11], s19 offen
    s_add_u32 s19, s17, 9216
    buffer_load_dwordx4 v[52:55], v1, s[8:11], s19 offen
    s_add_u32 s19, s17, 10240
    buffer_load_dwordx4 v[56:59], v1, s[8:11], s19 offen
    s_add_u32 s19, s17, 11264
    buffer_load_dwordx4 v[60:63], v1, s[8:11], s19 offen
    ds_read_b128 a[0:3], v1 offset:32768
    ds_read_b128 a[4:7], v1 offset:33792
    ds_read_b128 a[8:11], v1 offset:34816
    ds_read_b128 a[12:15], v1 offset:35840
    ds_read_b128 a[16:19], v1 offset:36864
    ds_read_b128 a[20:23], v1 offset:37888
    ds_read_b128 a[24:27], v1 offset:38912
    ds_read_b128 a[28:31], v1 offset:39936
    ds_read_b128 a[64:67], v5 offset:32768
    s_waitcnt lgkmcnt(9)
    v_mfma_f32_16x16x32_bf16 v[72:75], a[32:35], v[28:31], v[72:75]
    v_mfma_f32_16x16x32_bf16 v[76:79], a[36:39], v[28:31], v[76:79]
    v_mfma_f32_16x16x32_bf16 v[80:83], a[40:43], v[28:31], v[80:83]
    v_mfma_f32_16x16x32_bf16 v[84:87], a[44:47], v[28:31], v[84:87]
    v_mfma_f32_16x16x32_bf16 v[88:91], a[48:51], v[28:31], v[88:91]
    v_mfma_f32_16x16x32_bf16 v[92:95], a[52:55], v[28:31], v[92:95]
    v_mfma_f32_16x16x32_bf16 v[96:99], a[56:59], v[28:31], v[96:99]
    v_mfma_f32_16x16x32_bf16 v[100:103], a[60:63], v[28:31], v[100:103]
    v_mfma_f32_16x16x32_bf16 v[110:113], a[68:71], v[104:107], v[110:113]
    v_dot2_f32_bf16 v108, v28, v104, v108
    v_dot2_f32_bf16 v109, v28, v28, v109
    v_dot2_f32_bf16 v108, v29, v104, v108
    v_dot2_f32_bf16 v109, v29, v29, v109
    v_dot2_f32_bf16 v108, v30, v104, v108
    v_dot2_f32_bf16 v109, v30, v30, v109
    v_dot2_f32_bf16 v108, v31, v104, v108
    v_dot2_f32_bf16 v109, v31, v31, v109
    ds_read_b128 a[32:35], v1 offset:40960
    ds_read_b128 a[36:39], v1 offset:41984
    ds_read_b128 a[40:43], v1 offset:43008
    ds_read_b128 a[44:47], v1 offset:44032
    ds_read_b128 a[48:51], v1 offset:45056
    ds_read_b128 a[52:55], v1 offset:46080
    ds_read_b128 a[56:59], v1 offset:47104
    ds_read_b128 a[60:63], v1 offset:48128
    ds_read_b128 a[68:71], v5 offset:40960
    s_waitcnt lgkmcnt(9)
    v_mfma_f32_16x16x32_bf16 v[72:75], a[0:3], v[32:35], v[72:75]
    v_mfma_f32_16x16x32_bf16 v[76:79], a[4:7], v[32:35], v[76:79]
    v_mfma_f32_16x16x32_bf16 v[80:83], a[8:11], v[32:35], v[80:83]
    v_mfma_f32_16x16x32_bf16 v[84:87], a[12:15], v[32:35], v[84:87]
    v_mfma_f32_16x16x32_bf16 v[88:91], a[16:19], v[32:35], v[88:91]
    v_mfma_f32_16x16x32_bf16 v[92:95], a[20:23], v[32:35], v[92:95]
    v_mfma_f32_16x16x32_bf16 v[96:99], a[24:27], v[32:35], v[96:99]
    v_mfma_f32_16x16x32_bf16 v[100:103], a[28:31], v[32:35], v[100:103]
    v_mfma_f32_16x16x32_bf16 v[110:113], a[64:67], v[104:107], v[110:113]
    v_dot2_f32_bf16 v108, v32, v104, v108
    v_dot2_f32_bf16 v109, v32, v32, v109
    v_dot2_f32_bf16 v108, v33, v104, v108
    v_dot2_f32_bf16 v109, v33, v33, v109
    v_dot2_f32_bf16 v108, v34, v104, v108
    v_dot2_f32_bf16 v109, v34, v34, v109
    v_dot2_f32_bf16 v108, v35, v104, v108
    v_dot2_f32_bf16 v109, v35, v35, v109
    ds_read_b128 a[0:3], v1 offset:49152
    ds_read_b128 a[4:7], v1 offset:50176
    ds_read_b128 a[8:11], v1 offset:51200
    ds_read_b128 a[12:15], v1 offset:52224
    ds_read_b128 a[16:19], v1 offset:53248
    ds_read_b128 a[20:23], v1 offset:54272
    ds_read_b128 a[24:27], v1 offset:55296
    ds_read_b128 a[28:31], v1 offset:56320
    ds_read_b128 a[64:67], v5 offset:49152
    s_waitcnt lgkmcnt(9)
    v_mfma_f32_16x16x32_bf16 v[72:75], a[32:35], v[36:39], v[72:75]
    v_mfma_f32_16x16x32_bf16 v[76:79], a[36:39], v[36:39], v[76:79]
    v_mfma_f32_16x16x32_bf16 v[80:83], a[40:43], v[36:39], v[80:83]
    v_mfma_f32_16x16x32_bf16 v[84:87], a[44:47], v[36:39], v[84:87]
    v_mfma_f32_16x16x32_bf16 v[88:91], a[48:51], v[36:39], v[88:91]
    v_mfma_f32_16x16x32_bf16 v[92:95], a[52:55], v[36:39], v[92:95]
    v_mfma_f32_16x16x32_bf16 v[96:99], a[56:59], v[36:39], v[96:99]
    v_mfma_f32_16x16x32_bf16 v[100:103], a[60:63], v[36:39], v[100:103]
    v_mfma_f32_16x16x32_bf16 v[110:113], a[68:71], v[104:107], v[110:113]
    v_dot2_f32_bf16 v108, v36, v104, v108
    v_dot2_f32_bf16 v109, v36, v36, v109
    v_dot2_f32_bf16 v108, v37, v104, v108
    v_dot2_f32_bf16 v109, v37, v37, v109
    v_dot2_f32_bf16 v108, v38, v104, v108
    v_dot2_f32_bf16 v109, v38, v38, v109
    v_dot2_f32_bf16 v108, v39, v104, v108
    v_dot2_f32_bf16 v109, v39, v39, v109
    ds_read_b128 a[32:35], v1 offset:57344
    ds_read_b128 a[36:39], v1 offset:58368
    ds_read_b128 a[40:43], v1 offset:59392
    ds_read_b128 a[44:47], v1 offset:60416
    ds_read_b128 a[48:51], v1 offset:61440
    ds_read_b128 a[52:55], v1 offset:62464
    ds_read_b128 a[56:59], v1 offset:63488
    ds_read_b128 a[60:63], v1 offset:64512
    ds_read_b128 a[68:71], v5 offset:57344
    s_waitcnt lgkmcnt(9)
    v_mfma_f32_16x16x32_bf16 v[72:75], a[0:3], v[40:43], v[72:75]
    v_mfma_f32_16x16x32_bf16 v[76:79], a[4:7], v[40:43], v[76:79]
    v_mfma_f32_16x16x32_bf16 v[80:83], a[8:11], v[40:43], v[80:83]
    v_mfma_f32_16x16x32_bf16 v[84:87], a[12:15], v[40:43], v[84:87]
    v_mfma_f32_16x16x32_bf16 v[88:91], a[16:19], v[40:43], v[88:91]
    v_mfma_f32_16x16x32_bf16 v[92:95], a[20:23], v[40:43], v[92:95]
    v_mfma_f32_16x16x32_bf16 v[96:99], a[24:27], v[40:43], v[96:99]
    v_mfma_f32_16x16x32_bf16 v[100:103], a[28:31], v[40:43], v[100:103]
    v_mfma_f32_16x16x32_bf16 v[110:113], a[64:67], v[104:107], v[110:113]
    v_dot2_f32_bf16 v108, v40, v104, v108
    v_dot2_f32_bf16 v109, v40, v40, v109
    v_dot2_f32_bf16 v108, v41, v104, v108
    v_dot2_f32_bf16 v109, v41, v41, v109
    v_dot2_f32_bf16 v108, v42, v104, v108
    v_dot2_f32_bf16 v109, v42, v42, v109
    v_dot2_f32_bf16 v108, v43, v104, v108
    v_dot2_f32_bf16 v109, v43, v43, v109
    s_waitcnt vmcnt(0)
    s_barrier
    s_add_u32 s19, s3, 0
    s_add_u32 s19, s19, 96
    s_lshl_b32 s19, s19, 10
    s_mov_b32 m0, s19
    s_add_u32 s19, s19, s16
    buffer_load_dwordx4 v1, s[8:11], s19 offen lds
    s_add_u32 s19, s3, 8
    s_add_u32 s19, s19, 96
    s_lshl_b32 s19, s19, 10
    s_mov_b32 m0, s19
    s_add_u32 s19, s19, s16
    buffer_load_dwordx4 v1, s[8:11], s19 offen lds
    s_add_u32 s19, s17, 12288
    buffer_load_dwordx4 v[64:67], v1, s[8:11], s19 offen
    s_add_u32 s19, s17, 13312
    buffer_load_dwordx4 v[68:71], v1, s[8:11], s19 offen
    ds_read_b128 a[0:3], v4 offset:0
    ds_read_b128 a[4:7], v4 offset:1024
    ds_read_b128 a[8:11], v4 offset:2048
    ds_read_b128 a[12:15], v4 offset:3072
    ds_read_b128 a[16:19], v4 offset:4096
    ds_read_b128 a[20:23], v4 offset:5120
    ds_read_b128 a[24:27], v4 offset:6144
    ds_read_b128 a[28:31], v4 offset:7168
    ds_read_b128 a[64:67], v6 offset:0
    s_waitcnt lgkmcnt(9)
    v_mfma_f32_16x16x32_bf16 v[72:75], a[32:35], v[44:47], v[72:75]
    v_mfma_f32_16x16x32_bf16 v[76:79], a[36:39], v[44:47], v[76:79]
    v_mfma_f32_16x16x32_bf16 v[80:83], a[40:43], v[44:47], v[80:83]
    v_mfma_f32_16x16x32_bf16 v[84:87], a[44:47], v[44:47], v[84:87]
    v_mfma_f32_16x16x32_bf16 v[88:91], a[48:51], v[44:47], v[88:91]
    v_mfma_f32_16x16x32_bf16 v[92:95], a[52:55], v[44:47], v[92:95]
    v_mfma_f32_16x16x32_bf16 v[96:99], a[56:59], v[44:47], v[96:99]
    v_mfma_f32_16x16x32_bf16 v[100:103], a[60:63], v[44:47], v[100:103]
    v_mfma_f32_16x16x32_bf16 v[110:113], a[68:71], v[104:107], v[110:113]
    v_dot2_f32_bf16 v108, v44, v104, v108
    v_dot2_f32_bf16 v109, v44, v44, v109
    v_dot2_f32_bf16 v108, v45, v104, v108
    v_dot2_f32_bf16 v109, v45, v45, v109
    v_dot2_f32_bf16 v108, v46, v104, v108
    v_dot2_f32_bf16 v109, v46, v46, v109
    v_dot2_f32_bf16 v108, v47, v104, v108
    v_dot2_f32_bf16 v109, v47, v47, v109
    ds_read_b128 a[32:35], v4 offset:8192
    ds_read_b128 a[36:39], v4 offset:9216
    ds_read_b128 a[40:43], v4 offset:10240
    ds_read_b128 a[44:47], v4 offset:11264
    ds_read_b128 a[48:51], v4 offset:12288
    ds_read_b128 a[52:55], v4 offset:13312
    ds_read_b128 a[56:59], v4 offset:14336
    ds_read_b128 a[60:63], v4 offset:15360
    ds_read_b128 a[68:71], v6 offset:8192
    s_waitcnt lgkmcnt(9)
    v_mfma_f32_16x16x32_bf16 v[72:75], a[0:3], v[48:51], v[72:75]
    v_mfma_f32_16x16x32_bf16 v[76:79], a[4:7], v[48:51], v[76:79]
    v_mfma_f32_16x16x32_bf16 v[80:83], a[8:11], v[48:51], v[80:83]
    v_mfma_f32_16x16x32_bf16 v[84:87], a[12:15], v[48:51], v[84:87]
    v_mfma_f32_16x16x32_bf16 v[88:91], a[16:19], v[48:51], v[88:91]
    v_mfma_f32_16x16x32_bf16 v[92:95], a[20:23], v[48:51], v[92:95]
    v_mfma_f32_16x16x32_bf16 v[96:99], a[24:27], v[48:51], v[96:99]
    v_mfma_f32_16x16x32_bf16 v[100:103], a[28:31], v[48:51], v[100:103]
    v_mfma_f32_16x16x32_bf16 v[110:113], a[64:67], v[104:107], v[110:113]
    v_dot2_f32_bf16 v108, v48, v104, v108
    v_dot2_f32_bf16 v109, v48, v48, v109
    v_dot2_f32_bf16 v108, v49, v104, v108
    v_dot2_f32_bf16 v109, v49, v49, v109
    v_dot2_f32_bf16 v108, v50, v104, v108
    v_dot2_f32_bf16 v109, v50, v50, v109
    v_dot2_f32_bf16 v108, v51, v104, v108
    v_dot2_f32_bf16 v109, v51, v51, v109
    ds_read_b128 a[0:3], v4 offset:16384
    ds_read_b128 a[4:7], v4 offset:17408
    ds_read_b128 a[8:11], v4 offset:18432
    ds_read_b128 a[12:15], v4 offset:19456
    ds_read_b128 a[16:19], v4 offset:20480
    ds_read_b128 a[20:23], v4 offset:21504
    ds_read_b128 a[24:27], v4 offset:22528
    ds_read_b128 a[28:31], v4 offset:23552
    ds_read_b128 a[64:67], v6 offset:16384
    s_waitcnt lgkmcnt(9)
    v_mfma_f32_16x16x32_bf16 v[72:75], a[32:35], v[52:55], v[72:75]
    v_mfma_f32_16x16x32_bf16 v[76:79], a[36:39], v[52:55], v[76:79]
    v_mfma_f32_16x16x32_bf16 v[80:83], a[40:43], v[52:55], v[80:83]
    v_mfma_f32_16x16x32_bf16 v[84:87], a[44:47], v[52:55], v[84:87]
    v_mfma_f32_16x16x32_bf16 v[88:91], a[48:51], v[52:55], v[88:91]
    v_mfma_f32_16x16x32_bf16 v[92:95], a[52:55], v[52:55], v[92:95]
    v_mfma_f32_16x16x32_bf16 v[96:99], a[56:59], v[52:55], v[96:99]
    v_mfma_f32_16x16x32_bf16 v[100:103], a[60:63], v[52:55], v[100:103]
    v_mfma_f32_16x16x32_bf16 v[110:113], a[68:71], v[104:107], v[110:113]
    v_dot2_f32_bf16 v108, v52, v104, v108
    v_dot2_f32_bf16 v109, v52, v52, v109
    v_dot2_f32_bf16 v108, v53, v104, v108
    v_dot2_f32_bf16 v109, v53, v53, v109
    v_dot2_f32_bf16 v108, v54, v104, v108
    v_dot2_f32_bf16 v109, v54, v54, v109
    v_dot2_f32_bf16 v108, v55, v104, v108
    v_dot2_f32_bf16 v109, v55, v55, v109
    ds_read_b128 a[32:35], v4 offset:24576
    ds_read_b128 a[36:39], v4 offset:25600
    ds_read_b128 a[40:43], v4 offset:26624
    ds_read_b128 a[44:47], v4 offset:27648
    ds_read_b128 a[48:51], v4 offset:28672
    ds_read_b128 a[52:55], v4 offset:29696
    ds_read_b128 a[56:59], v4 offset:30720
    ds_read_b128 a[60:63], v4 offset:31744
    ds_read_b128 a[68:71], v6 offset:24576
    s_waitcnt lgkmcnt(9)
    v_mfma_f32_16x16x32_bf16 v[72:75], a[0:3], v[56:59], v[72:75]
    v_mfma_f32_16x16x32_bf16 v[76:79], a[4:7], v[56:59], v[76:79]
    v_mfma_f32_16x16x32_bf16 v[80:83], a[8:11], v[56:59], v[80:83]
    v_mfma_f32_16x16x32_bf16 v[84:87], a[12:15], v[56:59], v[84:87]
    v_mfma_f32_16x16x32_bf16 v[88:91], a[16:19], v[56:59], v[88:91]
    v_mfma_f32_16x16x32_bf16 v[92:95], a[20:23], v[56:59], v[92:95]
    v_mfma_f32_16x16x32_bf16 v[96:99], a[24:27], v[56:59], v[96:99]
    v_mfma_f32_16x16x32_bf16 v[100:103], a[28:31], v[56:59], v[100:103]
    v_mfma_f32_16x16x32_bf16 v[110:113], a[64:67], v[104:107], v[110:113]
    v_dot2_f32_bf16 v108, v56, v104, v108
    v_dot2_f32_bf16 v109, v56, v56, v109
    v_dot2_f32_bf16 v108, v57, v104, v108
    v_dot2_f32_bf16 v109, v57, v57, v109
    v_dot2_f32_bf16 v108, v58, v104, v108
    v_dot2_f32_bf16 v109, v58, v58, v109
    v_dot2_f32_bf16 v108, v59, v104, v108
    v_dot2_f32_bf16 v109, v59, v59, v109
    s_waitcnt vmcnt(0)
    s_barrier
    ds_read_b128 a[0:3], v4 offset:32768
    ds_read_b128 a[4:7], v4 offset:33792
    ds_read_b128 a[8:11], v4 offset:34816
    ds_read_b128 a[12:15], v4 offset:35840
    ds_read_b128 a[16:19], v4 offset:36864
    ds_read_b128 a[20:23], v4 offset:37888
    ds_read_b128 a[24:27], v4 offset:38912
    ds_read_b128 a[28:31], v4 offset:39936
    ds_read_b128 a[64:67], v6 offset:32768
    s_waitcnt lgkmcnt(9)
    v_mfma_f32_16x16x32_bf16 v[72:75], a[32:35], v[60:63], v[72:75]
    v_mfma_f32_16x16x32_bf16 v[76:79], a[36:39], v[60:63], v[76:79]
    v_mfma_f32_16x16x32_bf16 v[80:83], a[40:43], v[60:63], v[80:83]
    v_mfma_f32_16x16x32_bf16 v[84:87], a[44:47], v[60:63], v[84:87]
    v_mfma_f32_16x16x32_bf16 v[88:91], a[48:51], v[60:63], v[88:91]
    v_mfma_f32_16x16x32_bf16 v[92:95], a[52:55], v[60:63], v[92:95]
    v_mfma_f32_16x16x32_bf16 v[96:99], a[56:59], v[60:63], v[96:99]
    v_mfma_f32_16x16x32_bf16 v[100:103], a[60:63], v[60:63], v[100:103]
    v_mfma_f32_16x16x32_bf16 v[110:113], a[68:71], v[104:107], v[110:113]
    v_dot2_f32_bf16 v108, v60, v104, v108
    v_dot2_f32_bf16 v109, v60, v60, v109
    v_dot2_f32_bf16 v108, v61, v104, v108
    v_dot2_f32_bf16 v109, v61, v61, v109
    v_dot2_f32_bf16 v108, v62, v104, v108
    v_dot2_f32_bf16 v109, v62, v62, v109
    v_dot2_f32_bf16 v108, v63, v104, v108
    v_dot2_f32_bf16 v109, v63, v63, v109
    ds_read_b128 a[32:35], v4 offset:40960
    ds_read_b128 a[36:39], v4 offset:41984
    ds_read_b128 a[40:43], v4 offset:43008
    ds_read_b128 a[44:47], v4 offset:44032
    ds_read_b128 a[48:51], v4 offset:45056
    ds_read_b128 a[52:55], v4 offset:46080
    ds_read_b128 a[56:59], v4 offset:47104
    ds_read_b128 a[60:63], v4 offset:48128
    ds_read_b128 a[68:71], v6 offset:40960
    s_waitcnt lgkmcnt(9)
    v_mfma_f32_16x16x32_bf16 v[72:75], a[0:3], v[64:67], v[72:75]
    v_mfma_f32_16x16x32_bf16 v[76:79], a[4:7], v[64:67], v[76:79]
    v_mfma_f32_16x16x32_bf16 v[80:83], a[8:11], v[64:67], v[80:83]
    v_mfma_f32_16x16x32_bf16 v[84:87], a[12:15], v[64:67], v[84:87]
    v_mfma_f32_16x16x32_bf16 v[88:91], a[16:19], v[64:67], v[88:91]
    v_mfma_f32_16x16x32_bf16 v[92:95], a[20:23], v[64:67], v[92:95]
    v_mfma_f32_16x16x32_bf16 v[96:99], a[24:27], v[64:67], v[96:99]
    v_mfma_f32_16x16x32_bf16 v[100:103], a[28:31], v[64:67], v[100:103]
    v_mfma_f32_16x16x32_bf16 v[110:113], a[64:67], v[104:107], v[110:113]
    v_dot2_f32_bf16 v108, v64, v104, v108
    v_dot2_f32_bf16 v109, v64, v64, v109
    v_dot2_f32_bf16 v108, v65, v104, v108
    v_dot2_f32_bf16 v109, v65, v65, v109
    v_dot2_f32_bf16 v108, v66, v104, v108
    v_dot2_f32_bf16 v109, v66, v66, v109
    v_dot2_f32_bf16 v108, v67, v104, v108
    v_dot2_f32_bf16 v109, v67, v67, v109
    s_waitcnt lgkmcnt(0)
    v_mfma_f32_16x16x32_bf16 v[72:75], a[32:35], v[68:71], v[72:75]
    v_mfma_f32_16x16x32_bf16 v[76:79], a[36:39], v[68:71], v[76:79]
    v_mfma_f32_16x16x32_bf16 v[80:83], a[40:43], v[68:71], v[80:83]
    v_mfma_f32_16x16x32_bf16 v[84:87], a[44:47], v[68:71], v[84:87]
    v_mfma_f32_16x16x32_bf16 v[88:91], a[48:51], v[68:71], v[88:91]
    v_mfma_f32_16x16x32_bf16 v[92:95], a[52:55], v[68:71], v[92:95]
    v_mfma_f32_16x16x32_bf16 v[96:99], a[56:59], v[68:71], v[96:99]
    v_mfma_f32_16x16x32_bf16 v[100:103], a[60:63], v[68:71], v[100:103]
    v_mfma_f32_16x16x32_bf16 v[110:113], a[68:71], v[104:107], v[110:113]
    v_dot2_f32_bf16 v108, v68, v104, v108
    v_dot2_f32_bf16 v109, v68, v68, v109
    v_dot2_f32_bf16 v108, v69, v104, v108
    v_dot2_f32_bf16 v109, v69, v69, v109
    v_dot2_f32_bf16 v108, v70, v104, v108
    v_dot2_f32_bf16 v109, v70, v70, v109
    v_dot2_f32_bf16 v108, v71, v104, v108
    v_dot2_f32_bf16 v109, v71, v71, v109
    s_min_u32 s19, s3, 7
    s_lshl_b32 s19, s19, 10
    v_add_u32 v5, s19, v1
    ds_write_b128 v6, v[110:113] offset:49152
    v_mov_b32 v7, v108
    s_nop 1
    v_permlane16_swap_b32 v108, v7
    v_add_f32 v108, v108, v7
    v_mov_b32 v7, v108
    s_nop 1
    v_permlane32_swap_b32 v108, v7
    v_add_f32 v108, v108, v7
    v_mov_b32 v7, v109
    s_nop 1
    v_permlane16_swap_b32 v109, v7
    v_add_f32 v109, v109, v7
    v_mov_b32 v7, v109
    s_nop 1
    v_permlane32_swap_b32 v109, v7
    v_add_f32 v109, v109, v7
    s_waitcnt lgkmcnt(0)
    s_barrier
    ds_read_b128 v[114:117], v4 offset:49152
    ds_read_b128 v[118:121], v4 offset:50176
    ds_read_b128 v[122:125], v4 offset:51200
    ds_read_b128 v[126:129], v4 offset:52224
    ds_read_b128 v[130:133], v4 offset:53248
    ds_read_b128 v[134:137], v4 offset:54272
    ds_read_b128 v[138:141], v4 offset:55296
    ds_read_b128 v[142:145], v4 offset:56320
    v_mul_f32 v10, 0x3b124925, v108
    v_mul_f32 v11, 0x3b124925, v109
    v_fma_f32 v11, -v10, v10, v11
    v_max_f32 v11, 0, v11
    v_cvt_pk_bf16_f32 v10, v10, v10
    v_lshlrev_b32 v8, 16, v10
    v_cvt_pk_bf16_f32 v10, v11, v11
    v_lshlrev_b32 v11, 16, v10
    v_add_f32 v11, 0x3727c5ac, v11
    v_cvt_pk_bf16_f32 v10, v11, v11
    v_lshlrev_b32 v11, 16, v10
    v_sqrt_f32 v11, v11
    s_nop 0
    v_cvt_pk_bf16_f32 v10, v11, v11
    v_lshlrev_b32 v11, 16, v10
    v_rcp_f32 v9, v11
    v_sub_f32 v8, 0, v8
    v_mov_b32 v12, v8
    v_mov_b32 v13, v8
    v_mov_b32 v14, v9
    v_mov_b32 v15, v9
    v_lshlrev_b32 v16, 16, v150
    v_and_b32 v17, 0xffff0000, v150
    v_lshlrev_b32 v18, 16, v151
    v_and_b32 v19, 0xffff0000, v151
    v_lshlrev_b32 v20, 16, v152
    v_and_b32 v21, 0xffff0000, v152
    v_lshlrev_b32 v22, 16, v153
    v_and_b32 v23, 0xffff0000, v153
    v_lshlrev_b32 v24, 16, v154
    v_and_b32 v25, 0xffff0000, v154
    v_lshlrev_b32 v26, 16, v155
    v_and_b32 v27, 0xffff0000, v155
    v_lshlrev_b32 v28, 16, v156
    v_and_b32 v29, 0xffff0000, v156
    v_lshlrev_b32 v30, 16, v157
    v_and_b32 v31, 0xffff0000, v157
    v_lshlrev_b32 v32, 16, v158
    v_and_b32 v33, 0xffff0000, v158
    v_lshlrev_b32 v34, 16, v159
    v_and_b32 v35, 0xffff0000, v159
    v_lshlrev_b32 v36, 16, v160
    v_and_b32 v37, 0xffff0000, v160
    v_lshlrev_b32 v38, 16, v161
    v_and_b32 v39, 0xffff0000, v161
    v_lshlrev_b32 v40, 16, v162
    v_and_b32 v41, 0xffff0000, v162
    v_lshlrev_b32 v42, 16, v163
    v_and_b32 v43, 0xffff0000, v163
    v_lshlrev_b32 v44, 16, v164
    v_and_b32 v45, 0xffff0000, v164
    v_lshlrev_b32 v46, 16, v165
    v_and_b32 v47, 0xffff0000, v165
    s_waitcnt lgkmcnt(0)
    s_mul_i32 s19, s30, 56
    s_lshl_b32 s20, s12, 2
    s_add_u32 s19, s19, s20
    s_lshl_b32 s19, s19, 10
    s_add_u32 s19, s19, 16875520
    v_pk_fma_f32 v[72:73], v[114:115], v[12:13], v[72:73]
    v_pk_mul_f32 v[72:73], v[72:73], v[14:15]
    v_cvt_pk_bf16_f32 v7, v72, v73
    v_lshlrev_b32 v72, 16, v7
    v_and_b32 v73, 0xffff0000, v7
    v_pk_add_f32 v[72:73], v[72:73], v[16:17]
    v_cvt_pk_bf16_f32 v7, v72, v73
    v_lshlrev_b32 v72, 16, v7
    v_and_b32 v73, 0xffff0000, v7
    v_max_f32 v72, 0, v72
    v_max_f32 v73, 0, v73
    v_pk_mul_f32 v[72:73], v[72:73], v[72:73]
    v_cvt_pk_bf16_f32 v48, v72, v73
    v_pk_fma_f32 v[74:75], v[116:117], v[12:13], v[74:75]
    v_pk_mul_f32 v[74:75], v[74:75], v[14:15]
    v_cvt_pk_bf16_f32 v7, v74, v75
    v_lshlrev_b32 v74, 16, v7
    v_and_b32 v75, 0xffff0000, v7
    v_pk_add_f32 v[74:75], v[74:75], v[18:19]
    v_cvt_pk_bf16_f32 v7, v74, v75
    v_lshlrev_b32 v74, 16, v7
    v_and_b32 v75, 0xffff0000, v7
    v_max_f32 v74, 0, v74
    v_max_f32 v75, 0, v75
    v_pk_mul_f32 v[74:75], v[74:75], v[74:75]
    v_cvt_pk_bf16_f32 v49, v74, v75
    v_pk_fma_f32 v[76:77], v[118:119], v[12:13], v[76:77]
    v_pk_mul_f32 v[76:77], v[76:77], v[14:15]
    v_cvt_pk_bf16_f32 v7, v76, v77
    v_lshlrev_b32 v76, 16, v7
    v_and_b32 v77, 0xffff0000, v7
    v_pk_add_f32 v[76:77], v[76:77], v[20:21]
    v_cvt_pk_bf16_f32 v7, v76, v77
    v_lshlrev_b32 v76, 16, v7
    v_and_b32 v77, 0xffff0000, v7
    v_max_f32 v76, 0, v76
    v_max_f32 v77, 0, v77
    v_pk_mul_f32 v[76:77], v[76:77], v[76:77]
    v_cvt_pk_bf16_f32 v50, v76, v77
    v_pk_fma_f32 v[78:79], v[120:121], v[12:13], v[78:79]
    v_pk_mul_f32 v[78:79], v[78:79], v[14:15]
    v_cvt_pk_bf16_f32 v7, v78, v79
    v_lshlrev_b32 v78, 16, v7
    v_and_b32 v79, 0xffff0000, v7
    v_pk_add_f32 v[78:79], v[78:79], v[22:23]
    v_cvt_pk_bf16_f32 v7, v78, v79
    v_lshlrev_b32 v78, 16, v7
    v_and_b32 v79, 0xffff0000, v7
    v_max_f32 v78, 0, v78
    v_max_f32 v79, 0, v79
    v_pk_mul_f32 v[78:79], v[78:79], v[78:79]
    v_cvt_pk_bf16_f32 v51, v78, v79
    buffer_store_dwordx4 v[48:51], v1, s[8:11], s19 offen offset:0
    v_pk_fma_f32 v[80:81], v[122:123], v[12:13], v[80:81]
    v_pk_mul_f32 v[80:81], v[80:81], v[14:15]
    v_cvt_pk_bf16_f32 v7, v80, v81
    v_lshlrev_b32 v80, 16, v7
    v_and_b32 v81, 0xffff0000, v7
    v_pk_add_f32 v[80:81], v[80:81], v[24:25]
    v_cvt_pk_bf16_f32 v7, v80, v81
    v_lshlrev_b32 v80, 16, v7
    v_and_b32 v81, 0xffff0000, v7
    v_max_f32 v80, 0, v80
    v_max_f32 v81, 0, v81
    v_pk_mul_f32 v[80:81], v[80:81], v[80:81]
    v_cvt_pk_bf16_f32 v52, v80, v81
    v_pk_fma_f32 v[82:83], v[124:125], v[12:13], v[82:83]
    v_pk_mul_f32 v[82:83], v[82:83], v[14:15]
    v_cvt_pk_bf16_f32 v7, v82, v83
    v_lshlrev_b32 v82, 16, v7
    v_and_b32 v83, 0xffff0000, v7
    v_pk_add_f32 v[82:83], v[82:83], v[26:27]
    v_cvt_pk_bf16_f32 v7, v82, v83
    v_lshlrev_b32 v82, 16, v7
    v_and_b32 v83, 0xffff0000, v7
    v_max_f32 v82, 0, v82
    v_max_f32 v83, 0, v83
    v_pk_mul_f32 v[82:83], v[82:83], v[82:83]
    v_cvt_pk_bf16_f32 v53, v82, v83
    v_pk_fma_f32 v[84:85], v[126:127], v[12:13], v[84:85]
    v_pk_mul_f32 v[84:85], v[84:85], v[14:15]
    v_cvt_pk_bf16_f32 v7, v84, v85
    v_lshlrev_b32 v84, 16, v7
    v_and_b32 v85, 0xffff0000, v7
    v_pk_add_f32 v[84:85], v[84:85], v[28:29]
    v_cvt_pk_bf16_f32 v7, v84, v85
    v_lshlrev_b32 v84, 16, v7
    v_and_b32 v85, 0xffff0000, v7
    v_max_f32 v84, 0, v84
    v_max_f32 v85, 0, v85
    v_pk_mul_f32 v[84:85], v[84:85], v[84:85]
    v_cvt_pk_bf16_f32 v54, v84, v85
    v_pk_fma_f32 v[86:87], v[128:129], v[12:13], v[86:87]
    v_pk_mul_f32 v[86:87], v[86:87], v[14:15]
    v_cvt_pk_bf16_f32 v7, v86, v87
    v_lshlrev_b32 v86, 16, v7
    v_and_b32 v87, 0xffff0000, v7
    v_pk_add_f32 v[86:87], v[86:87], v[30:31]
    v_cvt_pk_bf16_f32 v7, v86, v87
    v_lshlrev_b32 v86, 16, v7
    v_and_b32 v87, 0xffff0000, v7
    v_max_f32 v86, 0, v86
    v_max_f32 v87, 0, v87
    v_pk_mul_f32 v[86:87], v[86:87], v[86:87]
    v_cvt_pk_bf16_f32 v55, v86, v87
    buffer_store_dwordx4 v[52:55], v1, s[8:11], s19 offen offset:1024
    v_pk_fma_f32 v[88:89], v[130:131], v[12:13], v[88:89]
    v_pk_mul_f32 v[88:89], v[88:89], v[14:15]
    v_cvt_pk_bf16_f32 v7, v88, v89
    v_lshlrev_b32 v88, 16, v7
    v_and_b32 v89, 0xffff0000, v7
    v_pk_add_f32 v[88:89], v[88:89], v[32:33]
    v_cvt_pk_bf16_f32 v7, v88, v89
    v_lshlrev_b32 v88, 16, v7
    v_and_b32 v89, 0xffff0000, v7
    v_max_f32 v88, 0, v88
    v_max_f32 v89, 0, v89
    v_pk_mul_f32 v[88:89], v[88:89], v[88:89]
    v_cvt_pk_bf16_f32 v48, v88, v89
    v_pk_fma_f32 v[90:91], v[132:133], v[12:13], v[90:91]
    v_pk_mul_f32 v[90:91], v[90:91], v[14:15]
    v_cvt_pk_bf16_f32 v7, v90, v91
    v_lshlrev_b32 v90, 16, v7
    v_and_b32 v91, 0xffff0000, v7
    v_pk_add_f32 v[90:91], v[90:91], v[34:35]
    v_cvt_pk_bf16_f32 v7, v90, v91
    v_lshlrev_b32 v90, 16, v7
    v_and_b32 v91, 0xffff0000, v7
    v_max_f32 v90, 0, v90
    v_max_f32 v91, 0, v91
    v_pk_mul_f32 v[90:91], v[90:91], v[90:91]
    v_cvt_pk_bf16_f32 v49, v90, v91
    v_pk_fma_f32 v[92:93], v[134:135], v[12:13], v[92:93]
    v_pk_mul_f32 v[92:93], v[92:93], v[14:15]
    v_cvt_pk_bf16_f32 v7, v92, v93
    v_lshlrev_b32 v92, 16, v7
    v_and_b32 v93, 0xffff0000, v7
    v_pk_add_f32 v[92:93], v[92:93], v[36:37]
    v_cvt_pk_bf16_f32 v7, v92, v93
    v_lshlrev_b32 v92, 16, v7
    v_and_b32 v93, 0xffff0000, v7
    v_max_f32 v92, 0, v92
    v_max_f32 v93, 0, v93
    v_pk_mul_f32 v[92:93], v[92:93], v[92:93]
    v_cvt_pk_bf16_f32 v50, v92, v93
    v_pk_fma_f32 v[94:95], v[136:137], v[12:13], v[94:95]
    v_pk_mul_f32 v[94:95], v[94:95], v[14:15]
    v_cvt_pk_bf16_f32 v7, v94, v95
    v_lshlrev_b32 v94, 16, v7
    v_and_b32 v95, 0xffff0000, v7
    v_pk_add_f32 v[94:95], v[94:95], v[38:39]
    v_cvt_pk_bf16_f32 v7, v94, v95
    v_lshlrev_b32 v94, 16, v7
    v_and_b32 v95, 0xffff0000, v7
    v_max_f32 v94, 0, v94
    v_max_f32 v95, 0, v95
    v_pk_mul_f32 v[94:95], v[94:95], v[94:95]
    v_cvt_pk_bf16_f32 v51, v94, v95
    buffer_store_dwordx4 v[48:51], v1, s[8:11], s19 offen offset:2048
    v_pk_fma_f32 v[96:97], v[138:139], v[12:13], v[96:97]
    v_pk_mul_f32 v[96:97], v[96:97], v[14:15]
    v_cvt_pk_bf16_f32 v7, v96, v97
    v_lshlrev_b32 v96, 16, v7
    v_and_b32 v97, 0xffff0000, v7
    v_pk_add_f32 v[96:97], v[96:97], v[40:41]
    v_cvt_pk_bf16_f32 v7, v96, v97
    v_lshlrev_b32 v96, 16, v7
    v_and_b32 v97, 0xffff0000, v7
    v_max_f32 v96, 0, v96
    v_max_f32 v97, 0, v97
    v_pk_mul_f32 v[96:97], v[96:97], v[96:97]
    v_cvt_pk_bf16_f32 v52, v96, v97
    v_pk_fma_f32 v[98:99], v[140:141], v[12:13], v[98:99]
    v_pk_mul_f32 v[98:99], v[98:99], v[14:15]
    v_cvt_pk_bf16_f32 v7, v98, v99
    v_lshlrev_b32 v98, 16, v7
    v_and_b32 v99, 0xffff0000, v7
    v_pk_add_f32 v[98:99], v[98:99], v[42:43]
    v_cvt_pk_bf16_f32 v7, v98, v99
    v_lshlrev_b32 v98, 16, v7
    v_and_b32 v99, 0xffff0000, v7
    v_max_f32 v98, 0, v98
    v_max_f32 v99, 0, v99
    v_pk_mul_f32 v[98:99], v[98:99], v[98:99]
    v_cvt_pk_bf16_f32 v53, v98, v99
    v_pk_fma_f32 v[100:101], v[142:143], v[12:13], v[100:101]
    v_pk_mul_f32 v[100:101], v[100:101], v[14:15]
    v_cvt_pk_bf16_f32 v7, v100, v101
    v_lshlrev_b32 v100, 16, v7
    v_and_b32 v101, 0xffff0000, v7
    v_pk_add_f32 v[100:101], v[100:101], v[44:45]
    v_cvt_pk_bf16_f32 v7, v100, v101
    v_lshlrev_b32 v100, 16, v7
    v_and_b32 v101, 0xffff0000, v7
    v_max_f32 v100, 0, v100
    v_max_f32 v101, 0, v101
    v_pk_mul_f32 v[100:101], v[100:101], v[100:101]
    v_cvt_pk_bf16_f32 v54, v100, v101
    v_pk_fma_f32 v[102:103], v[144:145], v[12:13], v[102:103]
    v_pk_mul_f32 v[102:103], v[102:103], v[14:15]
    v_cvt_pk_bf16_f32 v7, v102, v103
    v_lshlrev_b32 v102, 16, v7
    v_and_b32 v103, 0xffff0000, v7
    v_pk_add_f32 v[102:103], v[102:103], v[46:47]
    v_cvt_pk_bf16_f32 v7, v102, v103
    v_lshlrev_b32 v102, 16, v7
    v_and_b32 v103, 0xffff0000, v7
    v_max_f32 v102, 0, v102
    v_max_f32 v103, 0, v103
    v_pk_mul_f32 v[102:103], v[102:103], v[102:103]
    v_cvt_pk_bf16_f32 v55, v102, v103
    buffer_store_dwordx4 v[52:55], v1, s[8:11], s19 offen offset:3072
    s_nop 11
K3_END_15040512:
    s_endpgm
.globl ffb1_kernel
.p2align 8
.type ffb1_kernel,@function
ffb1_kernel:
    s_load_dwordx2 s[6:7], s[0:1], 64
    s_load_dwordx2 s[22:23], s[0:1], 72
    s_load_dwordx2 s[4:5], s[0:1], 88
    s_cmp_ge_u32 s2, 224
    s_cbranch_scc1 K4_END_15040512
    v_lshrrev_b32 v1, 6, v0
    v_and_b32 v0, 63, v0
    v_readfirstlane_b32 s3, v1
    v_lshlrev_b32 v1, 4, v0
    v_and_b32 v2, 15, v0
    v_lshrrev_b32 v3, 4, v0
    s_waitcnt lgkmcnt(0)
    s_mov_b32 s8, s4
    s_and_b32 s9, s5, 0xffff
    s_mov_b32 s10, 0x10000000
    s_mov_b32 s11, 0x00020000
    s_mov_b32 s24, s6
    s_and_b32 s25, s7, 0xffff
    s_mov_b32 s26, 0x380
    s_mov_b32 s27, 0x00020000
    s_mov_b32 s28, s22
    s_and_b32 s29, s23, 0xffff
    s_mov_b32 s30, 0x1c0000
    s_mov_b32 s31, 0x00020000
    s_and_b32 s14, s2, 7
    s_lshr_b32 s15, s2, 3
    s_mul_hi_u32 s16, s15, 0x24924925
    s_mul_i32 s17, s16, 7
    s_sub_u32 s12, s15, s17
    s_lshl_b32 s13, s14, 2
    s_add_u32 s13, s13, s16
    s_mul_i32 s19, s3, 14
    s_lshl_b32 s20, s12, 2
    s_add_u32 s20, s20, 0
    s_mul_i32 s20, s20, 56
    s_add_u32 s20, s20, s19
    s_lshl_b32 s20, s20, 10
    s_add_u32 s40, s20, 5308416
    s_lshl_b32 s20, s13, 2
    s_add_u32 s20, s20, 0
    s_mul_i32 s20, s20, 56
    s_add_u32 s20, s20, s19
    s_lshl_b32 s20, s20, 10
    s_add_u32 s44, s20, 16875520
    s_lshl_b32 s20, s12, 2
    s_add_u32 s20, s20, 1
    s_mul_i32 s20, s20, 56
    s_add_u32 s20, s20, s19
    s_lshl_b32 s20, s20, 10
    s_add_u32 s41, s20, 5308416
    s_lshl_b32 s20, s13, 2
    s_add_u32 s20, s20, 1
    s_mul_i32 s20, s20, 56
    s_add_u32 s20, s20, s19
    s_lshl_b32 s20, s20, 10
    s_add_u32 s45, s20, 16875520
    s_lshl_b32 s20, s12, 2
    s_add_u32 s20, s20, 2
    s_mul_i32 s20, s20, 56
    s_add_u32 s20, s20, s19
    s_lshl_b32 s20, s20, 10
    s_add_u32 s42, s20, 5308416
    s_lshl_b32 s20, s13, 2
    s_add_u32 s20, s20, 2
    s_mul_i32 s20, s20, 56
    s_add_u32 s20, s20, s19
    s_lshl_b32 s20, s20, 10
    s_add_u32 s46, s20, 16875520
    s_lshl_b32 s20, s12, 2
    s_add_u32 s20, s20, 3
    s_mul_i32 s20, s20, 56
    s_add_u32 s20, s20, s19
    s_lshl_b32 s20, s20, 10
    s_add_u32 s43, s20, 5308416
    s_lshl_b32 s20, s13, 2
    s_add_u32 s20, s20, 3
    s_mul_i32 s20, s20, 56
    s_add_u32 s20, s20, s19
    s_lshl_b32 s20, s20, 10
    s_add_u32 s47, s20, 16875520
    buffer_load_dwordx4 v[16:19], v1, s[8:11], s40 offen
    buffer_load_dwordx4 v[20:23], v1, s[8:11], s41 offen
    buffer_load_dwordx4 v[24:27], v1, s[8:11], s42 offen
    buffer_load_dwordx4 v[28:31], v1, s[8:11], s43 offen
    buffer_load_dwordx4 v[32:35], v1, s[8:11], s44 offen
    buffer_load_dwordx4 v[36:39], v1, s[8:11], s45 offen
    buffer_load_dwordx4 v[40:43], v1, s[8:11], s46 offen
    buffer_load_dwordx4 v[44:47], v1, s[8:11], s47 offen
    s_add_u32 s40, s40, 1024
    s_add_u32 s41, s41, 1024
    s_add_u32 s42, s42, 1024
    s_add_u32 s43, s43, 1024
    s_add_u32 s44, s44, 1024
    s_add_u32 s45, s45, 1024
    s_add_u32 s46, s46, 1024
    s_add_u32 s47, s47, 1024
    buffer_load_dwordx4 v[48:51], v1, s[8:11], s40 offen
    buffer_load_dwordx4 v[52:55], v1, s[8:11], s41 offen
    buffer_load_dwordx4 v[56:59], v1, s[8:11], s42 offen
    buffer_load_dwordx4 v[60:63], v1, s[8:11], s43 offen
    buffer_load_dwordx4 v[64:67], v1, s[8:11], s44 offen
    buffer_load_dwordx4 v[68:71], v1, s[8:11], s45 offen
    buffer_load_dwordx4 v[72:75], v1, s[8:11], s46 offen
    buffer_load_dwordx4 v[76:79], v1, s[8:11], s47 offen
    s_add_u32 s40, s40, 1024
    s_add_u32 s41, s41, 1024
    s_add_u32 s42, s42, 1024
    s_add_u32 s43, s43, 1024
    s_add_u32 s44, s44, 1024
    s_add_u32 s45, s45, 1024
    s_add_u32 s46, s46, 1024
    s_add_u32 s47, s47, 1024
    buffer_load_dwordx4 v[80:83], v1, s[8:11], s40 offen
    buffer_load_dwordx4 v[84:87], v1, s[8:11], s41 offen
    buffer_load_dwordx4 v[88:91], v1, s[8:11], s42 offen
    buffer_load_dwordx4 v[92:95], v1, s[8:11], s43 offen
    buffer_load_dwordx4 v[96:99], v1, s[8:11], s44 offen
    buffer_load_dwordx4 v[100:103], v1, s[8:11], s45 offen
    buffer_load_dwordx4 v[104:107], v1, s[8:11], s46 offen
    buffer_load_dwordx4 v[108:111], v1, s[8:11], s47 offen
    s_add_u32 s40, s40, 1024
    s_add_u32 s41, s41, 1024
    s_add_u32 s42, s42, 1024
    s_add_u32 s43, s43, 1024
    s_add_u32 s44, s44, 1024
    s_add_u32 s45, s45, 1024
    s_add_u32 s46, s46, 1024
    s_add_u32 s47, s47, 1024
    buffer_load_dwordx4 v[112:115], v1, s[8:11], s40 offen
    buffer_load_dwordx4 v[116:119], v1, s[8:11], s41 offen
    buffer_load_dwordx4 v[120:123], v1, s[8:11], s42 offen
    buffer_load_dwordx4 v[124:127], v1, s[8:11], s43 offen
    buffer_load_dwordx4 v[128:131], v1, s[8:11], s44 offen
    buffer_load_dwordx4 v[132:135], v1, s[8:11], s45 offen
    buffer_load_dwordx4 v[136:139], v1, s[8:11], s46 offen
    buffer_load_dwordx4 v[140:143], v1, s[8:11], s47 offen
    s_add_u32 s40, s40, 1024
    s_add_u32 s41, s41, 1024
    s_add_u32 s42, s42, 1024
    s_add_u32 s43, s43, 1024
    s_add_u32 s44, s44, 1024
    s_add_u32 s45, s45, 1024
    s_add_u32 s46, s46, 1024
    s_add_u32 s47, s47, 1024
    buffer_load_dwordx4 v[144:147], v1, s[8:11], s40 offen
    buffer_load_dwordx4 v[148:151], v1, s[8:11], s41 offen
    buffer_load_dwordx4 v[152:155], v1, s[8:11], s42 offen
    buffer_load_dwordx4 v[156:159], v1, s[8:11], s43 offen
    buffer_load_dwordx4 v[160:163], v1, s[8:11], s44 offen
    buffer_load_dwordx4 v[164:167], v1, s[8:11], s45 offen
    buffer_load_dwordx4 v[168:171], v1, s[8:11], s46 offen
    buffer_load_dwordx4 v[172:175], v1, s[8:11], s47 offen
    s_add_u32 s40, s40, 1024
    s_add_u32 s41, s41, 1024
    s_add_u32 s42, s42, 1024
    s_add_u32 s43, s43, 1024
    s_add_u32 s44, s44, 1024
    s_add_u32 s45, s45, 1024
    s_add_u32 s46, s46, 1024
    s_add_u32 s47, s47, 1024
    buffer_load_dwordx4 v[176:179], v1, s[8:11], s40 offen
    buffer_load_dwordx4 v[180:183], v1, s[8:11], s41 offen
    buffer_load_dwordx4 v[184:187], v1, s[8:11], s42 offen
    buffer_load_dwordx4 v[188:191], v1, s[8:11], s43 offen
    buffer_load_dwordx4 v[192:195], v1, s[8:11], s44 offen
    buffer_load_dwordx4 v[196:199], v1, s[8:11], s45 offen
    buffer_load_dwordx4 v[200:203], v1, s[8:11], s46 offen
    buffer_load_dwordx4 v[204:207], v1, s[8:11], s47 offen
    s_add_u32 s40, s40, 1024
    s_add_u32 s41, s41, 1024
    s_add_u32 s42, s42, 1024
    s_add_u32 s43, s43, 1024
    s_add_u32 s44, s44, 1024
    s_add_u32 s45, s45, 1024
    s_add_u32 s46, s46, 1024
    s_add_u32 s47, s47, 1024
    s_waitcnt vmcnt(40)
    v_mfma_f32_16x16x32_bf16 a[0:3], v[16:19], v[32:35], 0
    v_mfma_f32_16x16x32_bf16 a[4:7], v[16:19], v[36:39], 0
    v_mfma_f32_16x16x32_bf16 a[8:11], v[16:19], v[40:43], 0
    v_mfma_f32_16x16x32_bf16 a[12:15], v[16:19], v[44:47], 0
    v_mfma_f32_16x16x32_bf16 a[16:19], v[20:23], v[32:35], 0
    v_mfma_f32_16x16x32_bf16 a[20:23], v[20:23], v[36:39], 0
    v_mfma_f32_16x16x32_bf16 a[24:27], v[20:23], v[40:43], 0
    v_mfma_f32_16x16x32_bf16 a[28:31], v[20:23], v[44:47], 0
    v_mfma_f32_16x16x32_bf16 a[32:35], v[24:27], v[32:35], 0
    v_mfma_f32_16x16x32_bf16 a[36:39], v[24:27], v[36:39], 0
    v_mfma_f32_16x16x32_bf16 a[40:43], v[24:27], v[40:43], 0
    v_mfma_f32_16x16x32_bf16 a[44:47], v[24:27], v[44:47], 0
    v_mfma_f32_16x16x32_bf16 a[48:51], v[28:31], v[32:35], 0
    v_mfma_f32_16x16x32_bf16 a[52:55], v[28:31], v[36:39], 0
    v_mfma_f32_16x16x32_bf16 a[56:59], v[28:31], v[40:43], 0
    v_mfma_f32_16x16x32_bf16 a[60:63], v[28:31], v[44:47], 0
    buffer_load_dwordx4 v[16:19], v1, s[8:11], s40 offen
    buffer_load_dwordx4 v[20:23], v1, s[8:11], s41 offen
    buffer_load_dwordx4 v[24:27], v1, s[8:11], s42 offen
    buffer_load_dwordx4 v[28:31], v1, s[8:11], s43 offen
    buffer_load_dwordx4 v[32:35], v1, s[8:11], s44 offen
    buffer_load_dwordx4 v[36:39], v1, s[8:11], s45 offen
    buffer_load_dwordx4 v[40:43], v1, s[8:11], s46 offen
    buffer_load_dwordx4 v[44:47], v1, s[8:11], s47 offen
    s_add_u32 s40, s40, 1024
    s_add_u32 s41, s41, 1024
    s_add_u32 s42, s42, 1024
    s_add_u32 s43, s43, 1024
    s_add_u32 s44, s44, 1024
    s_add_u32 s45, s45, 1024
    s_add_u32 s46, s46, 1024
    s_add_u32 s47, s47, 1024
    s_waitcnt vmcnt(40)
    v_mfma_f32_16x16x32_bf16 a[0:3], v[48:51], v[64:67], a[0:3]
    v_mfma_f32_16x16x32_bf16 a[4:7], v[48:51], v[68:71], a[4:7]
    v_mfma_f32_16x16x32_bf16 a[8:11], v[48:51], v[72:75], a[8:11]
    v_mfma_f32_16x16x32_bf16 a[12:15], v[48:51], v[76:79], a[12:15]
    v_mfma_f32_16x16x32_bf16 a[16:19], v[52:55], v[64:67], a[16:19]
    v_mfma_f32_16x16x32_bf16 a[20:23], v[52:55], v[68:71], a[20:23]
    v_mfma_f32_16x16x32_bf16 a[24:27], v[52:55], v[72:75], a[24:27]
    v_mfma_f32_16x16x32_bf16 a[28:31], v[52:55], v[76:79], a[28:31]
    v_mfma_f32_16x16x32_bf16 a[32:35], v[56:59], v[64:67], a[32:35]
    v_mfma_f32_16x16x32_bf16 a[36:39], v[56:59], v[68:71], a[36:39]
    v_mfma_f32_16x16x32_bf16 a[40:43], v[56:59], v[72:75], a[40:43]
    v_mfma_f32_16x16x32_bf16 a[44:47], v[56:59], v[76:79], a[44:47]
    v_mfma_f32_16x16x32_bf16 a[48:51], v[60:63], v[64:67], a[48:51]
    v_mfma_f32_16x16x32_bf16 a[52:55], v[60:63], v[68:71], a[52:55]
    v_mfma_f32_16x16x32_bf16 a[56:59], v[60:63], v[72:75], a[56:59]
    v_mfma_f32_16x16x32_bf16 a[60:63], v[60:63], v[76:79], a[60:63]
    buffer_load_dwordx4 v[48:51], v1, s[8:11], s40 offen
    buffer_load_dwordx4 v[52:55], v1, s[8:11], s41 offen
    buffer_load_dwordx4 v[56:59], v1, s[8:11], s42 offen
    buffer_load_dwordx4 v[60:63], v1, s[8:11], s43 offen
    buffer_load_dwordx4 v[64:67], v1, s[8:11], s44 offen
    buffer_load_dwordx4 v[68:71], v1, s[8:11], s45 offen
    buffer_load_dwordx4 v[72:75], v1, s[8:11], s46 offen
    buffer_load_dwordx4 v[76:79], v1, s[8:11], s47 offen
    s_add_u32 s40, s40, 1024
    s_add_u32 s41, s41, 1024
    s_add_u32 s42, s42, 1024
    s_add_u32 s43, s43, 1024
    s_add_u32 s44, s44, 1024
    s_add_u32 s45, s45, 1024
    s_add_u32 s46, s46, 1024
    s_add_u32 s47, s47, 1024
    s_waitcnt vmcnt(40)
    v_mfma_f32_16x16x32_bf16 a[0:3], v[80:83], v[96:99], a[0:3]
    v_mfma_f32_16x16x32_bf16 a[4:7], v[80:83], v[100:103], a[4:7]
    v_mfma_f32_16x16x32_bf16 a[8:11], v[80:83], v[104:107], a[8:11]
    v_mfma_f32_16x16x32_bf16 a[12:15], v[80:83], v[108:111], a[12:15]
    v_mfma_f32_16x16x32_bf16 a[16:19], v[84:87], v[96:99], a[16:19]
    v_mfma_f32_16x16x32_bf16 a[20:23], v[84:87], v[100:103], a[20:23]
    v_mfma_f32_16x16x32_bf16 a[24:27], v[84:87], v[104:107], a[24:27]
    v_mfma_f32_16x16x32_bf16 a[28:31], v[84:87], v[108:111], a[28:31]
    v_mfma_f32_16x16x32_bf16 a[32:35], v[88:91], v[96:99], a[32:35]
    v_mfma_f32_16x16x32_bf16 a[36:39], v[88:91], v[100:103], a[36:39]
    v_mfma_f32_16x16x32_bf16 a[40:43], v[88:91], v[104:107], a[40:43]
    v_mfma_f32_16x16x32_bf16 a[44:47], v[88:91], v[108:111], a[44:47]
    v_mfma_f32_16x16x32_bf16 a[48:51], v[92:95], v[96:99], a[48:51]
    v_mfma_f32_16x16x32_bf16 a[52:55], v[92:95], v[100:103], a[52:55]
    v_mfma_f32_16x16x32_bf16 a[56:59], v[92:95], v[104:107], a[56:59]
    v_mfma_f32_16x16x32_bf16 a[60:63], v[92:95], v[108:111], a[60:63]
    buffer_load_dwordx4 v[80:83], v1, s[8:11], s40 offen
    buffer_load_dwordx4 v[84:87], v1, s[8:11], s41 offen
    buffer_load_dwordx4 v[88:91], v1, s[8:11], s42 offen
    buffer_load_dwordx4 v[92:95], v1, s[8:11], s43 offen
    buffer_load_dwordx4 v[96:99], v1, s[8:11], s44 offen
    buffer_load_dwordx4 v[100:103], v1, s[8:11], s45 offen
    buffer_load_dwordx4 v[104:107], v1, s[8:11], s46 offen
    buffer_load_dwordx4 v[108:111], v1, s[8:11], s47 offen
    s_add_u32 s40, s40, 1024
    s_add_u32 s41, s41, 1024
    s_add_u32 s42, s42, 1024
    s_add_u32 s43, s43, 1024
    s_add_u32 s44, s44, 1024
    s_add_u32 s45, s45, 1024
    s_add_u32 s46, s46, 1024
    s_add_u32 s47, s47, 1024
    s_waitcnt vmcnt(40)
    v_mfma_f32_16x16x32_bf16 a[0:3], v[112:115], v[128:131], a[0:3]
    v_mfma_f32_16x16x32_bf16 a[4:7], v[112:115], v[132:135], a[4:7]
    v_mfma_f32_16x16x32_bf16 a[8:11], v[112:115], v[136:139], a[8:11]
    v_mfma_f32_16x16x32_bf16 a[12:15], v[112:115], v[140:143], a[12:15]
    v_mfma_f32_16x16x32_bf16 a[16:19], v[116:119], v[128:131], a[16:19]
    v_mfma_f32_16x16x32_bf16 a[20:23], v[116:119], v[132:135], a[20:23]
    v_mfma_f32_16x16x32_bf16 a[24:27], v[116:119], v[136:139], a[24:27]
    v_mfma_f32_16x16x32_bf16 a[28:31], v[116:119], v[140:143], a[28:31]
    v_mfma_f32_16x16x32_bf16 a[32:35], v[120:123], v[128:131], a[32:35]
    v_mfma_f32_16x16x32_bf16 a[36:39], v[120:123], v[132:135], a[36:39]
    v_mfma_f32_16x16x32_bf16 a[40:43], v[120:123], v[136:139], a[40:43]
    v_mfma_f32_16x16x32_bf16 a[44:47], v[120:123], v[140:143], a[44:47]
    v_mfma_f32_16x16x32_bf16 a[48:51], v[124:127], v[128:131], a[48:51]
    v_mfma_f32_16x16x32_bf16 a[52:55], v[124:127], v[132:135], a[52:55]
    v_mfma_f32_16x16x32_bf16 a[56:59], v[124:127], v[136:139], a[56:59]
    v_mfma_f32_16x16x32_bf16 a[60:63], v[124:127], v[140:143], a[60:63]
    buffer_load_dwordx4 v[112:115], v1, s[8:11], s40 offen
    buffer_load_dwordx4 v[116:119], v1, s[8:11], s41 offen
    buffer_load_dwordx4 v[120:123], v1, s[8:11], s42 offen
    buffer_load_dwordx4 v[124:127], v1, s[8:11], s43 offen
    buffer_load_dwordx4 v[128:131], v1, s[8:11], s44 offen
    buffer_load_dwordx4 v[132:135], v1, s[8:11], s45 offen
    buffer_load_dwordx4 v[136:139], v1, s[8:11], s46 offen
    buffer_load_dwordx4 v[140:143], v1, s[8:11], s47 offen
    s_add_u32 s40, s40, 1024
    s_add_u32 s41, s41, 1024
    s_add_u32 s42, s42, 1024
    s_add_u32 s43, s43, 1024
    s_add_u32 s44, s44, 1024
    s_add_u32 s45, s45, 1024
    s_add_u32 s46, s46, 1024
    s_add_u32 s47, s47, 1024
    s_waitcnt vmcnt(40)
    v_mfma_f32_16x16x32_bf16 a[0:3], v[144:147], v[160:163], a[0:3]
    v_mfma_f32_16x16x32_bf16 a[4:7], v[144:147], v[164:167], a[4:7]
    v_mfma_f32_16x16x32_bf16 a[8:11], v[144:147], v[168:171], a[8:11]
    v_mfma_f32_16x16x32_bf16 a[12:15], v[144:147], v[172:175], a[12:15]
    v_mfma_f32_16x16x32_bf16 a[16:19], v[148:151], v[160:163], a[16:19]
    v_mfma_f32_16x16x32_bf16 a[20:23], v[148:151], v[164:167], a[20:23]
    v_mfma_f32_16x16x32_bf16 a[24:27], v[148:151], v[168:171], a[24:27]
    v_mfma_f32_16x16x32_bf16 a[28:31], v[148:151], v[172:175], a[28:31]
    v_mfma_f32_16x16x32_bf16 a[32:35], v[152:155], v[160:163], a[32:35]
    v_mfma_f32_16x16x32_bf16 a[36:39], v[152:155], v[164:167], a[36:39]
    v_mfma_f32_16x16x32_bf16 a[40:43], v[152:155], v[168:171], a[40:43]
    v_mfma_f32_16x16x32_bf16 a[44:47], v[152:155], v[172:175], a[44:47]
    v_mfma_f32_16x16x32_bf16 a[48:51], v[156:159], v[160:163], a[48:51]
    v_mfma_f32_16x16x32_bf16 a[52:55], v[156:159], v[164:167], a[52:55]
    v_mfma_f32_16x16x32_bf16 a[56:59], v[156:159], v[168:171], a[56:59]
    v_mfma_f32_16x16x32_bf16 a[60:63], v[156:159], v[172:175], a[60:63]
    buffer_load_dwordx4 v[144:147], v1, s[8:11], s40 offen
    buffer_load_dwordx4 v[148:151], v1, s[8:11], s41 offen
    buffer_load_dwordx4 v[152:155], v1, s[8:11], s42 offen
    buffer_load_dwordx4 v[156:159], v1, s[8:11], s43 offen
    buffer_load_dwordx4 v[160:163], v1, s[8:11], s44 offen
    buffer_load_dwordx4 v[164:167], v1, s[8:11], s45 offen
    buffer_load_dwordx4 v[168:171], v1, s[8:11], s46 offen
    buffer_load_dwordx4 v[172:175], v1, s[8:11], s47 offen
    s_add_u32 s40, s40, 1024
    s_add_u32 s41, s41, 1024
    s_add_u32 s42, s42, 1024
    s_add_u32 s43, s43, 1024
    s_add_u32 s44, s44, 1024
    s_add_u32 s45, s45, 1024
    s_add_u32 s46, s46, 1024
    s_add_u32 s47, s47, 1024
    s_waitcnt vmcnt(40)
    v_mfma_f32_16x16x32_bf16 a[0:3], v[176:179], v[192:195], a[0:3]
    v_mfma_f32_16x16x32_bf16 a[4:7], v[176:179], v[196:199], a[4:7]
    v_mfma_f32_16x16x32_bf16 a[8:11], v[176:179], v[200:203], a[8:11]
    v_mfma_f32_16x16x32_bf16 a[12:15], v[176:179], v[204:207], a[12:15]
    v_mfma_f32_16x16x32_bf16 a[16:19], v[180:183], v[192:195], a[16:19]
    v_mfma_f32_16x16x32_bf16 a[20:23], v[180:183], v[196:199], a[20:23]
    v_mfma_f32_16x16x32_bf16 a[24:27], v[180:183], v[200:203], a[24:27]
    v_mfma_f32_16x16x32_bf16 a[28:31], v[180:183], v[204:207], a[28:31]
    v_mfma_f32_16x16x32_bf16 a[32:35], v[184:187], v[192:195], a[32:35]
    v_mfma_f32_16x16x32_bf16 a[36:39], v[184:187], v[196:199], a[36:39]
    v_mfma_f32_16x16x32_bf16 a[40:43], v[184:187], v[200:203], a[40:43]
    v_mfma_f32_16x16x32_bf16 a[44:47], v[184:187], v[204:207], a[44:47]
    v_mfma_f32_16x16x32_bf16 a[48:51], v[188:191], v[192:195], a[48:51]
    v_mfma_f32_16x16x32_bf16 a[52:55], v[188:191], v[196:199], a[52:55]
    v_mfma_f32_16x16x32_bf16 a[56:59], v[188:191], v[200:203], a[56:59]
    v_mfma_f32_16x16x32_bf16 a[60:63], v[188:191], v[204:207], a[60:63]
    buffer_load_dwordx4 v[176:179], v1, s[8:11], s40 offen
    buffer_load_dwordx4 v[180:183], v1, s[8:11], s41 offen
    buffer_load_dwordx4 v[184:187], v1, s[8:11], s42 offen
    buffer_load_dwordx4 v[188:191], v1, s[8:11], s43 offen
    buffer_load_dwordx4 v[192:195], v1, s[8:11], s44 offen
    buffer_load_dwordx4 v[196:199], v1, s[8:11], s45 offen
    buffer_load_dwordx4 v[200:203], v1, s[8:11], s46 offen
    buffer_load_dwordx4 v[204:207], v1, s[8:11], s47 offen
    s_add_u32 s40, s40, 1024
    s_add_u32 s41, s41, 1024
    s_add_u32 s42, s42, 1024
    s_add_u32 s43, s43, 1024
    s_add_u32 s44, s44, 1024
    s_add_u32 s45, s45, 1024
    s_add_u32 s46, s46, 1024
    s_add_u32 s47, s47, 1024
    s_waitcnt vmcnt(40)
    v_mfma_f32_16x16x32_bf16 a[0:3], v[16:19], v[32:35], a[0:3]
    v_mfma_f32_16x16x32_bf16 a[4:7], v[16:19], v[36:39], a[4:7]
    v_mfma_f32_16x16x32_bf16 a[8:11], v[16:19], v[40:43], a[8:11]
    v_mfma_f32_16x16x32_bf16 a[12:15], v[16:19], v[44:47], a[12:15]
    v_mfma_f32_16x16x32_bf16 a[16:19], v[20:23], v[32:35], a[16:19]
    v_mfma_f32_16x16x32_bf16 a[20:23], v[20:23], v[36:39], a[20:23]
    v_mfma_f32_16x16x32_bf16 a[24:27], v[20:23], v[40:43], a[24:27]
    v_mfma_f32_16x16x32_bf16 a[28:31], v[20:23], v[44:47], a[28:31]
    v_mfma_f32_16x16x32_bf16 a[32:35], v[24:27], v[32:35], a[32:35]
    v_mfma_f32_16x16x32_bf16 a[36:39], v[24:27], v[36:39], a[36:39]
    v_mfma_f32_16x16x32_bf16 a[40:43], v[24:27], v[40:43], a[40:43]
    v_mfma_f32_16x16x32_bf16 a[44:47], v[24:27], v[44:47], a[44:47]
    v_mfma_f32_16x16x32_bf16 a[48:51], v[28:31], v[32:35], a[48:51]
    v_mfma_f32_16x16x32_bf16 a[52:55], v[28:31], v[36:39], a[52:55]
    v_mfma_f32_16x16x32_bf16 a[56:59], v[28:31], v[40:43], a[56:59]
    v_mfma_f32_16x16x32_bf16 a[60:63], v[28:31], v[44:47], a[60:63]
    buffer_load_dwordx4 v[16:19], v1, s[8:11], s40 offen
    buffer_load_dwordx4 v[20:23], v1, s[8:11], s41 offen
    buffer_load_dwordx4 v[24:27], v1, s[8:11], s42 offen
    buffer_load_dwordx4 v[28:31], v1, s[8:11], s43 offen
    buffer_load_dwordx4 v[32:35], v1, s[8:11], s44 offen
    buffer_load_dwordx4 v[36:39], v1, s[8:11], s45 offen
    buffer_load_dwordx4 v[40:43], v1, s[8:11], s46 offen
    buffer_load_dwordx4 v[44:47], v1, s[8:11], s47 offen
    s_add_u32 s40, s40, 1024
    s_add_u32 s41, s41, 1024
    s_add_u32 s42, s42, 1024
    s_add_u32 s43, s43, 1024
    s_add_u32 s44, s44, 1024
    s_add_u32 s45, s45, 1024
    s_add_u32 s46, s46, 1024
    s_add_u32 s47, s47, 1024
    s_waitcnt vmcnt(40)
    v_mfma_f32_16x16x32_bf16 a[0:3], v[48:51], v[64:67], a[0:3]
    v_mfma_f32_16x16x32_bf16 a[4:7], v[48:51], v[68:71], a[4:7]
    v_mfma_f32_16x16x32_bf16 a[8:11], v[48:51], v[72:75], a[8:11]
    v_mfma_f32_16x16x32_bf16 a[12:15], v[48:51], v[76:79], a[12:15]
    v_mfma_f32_16x16x32_bf16 a[16:19], v[52:55], v[64:67], a[16:19]
    v_mfma_f32_16x16x32_bf16 a[20:23], v[52:55], v[68:71], a[20:23]
    v_mfma_f32_16x16x32_bf16 a[24:27], v[52:55], v[72:75], a[24:27]
    v_mfma_f32_16x16x32_bf16 a[28:31], v[52:55], v[76:79], a[28:31]
    v_mfma_f32_16x16x32_bf16 a[32:35], v[56:59], v[64:67], a[32:35]
    v_mfma_f32_16x16x32_bf16 a[36:39], v[56:59], v[68:71], a[36:39]
    v_mfma_f32_16x16x32_bf16 a[40:43], v[56:59], v[72:75], a[40:43]
    v_mfma_f32_16x16x32_bf16 a[44:47], v[56:59], v[76:79], a[44:47]
    v_mfma_f32_16x16x32_bf16 a[48:51], v[60:63], v[64:67], a[48:51]
    v_mfma_f32_16x16x32_bf16 a[52:55], v[60:63], v[68:71], a[52:55]
    v_mfma_f32_16x16x32_bf16 a[56:59], v[60:63], v[72:75], a[56:59]
    v_mfma_f32_16x16x32_bf16 a[60:63], v[60:63], v[76:79], a[60:63]
    buffer_load_dwordx4 v[48:51], v1, s[8:11], s40 offen
    buffer_load_dwordx4 v[52:55], v1, s[8:11], s41 offen
    buffer_load_dwordx4 v[56:59], v1, s[8:11], s42 offen
    buffer_load_dwordx4 v[60:63], v1, s[8:11], s43 offen
    buffer_load_dwordx4 v[64:67], v1, s[8:11], s44 offen
    buffer_load_dwordx4 v[68:71], v1, s[8:11], s45 offen
    buffer_load_dwordx4 v[72:75], v1, s[8:11], s46 offen
    buffer_load_dwordx4 v[76:79], v1, s[8:11], s47 offen
    s_add_u32 s40, s40, 1024
    s_add_u32 s41, s41, 1024
    s_add_u32 s42, s42, 1024
    s_add_u32 s43, s43, 1024
    s_add_u32 s44, s44, 1024
    s_add_u32 s45, s45, 1024
    s_add_u32 s46, s46, 1024
    s_add_u32 s47, s47, 1024
    s_waitcnt vmcnt(40)
    v_mfma_f32_16x16x32_bf16 a[0:3], v[80:83], v[96:99], a[0:3]
    v_mfma_f32_16x16x32_bf16 a[4:7], v[80:83], v[100:103], a[4:7]
    v_mfma_f32_16x16x32_bf16 a[8:11], v[80:83], v[104:107], a[8:11]
    v_mfma_f32_16x16x32_bf16 a[12:15], v[80:83], v[108:111], a[12:15]
    v_mfma_f32_16x16x32_bf16 a[16:19], v[84:87], v[96:99], a[16:19]
    v_mfma_f32_16x16x32_bf16 a[20:23], v[84:87], v[100:103], a[20:23]
    v_mfma_f32_16x16x32_bf16 a[24:27], v[84:87], v[104:107], a[24:27]
    v_mfma_f32_16x16x32_bf16 a[28:31], v[84:87], v[108:111], a[28:31]
    v_mfma_f32_16x16x32_bf16 a[32:35], v[88:91], v[96:99], a[32:35]
    v_mfma_f32_16x16x32_bf16 a[36:39], v[88:91], v[100:103], a[36:39]
    v_mfma_f32_16x16x32_bf16 a[40:43], v[88:91], v[104:107], a[40:43]
    v_mfma_f32_16x16x32_bf16 a[44:47], v[88:91], v[108:111], a[44:47]
    v_mfma_f32_16x16x32_bf16 a[48:51], v[92:95], v[96:99], a[48:51]
    v_mfma_f32_16x16x32_bf16 a[52:55], v[92:95], v[100:103], a[52:55]
    v_mfma_f32_16x16x32_bf16 a[56:59], v[92:95], v[104:107], a[56:59]
    v_mfma_f32_16x16x32_bf16 a[60:63], v[92:95], v[108:111], a[60:63]
    s_waitcnt vmcnt(32)
    v_mfma_f32_16x16x32_bf16 a[0:3], v[112:115], v[128:131], a[0:3]
    v_mfma_f32_16x16x32_bf16 a[4:7], v[112:115], v[132:135], a[4:7]
    v_mfma_f32_16x16x32_bf16 a[8:11], v[112:115], v[136:139], a[8:11]
    v_mfma_f32_16x16x32_bf16 a[12:15], v[112:115], v[140:143], a[12:15]
    v_mfma_f32_16x16x32_bf16 a[16:19], v[116:119], v[128:131], a[16:19]
    v_mfma_f32_16x16x32_bf16 a[20:23], v[116:119], v[132:135], a[20:23]
    v_mfma_f32_16x16x32_bf16 a[24:27], v[116:119], v[136:139], a[24:27]
    v_mfma_f32_16x16x32_bf16 a[28:31], v[116:119], v[140:143], a[28:31]
    v_mfma_f32_16x16x32_bf16 a[32:35], v[120:123], v[128:131], a[32:35]
    v_mfma_f32_16x16x32_bf16 a[36:39], v[120:123], v[132:135], a[36:39]
    v_mfma_f32_16x16x32_bf16 a[40:43], v[120:123], v[136:139], a[40:43]
    v_mfma_f32_16x16x32_bf16 a[44:47], v[120:123], v[140:143], a[44:47]
    v_mfma_f32_16x16x32_bf16 a[48:51], v[124:127], v[128:131], a[48:51]
    v_mfma_f32_16x16x32_bf16 a[52:55], v[124:127], v[132:135], a[52:55]
    v_mfma_f32_16x16x32_bf16 a[56:59], v[124:127], v[136:139], a[56:59]
    v_mfma_f32_16x16x32_bf16 a[60:63], v[124:127], v[140:143], a[60:63]
    s_waitcnt vmcnt(24)
    v_mfma_f32_16x16x32_bf16 a[0:3], v[144:147], v[160:163], a[0:3]
    v_mfma_f32_16x16x32_bf16 a[4:7], v[144:147], v[164:167], a[4:7]
    v_mfma_f32_16x16x32_bf16 a[8:11], v[144:147], v[168:171], a[8:11]
    v_mfma_f32_16x16x32_bf16 a[12:15], v[144:147], v[172:175], a[12:15]
    v_mfma_f32_16x16x32_bf16 a[16:19], v[148:151], v[160:163], a[16:19]
    v_mfma_f32_16x16x32_bf16 a[20:23], v[148:151], v[164:167], a[20:23]
    v_mfma_f32_16x16x32_bf16 a[24:27], v[148:151], v[168:171], a[24:27]
    v_mfma_f32_16x16x32_bf16 a[28:31], v[148:151], v[172:175], a[28:31]
    v_mfma_f32_16x16x32_bf16 a[32:35], v[152:155], v[160:163], a[32:35]
    v_mfma_f32_16x16x32_bf16 a[36:39], v[152:155], v[164:167], a[36:39]
    v_mfma_f32_16x16x32_bf16 a[40:43], v[152:155], v[168:171], a[40:43]
    v_mfma_f32_16x16x32_bf16 a[44:47], v[152:155], v[172:175], a[44:47]
    v_mfma_f32_16x16x32_bf16 a[48:51], v[156:159], v[160:163], a[48:51]
    v_mfma_f32_16x16x32_bf16 a[52:55], v[156:159], v[164:167], a[52:55]
    v_mfma_f32_16x16x32_bf16 a[56:59], v[156:159], v[168:171], a[56:59]
    v_mfma_f32_16x16x32_bf16 a[60:63], v[156:159], v[172:175], a[60:63]
    s_waitcnt vmcnt(16)
    v_mfma_f32_16x16x32_bf16 a[0:3], v[176:179], v[192:195], a[0:3]
    v_mfma_f32_16x16x32_bf16 a[4:7], v[176:179], v[196:199], a[4:7]
    v_mfma_f32_16x16x32_bf16 a[8:11], v[176:179], v[200:203], a[8:11]
    v_mfma_f32_16x16x32_bf16 a[12:15], v[176:179], v[204:207], a[12:15]
    v_mfma_f32_16x16x32_bf16 a[16:19], v[180:183], v[192:195], a[16:19]
    v_mfma_f32_16x16x32_bf16 a[20:23], v[180:183], v[196:199], a[20:23]
    v_mfma_f32_16x16x32_bf16 a[24:27], v[180:183], v[200:203], a[24:27]
    v_mfma_f32_16x16x32_bf16 a[28:31], v[180:183], v[204:207], a[28:31]
    v_mfma_f32_16x16x32_bf16 a[32:35], v[184:187], v[192:195], a[32:35]
    v_mfma_f32_16x16x32_bf16 a[36:39], v[184:187], v[196:199], a[36:39]
    v_mfma_f32_16x16x32_bf16 a[40:43], v[184:187], v[200:203], a[40:43]
    v_mfma_f32_16x16x32_bf16 a[44:47], v[184:187], v[204:207], a[44:47]
    v_mfma_f32_16x16x32_bf16 a[48:51], v[188:191], v[192:195], a[48:51]
    v_mfma_f32_16x16x32_bf16 a[52:55], v[188:191], v[196:199], a[52:55]
    v_mfma_f32_16x16x32_bf16 a[56:59], v[188:191], v[200:203], a[56:59]
    v_mfma_f32_16x16x32_bf16 a[60:63], v[188:191], v[204:207], a[60:63]
    s_waitcnt vmcnt(8)
    v_mfma_f32_16x16x32_bf16 a[0:3], v[16:19], v[32:35], a[0:3]
    v_mfma_f32_16x16x32_bf16 a[4:7], v[16:19], v[36:39], a[4:7]
    v_mfma_f32_16x16x32_bf16 a[8:11], v[16:19], v[40:43], a[8:11]
    v_mfma_f32_16x16x32_bf16 a[12:15], v[16:19], v[44:47], a[12:15]
    v_mfma_f32_16x16x32_bf16 a[16:19], v[20:23], v[32:35], a[16:19]
    v_mfma_f32_16x16x32_bf16 a[20:23], v[20:23], v[36:39], a[20:23]
    v_mfma_f32_16x16x32_bf16 a[24:27], v[20:23], v[40:43], a[24:27]
    v_mfma_f32_16x16x32_bf16 a[28:31], v[20:23], v[44:47], a[28:31]
    v_mfma_f32_16x16x32_bf16 a[32:35], v[24:27], v[32:35], a[32:35]
    v_mfma_f32_16x16x32_bf16 a[36:39], v[24:27], v[36:39], a[36:39]
    v_mfma_f32_16x16x32_bf16 a[40:43], v[24:27], v[40:43], a[40:43]
    v_mfma_f32_16x16x32_bf16 a[44:47], v[24:27], v[44:47], a[44:47]
    v_mfma_f32_16x16x32_bf16 a[48:51], v[28:31], v[32:35], a[48:51]
    v_mfma_f32_16x16x32_bf16 a[52:55], v[28:31], v[36:39], a[52:55]
    v_mfma_f32_16x16x32_bf16 a[56:59], v[28:31], v[40:43], a[56:59]
    v_mfma_f32_16x16x32_bf16 a[60:63], v[28:31], v[44:47], a[60:63]
    s_waitcnt vmcnt(0)
    v_mfma_f32_16x16x32_bf16 a[0:3], v[48:51], v[64:67], a[0:3]
    v_mfma_f32_16x16x32_bf16 a[4:7], v[48:51], v[68:71], a[4:7]
    v_mfma_f32_16x16x32_bf16 a[8:11], v[48:51], v[72:75], a[8:11]
    v_mfma_f32_16x16x32_bf16 a[12:15], v[48:51], v[76:79], a[12:15]
    v_mfma_f32_16x16x32_bf16 a[16:19], v[52:55], v[64:67], a[16:19]
    v_mfma_f32_16x16x32_bf16 a[20:23], v[52:55], v[68:71], a[20:23]
    v_mfma_f32_16x16x32_bf16 a[24:27], v[52:55], v[72:75], a[24:27]
    v_mfma_f32_16x16x32_bf16 a[28:31], v[52:55], v[76:79], a[28:31]
    v_mfma_f32_16x16x32_bf16 a[32:35], v[56:59], v[64:67], a[32:35]
    v_mfma_f32_16x16x32_bf16 a[36:39], v[56:59], v[68:71], a[36:39]
    v_mfma_f32_16x16x32_bf16 a[40:43], v[56:59], v[72:75], a[40:43]
    v_mfma_f32_16x16x32_bf16 a[44:47], v[56:59], v[76:79], a[44:47]
    v_mfma_f32_16x16x32_bf16 a[48:51], v[60:63], v[64:67], a[48:51]
    v_mfma_f32_16x16x32_bf16 a[52:55], v[60:63], v[68:71], a[52:55]
    v_mfma_f32_16x16x32_bf16 a[56:59], v[60:63], v[72:75], a[56:59]
    v_mfma_f32_16x16x32_bf16 a[60:63], v[60:63], v[76:79], a[60:63]
    s_lshl_b32 s19, s3, 14
    v_add_u32 v4, s19, v1
    ds_write_b128 v4, a[0:3] offset:0
    ds_write_b128 v4, a[4:7] offset:1024
    ds_write_b128 v4, a[8:11] offset:2048
    ds_write_b128 v4, a[12:15] offset:3072
    ds_write_b128 v4, a[16:19] offset:4096
    ds_write_b128 v4, a[20:23] offset:5120
    ds_write_b128 v4, a[24:27] offset:6144
    ds_write_b128 v4, a[28:31] offset:7168
    ds_write_b128 v4, a[32:35] offset:8192
    ds_write_b128 v4, a[36:39] offset:9216
    ds_write_b128 v4, a[40:43] offset:10240
    ds_write_b128 v4, a[44:47] offset:11264
    ds_write_b128 v4, a[48:51] offset:12288
    ds_write_b128 v4, a[52:55] offset:13312
    ds_write_b128 v4, a[56:59] offset:14336
    ds_write_b128 v4, a[60:63] offset:15360
    s_lshl_b32 s19, s13, 2
    s_add_u32 s19, s19, s3
    s_mul_i32 s19, s19, 14336
    s_lshl_b32 s20, s12, 11
    s_add_u32 s19, s19, s20
    s_add_u32 s21, s19, 15040512
    buffer_load_dwordx4 v[80:83], v1, s[8:11], s21 offen
    buffer_load_dwordx4 v[84:87], v1, s[8:11], s21 offen offset:1024
    s_lshl_b32 s20, s12, 7
    v_lshl_add_u32 v5, v3, 3, s20
    buffer_load_dwordx2 v[88:89], v5, s[24:27], 0 offen offset:0
    buffer_load_dwordx2 v[90:91], v5, s[24:27], 0 offen offset:32
    buffer_load_dwordx2 v[92:93], v5, s[24:27], 0 offen offset:64
    buffer_load_dwordx2 v[94:95], v5, s[24:27], 0 offen offset:96
    s_waitcnt lgkmcnt(0)
    s_barrier
    s_lshl_b32 s20, s3, 10
    v_add_u32 v4, s20, v1
    ds_read_b128 v[16:19], v4 offset:0
    ds_read_b128 v[20:23], v4 offset:4096
    ds_read_b128 v[24:27], v4 offset:8192
    ds_read_b128 v[28:31], v4 offset:12288
    ds_read_b128 v[32:35], v4 offset:16384
    ds_read_b128 v[36:39], v4 offset:20480
    ds_read_b128 v[40:43], v4 offset:24576
    ds_read_b128 v[44:47], v4 offset:28672
    ds_read_b128 v[48:51], v4 offset:32768
    ds_read_b128 v[52:55], v4 offset:36864
    ds_read_b128 v[56:59], v4 offset:40960
    ds_read_b128 v[60:63], v4 offset:45056
    ds_read_b128 v[64:67], v4 offset:49152
    ds_read_b128 v[68:71], v4 offset:53248
    ds_read_b128 v[72:75], v4 offset:57344
    ds_read_b128 v[76:79], v4 offset:61440
    s_waitcnt lgkmcnt(8)
    v_add_f32 v16, v16, v32
    v_add_f32 v17, v17, v33
    v_add_f32 v18, v18, v34
    v_add_f32 v19, v19, v35
    v_add_f32 v20, v20, v36
    v_add_f32 v21, v21, v37
    v_add_f32 v22, v22, v38
    v_add_f32 v23, v23, v39
    v_add_f32 v24, v24, v40
    v_add_f32 v25, v25, v41
    v_add_f32 v26, v26, v42
    v_add_f32 v27, v27, v43
    v_add_f32 v28, v28, v44
    v_add_f32 v29, v29, v45
    v_add_f32 v30, v30, v46
    v_add_f32 v31, v31, v47
    s_waitcnt lgkmcnt(0)
    v_add_f32 v48, v48, v64
    v_add_f32 v16, v16, v48
    v_add_f32 v49, v49, v65
    v_add_f32 v17, v17, v49
    v_add_f32 v50, v50, v66
    v_add_f32 v18, v18, v50
    v_add_f32 v51, v51, v67
    v_add_f32 v19, v19, v51
    v_add_f32 v52, v52, v68
    v_add_f32 v20, v20, v52
    v_add_f32 v53, v53, v69
    v_add_f32 v21, v21, v53
    v_add_f32 v54, v54, v70
    v_add_f32 v22, v22, v54
    v_add_f32 v55, v55, v71
    v_add_f32 v23, v23, v55
    v_add_f32 v56, v56, v72
    v_add_f32 v24, v24, v56
    v_add_f32 v57, v57, v73
    v_add_f32 v25, v25, v57
    v_add_f32 v58, v58, v74
    v_add_f32 v26, v26, v58
    v_add_f32 v59, v59, v75
    v_add_f32 v27, v27, v59
    v_add_f32 v60, v60, v76
    v_add_f32 v28, v28, v60
    v_add_f32 v61, v61, v77
    v_add_f32 v29, v29, v61
    v_add_f32 v62, v62, v78
    v_add_f32 v30, v30, v62
    v_add_f32 v63, v63, v79
    v_add_f32 v31, v31, v63
    s_waitcnt vmcnt(0)
    v_cvt_pk_bf16_f32 v6, v16, v17
    v_lshlrev_b32 v16, 16, v6
    v_and_b32 v17, 0xffff0000, v6
    v_lshlrev_b32 v7, 16, v88
    v_and_b32 v8, 0xffff0000, v88
    v_add_f32 v16, v16, v7
    v_add_f32 v17, v17, v8
    v_cvt_pk_bf16_f32 v6, v16, v17
    v_lshlrev_b32 v16, 16, v6
    v_and_b32 v17, 0xffff0000, v6
    v_lshlrev_b32 v7, 16, v80
    v_and_b32 v8, 0xffff0000, v80
    v_add_f32 v16, v16, v7
    v_add_f32 v17, v17, v8
    v_cvt_pk_bf16_f32 v96, v16, v17
    v_cvt_pk_bf16_f32 v6, v18, v19
    v_lshlrev_b32 v18, 16, v6
    v_and_b32 v19, 0xffff0000, v6
    v_lshlrev_b32 v7, 16, v89
    v_and_b32 v8, 0xffff0000, v89
    v_add_f32 v18, v18, v7
    v_add_f32 v19, v19, v8
    v_cvt_pk_bf16_f32 v6, v18, v19
    v_lshlrev_b32 v18, 16, v6
    v_and_b32 v19, 0xffff0000, v6
    v_lshlrev_b32 v7, 16, v81
    v_and_b32 v8, 0xffff0000, v81
    v_add_f32 v18, v18, v7
    v_add_f32 v19, v19, v8
    v_cvt_pk_bf16_f32 v97, v18, v19
    v_cvt_pk_bf16_f32 v6, v20, v21
    v_lshlrev_b32 v20, 16, v6
    v_and_b32 v21, 0xffff0000, v6
    v_lshlrev_b32 v7, 16, v90
    v_and_b32 v8, 0xffff0000, v90
    v_add_f32 v20, v20, v7
    v_add_f32 v21, v21, v8
    v_cvt_pk_bf16_f32 v6, v20, v21
    v_lshlrev_b32 v20, 16, v6
    v_and_b32 v21, 0xffff0000, v6
    v_lshlrev_b32 v7, 16, v82
    v_and_b32 v8, 0xffff0000, v82
    v_add_f32 v20, v20, v7
    v_add_f32 v21, v21, v8
    v_cvt_pk_bf16_f32 v98, v20, v21
    v_cvt_pk_bf16_f32 v6, v22, v23
    v_lshlrev_b32 v22, 16, v6
    v_and_b32 v23, 0xffff0000, v6
    v_lshlrev_b32 v7, 16, v91
    v_and_b32 v8, 0xffff0000, v91
    v_add_f32 v22, v22, v7
    v_add_f32 v23, v23, v8
    v_cvt_pk_bf16_f32 v6, v22, v23
    v_lshlrev_b32 v22, 16, v6
    v_and_b32 v23, 0xffff0000, v6
    v_lshlrev_b32 v7, 16, v83
    v_and_b32 v8, 0xffff0000, v83
    v_add_f32 v22, v22, v7
    v_add_f32 v23, v23, v8
    v_cvt_pk_bf16_f32 v99, v22, v23
    v_cvt_pk_bf16_f32 v6, v24, v25
    v_lshlrev_b32 v24, 16, v6
    v_and_b32 v25, 0xffff0000, v6
    v_lshlrev_b32 v7, 16, v92
    v_and_b32 v8, 0xffff0000, v92
    v_add_f32 v24, v24, v7
    v_add_f32 v25, v25, v8
    v_cvt_pk_bf16_f32 v6, v24, v25
    v_lshlrev_b32 v24, 16, v6
    v_and_b32 v25, 0xffff0000, v6
    v_lshlrev_b32 v7, 16, v84
    v_and_b32 v8, 0xffff0000, v84
    v_add_f32 v24, v24, v7
    v_add_f32 v25, v25, v8
    v_cvt_pk_bf16_f32 v100, v24, v25
    v_cvt_pk_bf16_f32 v6, v26, v27
    v_lshlrev_b32 v26, 16, v6
    v_and_b32 v27, 0xffff0000, v6
    v_lshlrev_b32 v7, 16, v93
    v_and_b32 v8, 0xffff0000, v93
    v_add_f32 v26, v26, v7
    v_add_f32 v27, v27, v8
    v_cvt_pk_bf16_f32 v6, v26, v27
    v_lshlrev_b32 v26, 16, v6
    v_and_b32 v27, 0xffff0000, v6
    v_lshlrev_b32 v7, 16, v85
    v_and_b32 v8, 0xffff0000, v85
    v_add_f32 v26, v26, v7
    v_add_f32 v27, v27, v8
    v_cvt_pk_bf16_f32 v101, v26, v27
    v_cvt_pk_bf16_f32 v6, v28, v29
    v_lshlrev_b32 v28, 16, v6
    v_and_b32 v29, 0xffff0000, v6
    v_lshlrev_b32 v7, 16, v94
    v_and_b32 v8, 0xffff0000, v94
    v_add_f32 v28, v28, v7
    v_add_f32 v29, v29, v8
    v_cvt_pk_bf16_f32 v6, v28, v29
    v_lshlrev_b32 v28, 16, v6
    v_and_b32 v29, 0xffff0000, v6
    v_lshlrev_b32 v7, 16, v86
    v_and_b32 v8, 0xffff0000, v86
    v_add_f32 v28, v28, v7
    v_add_f32 v29, v29, v8
    v_cvt_pk_bf16_f32 v102, v28, v29
    v_cvt_pk_bf16_f32 v6, v30, v31
    v_lshlrev_b32 v30, 16, v6
    v_and_b32 v31, 0xffff0000, v6
    v_lshlrev_b32 v7, 16, v95
    v_and_b32 v8, 0xffff0000, v95
    v_add_f32 v30, v30, v7
    v_add_f32 v31, v31, v8
    v_cvt_pk_bf16_f32 v6, v30, v31
    v_lshlrev_b32 v30, 16, v6
    v_and_b32 v31, 0xffff0000, v6
    v_lshlrev_b32 v7, 16, v87
    v_and_b32 v8, 0xffff0000, v87
    v_add_f32 v30, v30, v7
    v_add_f32 v31, v31, v8
    v_cvt_pk_bf16_f32 v103, v30, v31
    s_lshl_b32 s20, s13, 2
    s_add_u32 s20, s20, s3
    s_lshl_b32 s20, s20, 4
    v_add_u32 v5, s20, v2
    v_mul_u32_u24 v5, 896, v5
    v_lshl_add_u32 v5, v3, 3, v5
    s_lshl_b32 s20, s12, 7
    v_add_u32 v5, s20, v5
    buffer_store_dwordx2 v[96:97], v5, s[28:31], 0 offen offset:0
    buffer_store_dwordx2 v[98:99], v5, s[28:31], 0 offen offset:32
    buffer_store_dwordx2 v[100:101], v5, s[28:31], 0 offen offset:64
    buffer_store_dwordx2 v[102:103], v5, s[28:31], 0 offen offset:96
    s_nop 11
K4_END_15040512:
    s_endpgm
.section .rodata,"a"
.p2align 6
.amdhsa_kernel prep_kernel
  .amdhsa_next_free_vgpr 24
  .amdhsa_next_free_sgpr 80
  .amdhsa_accum_offset 24
  .amdhsa_group_segment_fixed_size 0
  .amdhsa_kernarg_size 96
  .amdhsa_user_sgpr_count 2
  .amdhsa_user_sgpr_kernarg_segment_ptr 1
  .amdhsa_system_sgpr_workgroup_id_x 1
.end_amdhsa_kernel
.p2align 6
.amdhsa_kernel qkv0_kernel
  .amdhsa_next_free_vgpr 236
  .amdhsa_next_free_sgpr 80
  .amdhsa_accum_offset 180
  .amdhsa_group_segment_fixed_size 0
  .amdhsa_kernarg_size 96
  .amdhsa_user_sgpr_count 2
  .amdhsa_user_sgpr_kernarg_segment_ptr 1
  .amdhsa_system_sgpr_workgroup_id_x 1
.end_amdhsa_kernel
.p2align 6
.amdhsa_kernel wo0_kernel
  .amdhsa_next_free_vgpr 400
  .amdhsa_next_free_sgpr 80
  .amdhsa_accum_offset 208
  .amdhsa_group_segment_fixed_size 0
  .amdhsa_kernarg_size 96
  .amdhsa_user_sgpr_count 2
  .amdhsa_user_sgpr_kernarg_segment_ptr 1
  .amdhsa_system_sgpr_workgroup_id_x 1
.end_amdhsa_kernel
.p2align 6
.amdhsa_kernel ffa0_kernel
  .amdhsa_next_free_vgpr 240
  .amdhsa_next_free_sgpr 80
  .amdhsa_accum_offset 168
  .amdhsa_group_segment_fixed_size 0
  .amdhsa_kernarg_size 96
  .amdhsa_user_sgpr_count 2
  .amdhsa_user_sgpr_kernarg_segment_ptr 1
  .amdhsa_system_sgpr_workgroup_id_x 1
.end_amdhsa_kernel
.p2align 6
.amdhsa_kernel ffb0_kernel
  .amdhsa_next_free_vgpr 272
  .amdhsa_next_free_sgpr 80
  .amdhsa_accum_offset 208
  .amdhsa_group_segment_fixed_size 0
  .amdhsa_kernarg_size 96
  .amdhsa_user_sgpr_count 2
  .amdhsa_user_sgpr_kernarg_segment_ptr 1
  .amdhsa_system_sgpr_workgroup_id_x 1
.end_amdhsa_kernel
.p2align 6
.amdhsa_kernel qkv1_kernel
  .amdhsa_next_free_vgpr 236
  .amdhsa_next_free_sgpr 80
  .amdhsa_accum_offset 180
  .amdhsa_group_segment_fixed_size 0
  .amdhsa_kernarg_size 96
  .amdhsa_user_sgpr_count 2
  .amdhsa_user_sgpr_kernarg_segment_ptr 1
  .amdhsa_system_sgpr_workgroup_id_x 1
.end_amdhsa_kernel
.p2align 6
.amdhsa_kernel wo1_kernel
  .amdhsa_next_free_vgpr 400
  .amdhsa_next_free_sgpr 80
  .amdhsa_accum_offset 208
  .amdhsa_group_segment_fixed_size 0
  .amdhsa_kernarg_size 96
  .amdhsa_user_sgpr_count 2
  .amdhsa_user_sgpr_kernarg_segment_ptr 1
  .amdhsa_system_sgpr_workgroup_id_x 1
.end_amdhsa_kernel
.p2align 6
.amdhsa_kernel ffa1_kernel
  .amdhsa_next_free_vgpr 240
  .amdhsa_next_free_sgpr 80
  .amdhsa_accum_offset 168
  .amdhsa_group_segment_fixed_size 0
  .amdhsa_kernarg_size 96
  .amdhsa_user_sgpr_count 2
  .amdhsa_user_sgpr_kernarg_segment_ptr 1
  .amdhsa_system_sgpr_workgroup_id_x 1
.end_amdhsa_kernel
.p2align 6
.amdhsa_kernel ffb1_kernel
  .amdhsa_next_free_vgpr 272
  .amdhsa_next_free_sgpr 80
  .amdhsa_accum_offset 208
  .amdhsa_group_segment_fixed_size 0
  .amdhsa_kernarg_size 96
  .amdhsa_user_sgpr_count 2
  .amdhsa_user_sgpr_kernarg_segment_ptr 1
  .amdhsa_system_sgpr_workgroup_id_x 1
.end_amdhsa_kernel
```
